```python
import torch

def _softmax(x, axis=-1):
    return torch.softmax(x, dim=axis)
def _gelu(x):
    return torch.nn.functional.gelu(x, approximate="tanh")
def _silu(x):
    return torch.nn.functional.silu(x)
def _sigmoid(x):
    return torch.sigmoid(x)
def _layernorm(x, axis=-1, eps=1e-5):
    m = x.mean(dim=axis, keepdim=True)
    v = x.var(dim=axis, keepdim=True, unbiased=False)
    return (x - m) / torch.sqrt(v + eps)
def _scatter_add(tgt, idx, src, axis=0):
    return tgt.clone().index_add_(axis, idx, src)
def _segment_sum(src, seg, n):
    out = torch.zeros((n,) + src.shape[1:], dtype=src.dtype)
    return out.index_add_(0, seg, src)
def _pad(x, pw):
    flat = tuple(v for pair in reversed(pw) for v in pair)
    return torch.nn.functional.pad(x, flat)

kernel_name = 'interleave_layers__ssm_conv_h3__glu_gated_reglu__prompt'

def setup_inputs():

    _w = (lambda a: (lambda t: t.to(torch.bfloat16) if t.is_floating_point() else t)(torch.as_tensor(a)))
    def _A_setup():
        B, S, D = 1, 2048, 448
        ks = 4
        return {
            "q": _w((lambda *s: torch.randn(*s, dtype=torch.bfloat16) * 0.05)(B, S, D)),
            "k": _w((lambda *s: torch.randn(*s, dtype=torch.bfloat16) * 0.2)(B, S, D)),
            "v": _w((lambda *s: torch.randn(*s, dtype=torch.bfloat16) * 0.2)(B, S, D)),
            "shift_k": _w((lambda *s: torch.randn(*s, dtype=torch.bfloat16) * 0.2)(D, ks) * 0.5),
            "ssm_k": _w((lambda *s: torch.randn(*s, dtype=torch.bfloat16) * 0.2)(D, S) * (1.0 / S ** 0.5)),
            "ssm_D": _w((lambda *s: torch.randn(*s, dtype=torch.bfloat16) * 0.2)(D)),
        }
    _A_in = _A_setup()

    def _B_setup():
        B, S, D, F = 1, 2048, 448, 1792
        return {
            "x": _w((lambda *s: torch.randn(*s, dtype=torch.bfloat16) * 0.05)(B, S, D)),
            "W_gate": _w((lambda *s: torch.randn(*s, dtype=torch.bfloat16) * 0.2)(D, F) * (2.0 / D) ** 0.5),
            "W_up": _w((lambda *s: torch.randn(*s, dtype=torch.bfloat16) * 0.2)(D, F) * (2.0 / D) ** 0.5),
            "W_down": _w((lambda *s: torch.randn(*s, dtype=torch.bfloat16) * 0.2)(F, D) * (1.0 / F) ** 0.5),
        }
    _B_in = _B_setup()

    return {
        "A_q": _A_in["q"],
        "A_k": _A_in["k"],
        "A_v": _A_in["v"],
        "A_shift_k": _A_in["shift_k"],
        "A_ssm_k": _A_in["ssm_k"],
        "A_ssm_D": _A_in["ssm_D"],
        "B_x": _B_in["x"],
        "B_W_gate": _B_in["W_gate"],
        "B_W_up": _B_in["W_up"],
        "B_W_down": _B_in["W_down"],
    }

def reference(A_q, A_k, A_v, A_shift_k, A_ssm_k, A_ssm_D, B_x, B_W_gate, B_W_up, B_W_down):
    def _A_ref(q, k, v, shift_k, ssm_k, ssm_D):
        B, S, D = q.shape
        ks = shift_k.shape[-1]
        k_pad = _pad(k, ((0, 0), (ks - 1, 0), (0, 0)))
        k_shift = torch.zeros_like(k)
        for t in range(ks):
            k_shift = k_shift + k_pad[:, t:t + S, :] * shift_k[:, ks - 1 - t][None, None, :]
        kv = k_shift * v
        L = 2 * S
        kv_pad = _pad(kv, ((0, 0), (0, S), (0, 0)))
        kf_pad = _pad(ssm_k, ((0, 0), (0, S)))
        kv_f = (lambda x, axes=(-2,-1): torch.fft.rfft2(x.float(), dim=axes))(kv_pad[:, None, :, :], axes=(1, 2))
        kf_f = (lambda x, axes=(-2,-1): torch.fft.rfft2(x.float(), dim=axes))(kf_pad[:, None, :], axes=(1, 2))
        kf_f = (lambda x, *d: x.permute(*d))(kf_f, 1, 2, 0)
        y_f = kv_f * kf_f[None, :, :, :]
        y = (lambda x, s, axes=(-2,-1): torch.fft.irfft2(x, s=s, dim=axes).to(torch.bfloat16))(y_f, (1, L), axes=(1, 2))[:, 0, :S, :]
        y = y + kv * ssm_D[None, None, :]
        return q * y

    def _B_ref(x, W_gate, W_up, W_down):
        gate = torch.einsum("bsd,df->bsf", x, W_gate)
        up = torch.einsum("bsd,df->bsf", x, W_up)
        gate = gate * (lambda x, dt: x.to(dt))(gate > 0, gate.dtype)
        h = gate * up
        return torch.einsum("bsf,fd->bsd", h, W_down)

    x = A_q
    x = x + _A_ref(_layernorm(x, axis=-1), A_k, A_v, A_shift_k, A_ssm_k, A_ssm_D)
    x = x + _B_ref(_layernorm(x, axis=-1), B_W_gate, B_W_up, B_W_down)
    x = x + _A_ref(_layernorm(x, axis=-1), A_k, A_v, A_shift_k, A_ssm_k, A_ssm_D)
    x = x + _B_ref(_layernorm(x, axis=-1), B_W_gate, B_W_up, B_W_down)
    return x
```

```asm
; @launch kernel=pre_kernel grid=(456,1,1) block=(256,1,1) lds=36864
; @launch kernel=ffn_kernel grid=(256,1,1) block=(256,1,1) lds=163840
.amdgcn_target "amdgcn-amd-amdhsa--gfx950"
.text
.globl pre_kernel
.p2align 8
.type pre_kernel,@function
pre_kernel:
    s_load_dwordx2 s[4:5], s[0:1], 96
    s_mov_b32 s75, s2
    v_lshrrev_b32 v1, 6, v0
    s_nop 0
    v_readfirstlane_b32 s3, v1
    v_and_b32 v2, 63, v0
    s_cmp_ge_u32 s2, 456
    s_cbranch_scc1 pre_exit
    s_add_u32 s2, s2, 232
    s_cmp_ge_u32 s2, 456
    s_cselect_b32 s6, 456, 0
    s_sub_u32 s2, s2, s6
    s_mov_b32 s75, s2
    s_cmp_lt_u32 s2, 112
    s_cbranch_scc1 prep_w1
    s_cmp_lt_u32 s2, 168
    s_cbranch_scc1 prep_w2
    s_cmp_lt_u32 s2, 232
    s_cbranch_scc1 fr_ln
    s_cmp_lt_u32 s2, 456
    s_cbranch_scc1 prep_kv
pre_exit:
    s_endpgm
fr_ln:
    s_load_dwordx2 s[6:7], s[0:1], 0
    s_sub_u32 s2, s2, 168
    s_lshl_b32 s20, s2, 5
    s_lshl_b32 s21, s3, 3
    s_add_u32 s20, s20, s21
    v_lshrrev_b32 v3, 3, v2
    v_and_b32 v4, 7, v2
    v_add_u32 v3, s20, v3
    v_mul_u32_u24 v5, 896, v3
    v_lshl_add_u32 v5, v4, 4, v5
    s_waitcnt lgkmcnt(0)
    s_mov_b32 s8, s6
    s_mov_b32 s9, s7
    s_mov_b32 s10, 1835008
    s_mov_b32 s11, 0x00020000
    s_add_u32 s12, s4, 2097152
    s_addc_u32 s13, s5, 0
    s_mov_b32 s14, 16384
    s_mov_b32 s15, 0x00020000
    s_add_u32 s24, s4, 31457280
    s_addc_u32 s25, s5, 0
    s_mov_b32 s26, 1572864
    s_mov_b32 s27, 0x00020000
    buffer_load_dwordx4 v[8:11], v5, s[8:11], 0 offen offset:0
    buffer_load_dwordx4 v[12:15], v5, s[8:11], 0 offen offset:128
    buffer_load_dwordx4 v[16:19], v5, s[8:11], 0 offen offset:256
    buffer_load_dwordx4 v[20:23], v5, s[8:11], 0 offen offset:384
    buffer_load_dwordx4 v[24:27], v5, s[8:11], 0 offen offset:512
    buffer_load_dwordx4 v[28:31], v5, s[8:11], 0 offen offset:640
    buffer_load_dwordx4 v[32:35], v5, s[8:11], 0 offen offset:768
    v_lshlrev_b32 v6, 4, v0
    v_mov_b32 v40, 0
    v_mov_b32 v41, 0
    v_mov_b32 v42, 0
    v_mov_b32 v43, 0
    s_lshl_b32 s21, s2, 12
    s_add_u32 s23, s21, 0
    buffer_store_dwordx4 v[40:43], v6, s[24:27], s23 offen sc1
    s_add_u32 s23, s21, 786432
    buffer_store_dwordx4 v[40:43], v6, s[24:27], s23 offen sc1
    s_add_u32 s23, s21, 1310720
    buffer_store_dwordx4 v[40:43], v6, s[24:27], s23 offen sc1
    v_lshrrev_b32 v7, 2, v0
    v_lshlrev_b32 v7, 8, v7
    v_and_b32 v49, 3, v0
    v_lshl_add_u32 v7, v49, 4, v7
    s_lshl_b32 s21, s2, 14
    s_add_u32 s23, s21, 262144
    s_add_u32 s21, s21, 524288
    s_cmp_lt_u32 s2, 32
    s_cselect_b32 s23, s23, s21
    s_cmp_lt_u32 s2, 44
    s_cselect_b32 s23, s23, 2147483648
    buffer_store_dwordx4 v[40:43], v7, s[24:27], s23 offen sc1
    v_mov_b32 v44, 0
    s_mov_b32 s22, 0x3f803f80
    s_waitcnt vmcnt(4)
    v_dot2_f32_bf16 v44, v8, s22, v44
    v_dot2_f32_bf16 v44, v9, s22, v44
    v_dot2_f32_bf16 v44, v10, s22, v44
    v_dot2_f32_bf16 v44, v11, s22, v44
    v_dot2_f32_bf16 v44, v12, s22, v44
    v_dot2_f32_bf16 v44, v13, s22, v44
    v_dot2_f32_bf16 v44, v14, s22, v44
    v_dot2_f32_bf16 v44, v15, s22, v44
    v_dot2_f32_bf16 v44, v16, s22, v44
    v_dot2_f32_bf16 v44, v17, s22, v44
    v_dot2_f32_bf16 v44, v18, s22, v44
    v_dot2_f32_bf16 v44, v19, s22, v44
    v_dot2_f32_bf16 v44, v20, s22, v44
    v_dot2_f32_bf16 v44, v21, s22, v44
    v_dot2_f32_bf16 v44, v22, s22, v44
    v_dot2_f32_bf16 v44, v23, s22, v44
    v_dot2_f32_bf16 v44, v24, s22, v44
    v_dot2_f32_bf16 v44, v25, s22, v44
    v_dot2_f32_bf16 v44, v26, s22, v44
    v_dot2_f32_bf16 v44, v27, s22, v44
    v_dot2_f32_bf16 v44, v28, s22, v44
    v_dot2_f32_bf16 v44, v29, s22, v44
    v_dot2_f32_bf16 v44, v30, s22, v44
    v_dot2_f32_bf16 v44, v31, s22, v44
    v_dot2_f32_bf16 v44, v32, s22, v44
    v_dot2_f32_bf16 v44, v33, s22, v44
    v_dot2_f32_bf16 v44, v34, s22, v44
    v_dot2_f32_bf16 v44, v35, s22, v44
    s_nop 2
    v_add_f32_dpp v44, v44, v44 quad_perm:[1,0,3,2] row_mask:0xf bank_mask:0xf
    s_nop 1
    v_add_f32_dpp v44, v44, v44 quad_perm:[2,3,0,1] row_mask:0xf bank_mask:0xf
    s_nop 1
    v_add_f32_dpp v44, v44, v44 row_half_mirror row_mask:0xf bank_mask:0xf
    v_mul_f32 v44, 0x3b124925, v44
    v_mov_b32 v45, 0
    v_mov_b32 v46, 0
    v_lshlrev_b32 v47, 16, v8
    v_and_b32 v48, 0xffff0000, v8
    v_sub_f32 v47, v47, v44
    v_sub_f32 v48, v48, v44
    v_fmac_f32 v45, v47, v47
    v_fmac_f32 v46, v48, v48
    v_lshlrev_b32 v47, 16, v9
    v_and_b32 v48, 0xffff0000, v9
    v_sub_f32 v47, v47, v44
    v_sub_f32 v48, v48, v44
    v_fmac_f32 v45, v47, v47
    v_fmac_f32 v46, v48, v48
    v_lshlrev_b32 v47, 16, v10
    v_and_b32 v48, 0xffff0000, v10
    v_sub_f32 v47, v47, v44
    v_sub_f32 v48, v48, v44
    v_fmac_f32 v45, v47, v47
    v_fmac_f32 v46, v48, v48
    v_lshlrev_b32 v47, 16, v11
    v_and_b32 v48, 0xffff0000, v11
    v_sub_f32 v47, v47, v44
    v_sub_f32 v48, v48, v44
    v_fmac_f32 v45, v47, v47
    v_fmac_f32 v46, v48, v48
    v_lshlrev_b32 v47, 16, v12
    v_and_b32 v48, 0xffff0000, v12
    v_sub_f32 v47, v47, v44
    v_sub_f32 v48, v48, v44
    v_fmac_f32 v45, v47, v47
    v_fmac_f32 v46, v48, v48
    v_lshlrev_b32 v47, 16, v13
    v_and_b32 v48, 0xffff0000, v13
    v_sub_f32 v47, v47, v44
    v_sub_f32 v48, v48, v44
    v_fmac_f32 v45, v47, v47
    v_fmac_f32 v46, v48, v48
    v_lshlrev_b32 v47, 16, v14
    v_and_b32 v48, 0xffff0000, v14
    v_sub_f32 v47, v47, v44
    v_sub_f32 v48, v48, v44
    v_fmac_f32 v45, v47, v47
    v_fmac_f32 v46, v48, v48
    v_lshlrev_b32 v47, 16, v15
    v_and_b32 v48, 0xffff0000, v15
    v_sub_f32 v47, v47, v44
    v_sub_f32 v48, v48, v44
    v_fmac_f32 v45, v47, v47
    v_fmac_f32 v46, v48, v48
    v_lshlrev_b32 v47, 16, v16
    v_and_b32 v48, 0xffff0000, v16
    v_sub_f32 v47, v47, v44
    v_sub_f32 v48, v48, v44
    v_fmac_f32 v45, v47, v47
    v_fmac_f32 v46, v48, v48
    v_lshlrev_b32 v47, 16, v17
    v_and_b32 v48, 0xffff0000, v17
    v_sub_f32 v47, v47, v44
    v_sub_f32 v48, v48, v44
    v_fmac_f32 v45, v47, v47
    v_fmac_f32 v46, v48, v48
    v_lshlrev_b32 v47, 16, v18
    v_and_b32 v48, 0xffff0000, v18
    v_sub_f32 v47, v47, v44
    v_sub_f32 v48, v48, v44
    v_fmac_f32 v45, v47, v47
    v_fmac_f32 v46, v48, v48
    v_lshlrev_b32 v47, 16, v19
    v_and_b32 v48, 0xffff0000, v19
    v_sub_f32 v47, v47, v44
    v_sub_f32 v48, v48, v44
    v_fmac_f32 v45, v47, v47
    v_fmac_f32 v46, v48, v48
    v_lshlrev_b32 v47, 16, v20
    v_and_b32 v48, 0xffff0000, v20
    v_sub_f32 v47, v47, v44
    v_sub_f32 v48, v48, v44
    v_fmac_f32 v45, v47, v47
    v_fmac_f32 v46, v48, v48
    v_lshlrev_b32 v47, 16, v21
    v_and_b32 v48, 0xffff0000, v21
    v_sub_f32 v47, v47, v44
    v_sub_f32 v48, v48, v44
    v_fmac_f32 v45, v47, v47
    v_fmac_f32 v46, v48, v48
    v_lshlrev_b32 v47, 16, v22
    v_and_b32 v48, 0xffff0000, v22
    v_sub_f32 v47, v47, v44
    v_sub_f32 v48, v48, v44
    v_fmac_f32 v45, v47, v47
    v_fmac_f32 v46, v48, v48
    v_lshlrev_b32 v47, 16, v23
    v_and_b32 v48, 0xffff0000, v23
    v_sub_f32 v47, v47, v44
    v_sub_f32 v48, v48, v44
    v_fmac_f32 v45, v47, v47
    v_fmac_f32 v46, v48, v48
    v_lshlrev_b32 v47, 16, v24
    v_and_b32 v48, 0xffff0000, v24
    v_sub_f32 v47, v47, v44
    v_sub_f32 v48, v48, v44
    v_fmac_f32 v45, v47, v47
    v_fmac_f32 v46, v48, v48
    v_lshlrev_b32 v47, 16, v25
    v_and_b32 v48, 0xffff0000, v25
    v_sub_f32 v47, v47, v44
    v_sub_f32 v48, v48, v44
    v_fmac_f32 v45, v47, v47
    v_fmac_f32 v46, v48, v48
    v_lshlrev_b32 v47, 16, v26
    v_and_b32 v48, 0xffff0000, v26
    v_sub_f32 v47, v47, v44
    v_sub_f32 v48, v48, v44
    v_fmac_f32 v45, v47, v47
    v_fmac_f32 v46, v48, v48
    v_lshlrev_b32 v47, 16, v27
    v_and_b32 v48, 0xffff0000, v27
    v_sub_f32 v47, v47, v44
    v_sub_f32 v48, v48, v44
    v_fmac_f32 v45, v47, v47
    v_fmac_f32 v46, v48, v48
    v_lshlrev_b32 v47, 16, v28
    v_and_b32 v48, 0xffff0000, v28
    v_sub_f32 v47, v47, v44
    v_sub_f32 v48, v48, v44
    v_fmac_f32 v45, v47, v47
    v_fmac_f32 v46, v48, v48
    v_lshlrev_b32 v47, 16, v29
    v_and_b32 v48, 0xffff0000, v29
    v_sub_f32 v47, v47, v44
    v_sub_f32 v48, v48, v44
    v_fmac_f32 v45, v47, v47
    v_fmac_f32 v46, v48, v48
    v_lshlrev_b32 v47, 16, v30
    v_and_b32 v48, 0xffff0000, v30
    v_sub_f32 v47, v47, v44
    v_sub_f32 v48, v48, v44
    v_fmac_f32 v45, v47, v47
    v_fmac_f32 v46, v48, v48
    v_lshlrev_b32 v47, 16, v31
    v_and_b32 v48, 0xffff0000, v31
    v_sub_f32 v47, v47, v44
    v_sub_f32 v48, v48, v44
    v_fmac_f32 v45, v47, v47
    v_fmac_f32 v46, v48, v48
    v_lshlrev_b32 v47, 16, v32
    v_and_b32 v48, 0xffff0000, v32
    v_sub_f32 v47, v47, v44
    v_sub_f32 v48, v48, v44
    v_fmac_f32 v45, v47, v47
    v_fmac_f32 v46, v48, v48
    v_lshlrev_b32 v47, 16, v33
    v_and_b32 v48, 0xffff0000, v33
    v_sub_f32 v47, v47, v44
    v_sub_f32 v48, v48, v44
    v_fmac_f32 v45, v47, v47
    v_fmac_f32 v46, v48, v48
    v_lshlrev_b32 v47, 16, v34
    v_and_b32 v48, 0xffff0000, v34
    v_sub_f32 v47, v47, v44
    v_sub_f32 v48, v48, v44
    v_fmac_f32 v45, v47, v47
    v_fmac_f32 v46, v48, v48
    v_lshlrev_b32 v47, 16, v35
    v_and_b32 v48, 0xffff0000, v35
    v_sub_f32 v47, v47, v44
    v_sub_f32 v48, v48, v44
    v_fmac_f32 v45, v47, v47
    v_fmac_f32 v46, v48, v48
    v_add_f32 v45, v45, v46
    s_nop 1
    v_add_f32_dpp v45, v45, v45 quad_perm:[1,0,3,2] row_mask:0xf bank_mask:0xf
    s_nop 1
    v_add_f32_dpp v45, v45, v45 quad_perm:[2,3,0,1] row_mask:0xf bank_mask:0xf
    s_nop 1
    v_add_f32_dpp v45, v45, v45 row_half_mirror row_mask:0xf bank_mask:0xf
    v_mul_f32 v45, 0x3b124925, v45
    v_cvt_pk_bf16_f32 v44, v44, v44
    v_lshlrev_b32 v44, 16, v44
    v_cvt_pk_bf16_f32 v45, v45, v45
    v_lshlrev_b32 v45, 16, v45
    v_add_f32 v45, 0x3727c5ac, v45
    v_cvt_pk_bf16_f32 v45, v45, v45
    v_lshlrev_b32 v45, 16, v45
    v_sqrt_f32 v45, v45
    s_nop 0
    v_cvt_pk_bf16_f32 v45, v45, v45
    v_lshlrev_b32 v45, 16, v45
    v_rcp_f32 v45, v45
    v_lshlrev_b32 v3, 3, v3
    v_cmp_eq_u32 vcc, 0, v4
    v_mov_b32 v6, 2147483648
    s_nop 0
    v_cndmask_b32 v3, v6, v3, vcc
    buffer_store_dwordx2 v[44:45], v3, s[12:15], 0 offen
    s_endpgm
prep_kv:
    s_load_dwordx4 s[24:27], s[0:1], 8
    s_load_dwordx2 s[28:29], s[0:1], 24
    s_load_dwordx2 s[36:37], s[0:1], 32
    s_sub_u32 s2, s2, 232
    s_and_b32 s20, s2, 31
    s_lshr_b32 s21, s2, 5
    v_and_b32 v3, 7, v0
    v_lshrrev_b32 v4, 3, v0
    s_lshl_b32 s22, s20, 6
    v_lshl_add_u32 v5, v4, 1, s22
    s_movk_i32 s23, 896
    v_mul_lo_u32 v5, v5, s23
    s_lshl_b32 s22, s21, 7
    v_lshl_add_u32 v6, v3, 4, s22
    v_add_u32 v5, v5, v6
    v_mov_b32 v10, 2147483648
    v_subrev_u32 v7, 2688, v5
    v_cmp_gt_i32 vcc, 0, v7
    s_nop 1
    v_cndmask_b32 v7, v7, v10, vcc
    v_subrev_u32 v8, 1792, v5
    v_cmp_gt_i32 vcc, 0, v8
    s_nop 1
    v_cndmask_b32 v8, v8, v10, vcc
    v_subrev_u32 v9, 896, v5
    v_cmp_gt_i32 vcc, 0, v9
    s_nop 1
    v_cndmask_b32 v9, v9, v10, vcc
    v_lshlrev_b32 v11, 2, v6
    s_waitcnt lgkmcnt(0)
    s_mov_b32 s8, s24
    s_mov_b32 s9, s25
    s_mov_b32 s10, 1835008
    s_mov_b32 s11, 0x00020000
    s_mov_b32 s12, s26
    s_mov_b32 s13, s27
    s_mov_b32 s14, 1835008
    s_mov_b32 s15, 0x00020000
    s_mov_b32 s16, s28
    s_mov_b32 s17, s29
    s_mov_b32 s18, 3584
    s_mov_b32 s19, 0x00020000
    s_mov_b32 s32, s4
    s_mov_b32 s33, s5
    s_mov_b32 s34, 1892352
    s_mov_b32 s35, 0x00020000
    buffer_load_dwordx4 v[16:19], v7, s[8:11], 0 offen
    buffer_load_dwordx4 v[20:23], v8, s[8:11], 0 offen
    buffer_load_dwordx4 v[24:27], v9, s[8:11], 0 offen
    buffer_load_dwordx4 v[28:31], v5, s[8:11], 0 offen
    buffer_load_dwordx4 v[32:35], v5, s[8:11], 0 offen offset:896
    buffer_load_dwordx4 v[36:39], v5, s[12:15], 0 offen
    buffer_load_dwordx4 v[40:43], v5, s[12:15], 0 offen offset:896
    buffer_load_dwordx4 v[44:47], v11, s[16:19], 0 offen offset:0
    buffer_load_dwordx4 v[48:51], v11, s[16:19], 0 offen offset:16
    buffer_load_dwordx4 v[52:55], v11, s[16:19], 0 offen offset:32
    buffer_load_dwordx4 v[56:59], v11, s[16:19], 0 offen offset:48
    v_mul_u32_u24 v12, 1056, v3
    v_lshl_add_u32 v12, v4, 2, v12
    s_waitcnt vmcnt(0)
    v_lshlrev_b32 v60, 16, v16
    v_lshlrev_b32 v61, 16, v20
    v_lshlrev_b32 v62, 16, v24
    v_lshlrev_b32 v63, 16, v28
    v_lshlrev_b32 v64, 16, v32
    v_lshlrev_b32 v65, 16, v44
    v_and_b32 v66, 0xffff0000, v44
    v_lshlrev_b32 v67, 16, v45
    v_and_b32 v68, 0xffff0000, v45
    v_lshlrev_b32 v69, 16, v36
    v_lshlrev_b32 v70, 16, v40
    v_mul_f32 v71, v60, v68
    v_fmac_f32 v71, v61, v67
    v_fmac_f32 v71, v62, v66
    v_fmac_f32 v71, v63, v65
    v_mul_f32 v72, v61, v68
    v_fmac_f32 v72, v62, v67
    v_fmac_f32 v72, v63, v66
    v_fmac_f32 v72, v64, v65
    v_cvt_pk_bf16_f32 v73, v71, v72
    v_lshlrev_b32 v71, 16, v73
    v_and_b32 v72, 0xffff0000, v73
    v_mul_f32 v71, v71, v69
    v_mul_f32 v72, v72, v70
    v_cvt_pk_bf16_f32 v74, v71, v72
    ds_write_b32 v12, v74 offset:0
    v_and_b32 v60, 0xffff0000, v16
    v_and_b32 v61, 0xffff0000, v20
    v_and_b32 v62, 0xffff0000, v24
    v_and_b32 v63, 0xffff0000, v28
    v_and_b32 v64, 0xffff0000, v32
    v_lshlrev_b32 v65, 16, v46
    v_and_b32 v66, 0xffff0000, v46
    v_lshlrev_b32 v67, 16, v47
    v_and_b32 v68, 0xffff0000, v47
    v_and_b32 v69, 0xffff0000, v36
    v_and_b32 v70, 0xffff0000, v40
    v_mul_f32 v71, v60, v68
    v_fmac_f32 v71, v61, v67
    v_fmac_f32 v71, v62, v66
    v_fmac_f32 v71, v63, v65
    v_mul_f32 v72, v61, v68
    v_fmac_f32 v72, v62, v67
    v_fmac_f32 v72, v63, v66
    v_fmac_f32 v72, v64, v65
    v_cvt_pk_bf16_f32 v73, v71, v72
    v_lshlrev_b32 v71, 16, v73
    v_and_b32 v72, 0xffff0000, v73
    v_mul_f32 v71, v71, v69
    v_mul_f32 v72, v72, v70
    v_cvt_pk_bf16_f32 v75, v71, v72
    ds_write_b32 v12, v75 offset:132
    v_lshlrev_b32 v60, 16, v17
    v_lshlrev_b32 v61, 16, v21
    v_lshlrev_b32 v62, 16, v25
    v_lshlrev_b32 v63, 16, v29
    v_lshlrev_b32 v64, 16, v33
    v_lshlrev_b32 v65, 16, v48
    v_and_b32 v66, 0xffff0000, v48
    v_lshlrev_b32 v67, 16, v49
    v_and_b32 v68, 0xffff0000, v49
    v_lshlrev_b32 v69, 16, v37
    v_lshlrev_b32 v70, 16, v41
    v_mul_f32 v71, v60, v68
    v_fmac_f32 v71, v61, v67
    v_fmac_f32 v71, v62, v66
    v_fmac_f32 v71, v63, v65
    v_mul_f32 v72, v61, v68
    v_fmac_f32 v72, v62, v67
    v_fmac_f32 v72, v63, v66
    v_fmac_f32 v72, v64, v65
    v_cvt_pk_bf16_f32 v73, v71, v72
    v_lshlrev_b32 v71, 16, v73
    v_and_b32 v72, 0xffff0000, v73
    v_mul_f32 v71, v71, v69
    v_mul_f32 v72, v72, v70
    v_cvt_pk_bf16_f32 v76, v71, v72
    ds_write_b32 v12, v76 offset:264
    v_and_b32 v60, 0xffff0000, v17
    v_and_b32 v61, 0xffff0000, v21
    v_and_b32 v62, 0xffff0000, v25
    v_and_b32 v63, 0xffff0000, v29
    v_and_b32 v64, 0xffff0000, v33
    v_lshlrev_b32 v65, 16, v50
    v_and_b32 v66, 0xffff0000, v50
    v_lshlrev_b32 v67, 16, v51
    v_and_b32 v68, 0xffff0000, v51
    v_and_b32 v69, 0xffff0000, v37
    v_and_b32 v70, 0xffff0000, v41
    v_mul_f32 v71, v60, v68
    v_fmac_f32 v71, v61, v67
    v_fmac_f32 v71, v62, v66
    v_fmac_f32 v71, v63, v65
    v_mul_f32 v72, v61, v68
    v_fmac_f32 v72, v62, v67
    v_fmac_f32 v72, v63, v66
    v_fmac_f32 v72, v64, v65
    v_cvt_pk_bf16_f32 v73, v71, v72
    v_lshlrev_b32 v71, 16, v73
    v_and_b32 v72, 0xffff0000, v73
    v_mul_f32 v71, v71, v69
    v_mul_f32 v72, v72, v70
    v_cvt_pk_bf16_f32 v77, v71, v72
    ds_write_b32 v12, v77 offset:396
    v_lshlrev_b32 v60, 16, v18
    v_lshlrev_b32 v61, 16, v22
    v_lshlrev_b32 v62, 16, v26
    v_lshlrev_b32 v63, 16, v30
    v_lshlrev_b32 v64, 16, v34
    v_lshlrev_b32 v65, 16, v52
    v_and_b32 v66, 0xffff0000, v52
    v_lshlrev_b32 v67, 16, v53
    v_and_b32 v68, 0xffff0000, v53
    v_lshlrev_b32 v69, 16, v38
    v_lshlrev_b32 v70, 16, v42
    v_mul_f32 v71, v60, v68
    v_fmac_f32 v71, v61, v67
    v_fmac_f32 v71, v62, v66
    v_fmac_f32 v71, v63, v65
    v_mul_f32 v72, v61, v68
    v_fmac_f32 v72, v62, v67
    v_fmac_f32 v72, v63, v66
    v_fmac_f32 v72, v64, v65
    v_cvt_pk_bf16_f32 v73, v71, v72
    v_lshlrev_b32 v71, 16, v73
    v_and_b32 v72, 0xffff0000, v73
    v_mul_f32 v71, v71, v69
    v_mul_f32 v72, v72, v70
    v_cvt_pk_bf16_f32 v78, v71, v72
    ds_write_b32 v12, v78 offset:528
    v_and_b32 v60, 0xffff0000, v18
    v_and_b32 v61, 0xffff0000, v22
    v_and_b32 v62, 0xffff0000, v26
    v_and_b32 v63, 0xffff0000, v30
    v_and_b32 v64, 0xffff0000, v34
    v_lshlrev_b32 v65, 16, v54
    v_and_b32 v66, 0xffff0000, v54
    v_lshlrev_b32 v67, 16, v55
    v_and_b32 v68, 0xffff0000, v55
    v_and_b32 v69, 0xffff0000, v38
    v_and_b32 v70, 0xffff0000, v42
    v_mul_f32 v71, v60, v68
    v_fmac_f32 v71, v61, v67
    v_fmac_f32 v71, v62, v66
    v_fmac_f32 v71, v63, v65
    v_mul_f32 v72, v61, v68
    v_fmac_f32 v72, v62, v67
    v_fmac_f32 v72, v63, v66
    v_fmac_f32 v72, v64, v65
    v_cvt_pk_bf16_f32 v73, v71, v72
    v_lshlrev_b32 v71, 16, v73
    v_and_b32 v72, 0xffff0000, v73
    v_mul_f32 v71, v71, v69
    v_mul_f32 v72, v72, v70
    v_cvt_pk_bf16_f32 v79, v71, v72
    ds_write_b32 v12, v79 offset:660
    v_lshlrev_b32 v60, 16, v19
    v_lshlrev_b32 v61, 16, v23
    v_lshlrev_b32 v62, 16, v27
    v_lshlrev_b32 v63, 16, v31
    v_lshlrev_b32 v64, 16, v35
    v_lshlrev_b32 v65, 16, v56
    v_and_b32 v66, 0xffff0000, v56
    v_lshlrev_b32 v67, 16, v57
    v_and_b32 v68, 0xffff0000, v57
    v_lshlrev_b32 v69, 16, v39
    v_lshlrev_b32 v70, 16, v43
    v_mul_f32 v71, v60, v68
    v_fmac_f32 v71, v61, v67
    v_fmac_f32 v71, v62, v66
    v_fmac_f32 v71, v63, v65
    v_mul_f32 v72, v61, v68
    v_fmac_f32 v72, v62, v67
    v_fmac_f32 v72, v63, v66
    v_fmac_f32 v72, v64, v65
    v_cvt_pk_bf16_f32 v73, v71, v72
    v_lshlrev_b32 v71, 16, v73
    v_and_b32 v72, 0xffff0000, v73
    v_mul_f32 v71, v71, v69
    v_mul_f32 v72, v72, v70
    v_cvt_pk_bf16_f32 v80, v71, v72
    ds_write_b32 v12, v80 offset:792
    v_and_b32 v60, 0xffff0000, v19
    v_and_b32 v61, 0xffff0000, v23
    v_and_b32 v62, 0xffff0000, v27
    v_and_b32 v63, 0xffff0000, v31
    v_and_b32 v64, 0xffff0000, v35
    v_lshlrev_b32 v65, 16, v58
    v_and_b32 v66, 0xffff0000, v58
    v_lshlrev_b32 v67, 16, v59
    v_and_b32 v68, 0xffff0000, v59
    v_and_b32 v69, 0xffff0000, v39
    v_and_b32 v70, 0xffff0000, v43
    v_mul_f32 v71, v60, v68
    v_fmac_f32 v71, v61, v67
    v_fmac_f32 v71, v62, v66
    v_fmac_f32 v71, v63, v65
    v_mul_f32 v72, v61, v68
    v_fmac_f32 v72, v62, v67
    v_fmac_f32 v72, v63, v66
    v_fmac_f32 v72, v64, v65
    v_cvt_pk_bf16_f32 v73, v71, v72
    v_lshlrev_b32 v71, 16, v73
    v_and_b32 v72, 0xffff0000, v73
    v_mul_f32 v71, v71, v69
    v_mul_f32 v72, v72, v70
    v_cvt_pk_bf16_f32 v81, v71, v72
    ds_write_b32 v12, v81 offset:924
    s_waitcnt lgkmcnt(0)
    s_barrier
    v_mul_u32_u24 v12, 132, v4
    v_lshl_add_u32 v12, v3, 4, v12
    ds_read2_b32 v[16:17], v12 offset0:0 offset1:1
    ds_read2_b32 v[18:19], v12 offset0:2 offset1:3
    v_add_u32 v13, 4224, v12
    ds_read2_b32 v[20:21], v13 offset0:0 offset1:1
    ds_read2_b32 v[22:23], v13 offset0:2 offset1:3
    s_lshl_b32 s22, s21, 6
    v_add_u32 v5, s22, v4
    s_movk_i32 s23, 4224
    v_mul_lo_u32 v5, v5, s23
    v_lshl_add_u32 v5, v3, 4, v5
    s_lshl_b32 s22, s20, 7
    s_add_u32 s22, s22, 32
    s_add_u32 s23, s22, 135168
    s_waitcnt lgkmcnt(0)
    buffer_store_dwordx4 v[16:19], v5, s[32:35], s22 offen sc1
    buffer_store_dwordx4 v[20:23], v5, s[32:35], s23 offen sc1
    s_cmp_lg_u32 s20, 0
    s_cbranch_scc1 prep_kv_done
    v_cmp_gt_u32 vcc, 2, v3
    s_nop 1
    v_cndmask_b32 v6, v10, v5, vcc
    v_mov_b32 v24, 0
    v_mov_b32 v25, 0
    v_mov_b32 v26, 0
    v_mov_b32 v27, 0
    s_mov_b32 s23, 135168
    buffer_store_dwordx4 v[24:27], v6, s[32:35], 0 offen sc1
    buffer_store_dwordx4 v[24:27], v6, s[32:35], s23 offen sc1
prep_kv_done:
    s_endpgm
prep_w1:
    s_load_dwordx4 s[24:27], s[0:1], 56
    s_lshr_b32 s20, s2, 2
    s_and_b32 s21, s2, 3
    v_and_b32 v3, 7, v0
    v_bfe_u32 v4, v0, 3, 4
    s_mul_i32 s22, s21, 112
    v_add_u32 v5, s22, v4
    s_movk_i32 s23, 3584
    v_mul_lo_u32 v5, v5, s23
    s_lshl_b32 s22, s20, 7
    v_lshl_add_u32 v6, v3, 4, s22
    v_add_u32 v5, v5, v6
    s_lshr_b32 s30, s3, 1
    s_mul_i32 s22, s30, 18048
    v_mul_u32_u24 v6, 160, v4
    v_lshl_add_u32 v6, v3, 4, v6
    v_add_u32 v6, s22, v6
    s_waitcnt lgkmcnt(0)
    s_cmp_eq_u32 s30, 0
    s_cselect_b32 s28, s24, s26
    s_cselect_b32 s29, s25, s27
    s_mov_b32 s8, s28
    s_mov_b32 s9, s29
    s_mov_b32 s10, 1605632
    s_mov_b32 s11, 0x00020000
    s_add_u32 s12, s4, 25165824
    s_addc_u32 s13, s5, 0
    s_mov_b32 s14, 3325952
    s_mov_b32 s15, 0x00020000
    s_mov_b32 s22, 0
    buffer_load_dwordx4 v[16:19], v5, s[8:11], s22 offen
    s_mov_b32 s22, 57344
    buffer_load_dwordx4 v[20:23], v5, s[8:11], s22 offen
    s_mov_b32 s22, 114688
    buffer_load_dwordx4 v[24:27], v5, s[8:11], s22 offen
    s_mov_b32 s22, 172032
    buffer_load_dwordx4 v[28:31], v5, s[8:11], s22 offen
    s_mov_b32 s22, 229376
    buffer_load_dwordx4 v[32:35], v5, s[8:11], s22 offen
    s_mov_b32 s22, 286720
    buffer_load_dwordx4 v[36:39], v5, s[8:11], s22 offen
    s_mov_b32 s22, 344064
    buffer_load_dwordx4 v[40:43], v5, s[8:11], s22 offen
    v_lshrrev_b32 v7, 4, v2
    v_bfe_u32 v8, v2, 2, 2
    v_and_b32 v9, 3, v2
    v_lshrrev_b32 v10, 1, v9
    v_mul_u32_u24 v10, 18048, v10
    v_lshrrev_b32 v11, 1, v7
    v_lshl_add_u32 v11, v11, 3, v8
    v_mul_u32_u24 v11, 160, v11
    v_add_u32 v10, v10, v11
    v_and_b32 v11, 1, v7
    v_lshl_add_u32 v10, v11, 4, v10
    v_and_b32 v11, 1, v9
    v_lshl_add_u32 v10, v11, 3, v10
    s_lshl_b32 s22, s3, 5
    v_add_u32 v10, s22, v10
    s_lshl_b32 s22, s20, 2
    s_add_u32 s22, s22, s3
    s_mul_i32 s23, s22, 9363
    s_lshr_b32 s23, s23, 16
    s_mul_i32 s31, s23, 7
    s_sub_u32 s22, s22, s31
    s_mul_i32 s23, s23, 203
    s_mul_i32 s35, s21, 21
    s_add_u32 s35, s35, s22
    s_add_u32 s36, s22, 91
    s_movk_i32 s37, 3072
    s_cmp_lt_u32 s22, 3
    s_cbranch_scc1 prep_w1_pos
    s_cmp_gt_u32 s22, 3
    s_cbranch_scc1 prep_w1_hi
    s_movk_i32 s37, 1024
    s_mul_i32 s35, s21, 7
    s_add_u32 s35, s35, 87
    s_movk_i32 s36, 115
    s_cmp_eq_u32 s35, 87
    s_cselect_b32 s35, 84, s35
    s_branch prep_w1_pos
prep_w1_hi:
    s_add_u32 s35, s35, 112
    s_lshl_b32 s38, s22, 3
    s_add_u32 s36, s38, 154
    s_cmp_lt_u32 s21, 3
    s_cbranch_scc1 prep_w1_pos
    s_movk_i32 s37, 1024
    s_add_u32 s35, s38, 147
prep_w1_pos:
    s_add_u32 s35, s35, s23
    s_lshl_b32 s32, s35, 10
    s_add_u32 s36, s36, s23
    s_lshl_b32 s33, s36, 10
    v_lshlrev_b32 v11, 4, v2
    s_waitcnt vmcnt(6)
    ds_write_b128 v6, v[16:19] offset:0
    s_waitcnt vmcnt(5)
    ds_write_b128 v6, v[20:23] offset:2560
    s_waitcnt vmcnt(4)
    ds_write_b128 v6, v[24:27] offset:5120
    s_waitcnt vmcnt(3)
    ds_write_b128 v6, v[28:31] offset:7680
    s_waitcnt vmcnt(2)
    ds_write_b128 v6, v[32:35] offset:10240
    s_waitcnt vmcnt(1)
    ds_write_b128 v6, v[36:39] offset:12800
    s_waitcnt vmcnt(0)
    ds_write_b128 v6, v[40:43] offset:15360
    s_waitcnt lgkmcnt(0)
    s_barrier
    ds_read_b64_tr_b16 v[16:17], v10 offset:0
    ds_read_b64_tr_b16 v[18:19], v10 offset:640
    ds_read_b64_tr_b16 v[20:21], v10 offset:2560
    ds_read_b64_tr_b16 v[22:23], v10 offset:3200
    ds_read_b64_tr_b16 v[24:25], v10 offset:5120
    ds_read_b64_tr_b16 v[26:27], v10 offset:5760
    ds_read_b64_tr_b16 v[28:29], v10 offset:7680
    ds_read_b64_tr_b16 v[30:31], v10 offset:8320
    ds_read_b64_tr_b16 v[32:33], v10 offset:10240
    ds_read_b64_tr_b16 v[34:35], v10 offset:10880
    ds_read_b64_tr_b16 v[36:37], v10 offset:12800
    ds_read_b64_tr_b16 v[38:39], v10 offset:13440
    ds_read_b64_tr_b16 v[40:41], v10 offset:15360
    ds_read_b64_tr_b16 v[42:43], v10 offset:16000
    v_mov_b32 v12, 0
    s_mov_b32 s34, 0x3f803f80
    s_waitcnt lgkmcnt(12)
    buffer_store_dwordx4 v[16:19], v11, s[12:15], s32 offen sc1
    s_add_u32 s32, s32, s37
    v_dot2_f32_bf16 v12, v16, s34, v12
    v_dot2_f32_bf16 v12, v17, s34, v12
    v_dot2_f32_bf16 v12, v18, s34, v12
    v_dot2_f32_bf16 v12, v19, s34, v12
    s_waitcnt lgkmcnt(10)
    buffer_store_dwordx4 v[20:23], v11, s[12:15], s32 offen sc1
    s_add_u32 s32, s32, s37
    v_dot2_f32_bf16 v12, v20, s34, v12
    v_dot2_f32_bf16 v12, v21, s34, v12
    v_dot2_f32_bf16 v12, v22, s34, v12
    v_dot2_f32_bf16 v12, v23, s34, v12
    s_waitcnt lgkmcnt(8)
    buffer_store_dwordx4 v[24:27], v11, s[12:15], s32 offen sc1
    s_add_u32 s32, s32, s37
    v_dot2_f32_bf16 v12, v24, s34, v12
    v_dot2_f32_bf16 v12, v25, s34, v12
    v_dot2_f32_bf16 v12, v26, s34, v12
    v_dot2_f32_bf16 v12, v27, s34, v12
    s_waitcnt lgkmcnt(6)
    buffer_store_dwordx4 v[28:31], v11, s[12:15], s32 offen sc1
    s_add_u32 s32, s32, s37
    v_dot2_f32_bf16 v12, v28, s34, v12
    v_dot2_f32_bf16 v12, v29, s34, v12
    v_dot2_f32_bf16 v12, v30, s34, v12
    v_dot2_f32_bf16 v12, v31, s34, v12
    s_waitcnt lgkmcnt(4)
    buffer_store_dwordx4 v[32:35], v11, s[12:15], s32 offen sc1
    s_add_u32 s32, s32, s37
    v_dot2_f32_bf16 v12, v32, s34, v12
    v_dot2_f32_bf16 v12, v33, s34, v12
    v_dot2_f32_bf16 v12, v34, s34, v12
    v_dot2_f32_bf16 v12, v35, s34, v12
    s_waitcnt lgkmcnt(2)
    buffer_store_dwordx4 v[36:39], v11, s[12:15], s32 offen sc1
    s_add_u32 s32, s32, s37
    v_dot2_f32_bf16 v12, v36, s34, v12
    v_dot2_f32_bf16 v12, v37, s34, v12
    v_dot2_f32_bf16 v12, v38, s34, v12
    v_dot2_f32_bf16 v12, v39, s34, v12
    s_waitcnt lgkmcnt(0)
    buffer_store_dwordx4 v[40:43], v11, s[12:15], s32 offen sc1
    s_add_u32 s32, s32, s37
    v_dot2_f32_bf16 v12, v40, s34, v12
    v_dot2_f32_bf16 v12, v41, s34, v12
    v_dot2_f32_bf16 v12, v42, s34, v12
    v_dot2_f32_bf16 v12, v43, s34, v12
    s_nop 2
    v_mov_b32 v13, v12
    s_nop 1
    v_permlane32_swap_b32 v12, v13
    v_add_f32 v12, v12, v13
    v_cvt_pk_bf16_f32 v13, v12, v12
    v_lshlrev_b32 v13, 16, v13
    v_sub_f32 v12, v12, v13
    v_cvt_pk_bf16_f32 v14, v12, v12
    v_lshlrev_b32 v14, 16, v14
    v_sub_f32 v12, v12, v14
    v_cvt_pk_bf16_f32 v44, v13, v14
    v_cvt_pk_bf16_f32 v45, v12, 0
    s_lshr_b32 s22, s21, 1
    s_lshl_b32 s22, s22, 9
    s_and_b32 s23, s21, 1
    s_lshl_b32 s23, s23, 3
    s_add_u32 s22, s22, s23
    s_add_u32 s22, s22, s33
    v_cmp_gt_u32 vcc, 32, v2
    v_mov_b32 v15, 2147483648
    s_nop 0
    v_cndmask_b32 v11, v15, v11, vcc
    buffer_store_dwordx2 v[44:45], v11, s[12:15], s22 offen sc1
    s_endpgm
prep_w2:
    s_load_dwordx2 s[24:25], s[0:1], 72
    s_sub_u32 s2, s2, 112
    s_mul_i32 s20, s2, 4682
    s_lshr_b32 s20, s20, 16
    s_mul_i32 s21, s20, 14
    s_sub_u32 s21, s2, s21
    s_and_b32 s23, s21, 1
    s_lshr_b32 s21, s21, 1
    s_mul_i32 s20, s20, 448
    s_mul_i32 s23, s23, 224
    s_add_u32 s20, s20, s23
    s_lshl_b32 s21, s21, 4
    s_add_u32 s20, s20, s21
    s_mul_i32 s20, s20, 896
    v_lshlrev_b32 v5, 4, v0
    v_add_u32 v6, 86016, v5
    v_cmp_gt_u32 vcc, 128, v0
    s_nop 1
    v_cndmask_b32 v7, v6, v5, vcc
    s_waitcnt lgkmcnt(0)
    s_mov_b32 s8, s24
    s_mov_b32 s9, s25
    s_mov_b32 s10, 1605632
    s_mov_b32 s11, 0x00020000
    s_add_u32 s12, s4, 29360128
    s_addc_u32 s13, s5, 0
    s_mov_b32 s14, 1605632
    s_mov_b32 s15, 0x00020000
    buffer_load_dwordx4 v[16:19], v5, s[8:11], s20 offen
    s_add_u32 s20, s20, 4096
    buffer_load_dwordx4 v[20:23], v5, s[8:11], s20 offen
    s_add_u32 s20, s20, 4096
    buffer_load_dwordx4 v[24:27], v5, s[8:11], s20 offen
    s_add_u32 s20, s20, 4096
    buffer_load_dwordx4 v[28:31], v7, s[8:11], s20 offen
    s_add_u32 s20, s20, 4096
    buffer_load_dwordx4 v[32:35], v6, s[8:11], s20 offen
    s_add_u32 s20, s20, 4096
    buffer_load_dwordx4 v[36:39], v6, s[8:11], s20 offen
    s_add_u32 s20, s20, 4096
    buffer_load_dwordx4 v[40:43], v6, s[8:11], s20 offen
    s_add_u32 s20, s20, 4096
    v_add_u32 v6, 0, v0
    v_mul_u32_u24 v7, 9363, v6
    v_lshrrev_b32 v7, 19, v7
    v_lshlrev_b32 v7, 5, v7
    v_lshl_add_u32 v48, v6, 4, v7
    v_add_u32 v6, 256, v0
    v_mul_u32_u24 v7, 9363, v6
    v_lshrrev_b32 v7, 19, v7
    v_lshlrev_b32 v7, 5, v7
    v_lshl_add_u32 v49, v6, 4, v7
    v_add_u32 v6, 512, v0
    v_mul_u32_u24 v7, 9363, v6
    v_lshrrev_b32 v7, 19, v7
    v_lshlrev_b32 v7, 5, v7
    v_lshl_add_u32 v50, v6, 4, v7
    v_add_u32 v6, 768, v0
    v_mul_u32_u24 v7, 9363, v6
    v_lshrrev_b32 v7, 19, v7
    v_lshlrev_b32 v7, 5, v7
    v_lshl_add_u32 v51, v6, 4, v7
    v_add_u32 v6, 1024, v0
    v_mul_u32_u24 v7, 9363, v6
    v_lshrrev_b32 v7, 19, v7
    v_lshlrev_b32 v7, 5, v7
    v_lshl_add_u32 v52, v6, 4, v7
    v_add_u32 v6, 1280, v0
    v_mul_u32_u24 v7, 9363, v6
    v_lshrrev_b32 v7, 19, v7
    v_lshlrev_b32 v7, 5, v7
    v_lshl_add_u32 v53, v6, 4, v7
    v_add_u32 v6, 1536, v0
    v_mul_u32_u24 v7, 9363, v6
    v_lshrrev_b32 v7, 19, v7
    v_lshlrev_b32 v7, 5, v7
    v_lshl_add_u32 v54, v6, 4, v7
    v_lshrrev_b32 v7, 4, v2
    v_bfe_u32 v8, v2, 2, 2
    v_and_b32 v9, 3, v2
    v_lshrrev_b32 v10, 1, v7
    v_lshl_add_u32 v10, v10, 4, v8
    v_and_b32 v11, 1, v7
    v_lshl_add_u32 v10, v11, 2, v10
    v_mul_u32_u24 v10, 928, v10
    v_lshl_add_u32 v10, v9, 3, v10
    s_mul_i32 s22, s3, 224
    v_add_u32 v10, s22, v10
    s_mul_i32 s22, s3, 56
    s_add_u32 s22, s22, s2
    s_mul_i32 s22, s22, 7168
    v_lshlrev_b32 v11, 4, v2
    s_waitcnt vmcnt(6)
    ds_write_b128 v48, v[16:19]
    s_waitcnt vmcnt(5)
    ds_write_b128 v49, v[20:23]
    s_waitcnt vmcnt(4)
    ds_write_b128 v50, v[24:27]
    s_waitcnt vmcnt(3)
    ds_write_b128 v51, v[28:31]
    s_waitcnt vmcnt(2)
    ds_write_b128 v52, v[32:35]
    s_waitcnt vmcnt(1)
    ds_write_b128 v53, v[36:39]
    s_waitcnt vmcnt(0)
    ds_write_b128 v54, v[40:43]
    s_waitcnt lgkmcnt(0)
    s_barrier
    ds_read_b64_tr_b16 v[16:17], v10 offset:0
    ds_read_b64_tr_b16 v[18:19], v10 offset:7424
    ds_read_b64_tr_b16 v[20:21], v10 offset:32
    ds_read_b64_tr_b16 v[22:23], v10 offset:7456
    ds_read_b64_tr_b16 v[24:25], v10 offset:64
    ds_read_b64_tr_b16 v[26:27], v10 offset:7488
    ds_read_b64_tr_b16 v[28:29], v10 offset:96
    ds_read_b64_tr_b16 v[30:31], v10 offset:7520
    ds_read_b64_tr_b16 v[32:33], v10 offset:128
    ds_read_b64_tr_b16 v[34:35], v10 offset:7552
    ds_read_b64_tr_b16 v[36:37], v10 offset:160
    ds_read_b64_tr_b16 v[38:39], v10 offset:7584
    ds_read_b64_tr_b16 v[40:41], v10 offset:192
    ds_read_b64_tr_b16 v[42:43], v10 offset:7616
    s_waitcnt lgkmcnt(12)
    buffer_store_dwordx4 v[16:19], v11, s[12:15], s22 offen offset:0 sc1
    s_waitcnt lgkmcnt(10)
    buffer_store_dwordx4 v[20:23], v11, s[12:15], s22 offen offset:1024 sc1
    s_waitcnt lgkmcnt(8)
    buffer_store_dwordx4 v[24:27], v11, s[12:15], s22 offen offset:2048 sc1
    s_waitcnt lgkmcnt(6)
    buffer_store_dwordx4 v[28:31], v11, s[12:15], s22 offen offset:3072 sc1
    s_waitcnt lgkmcnt(4)
    s_add_u32 s22, s22, 4096
    buffer_store_dwordx4 v[32:35], v11, s[12:15], s22 offen offset:0 sc1
    s_waitcnt lgkmcnt(2)
    buffer_store_dwordx4 v[36:39], v11, s[12:15], s22 offen offset:1024 sc1
    s_waitcnt lgkmcnt(0)
    buffer_store_dwordx4 v[40:43], v11, s[12:15], s22 offen offset:2048 sc1
    s_endpgm
.globl ffn_kernel
.p2align 8
.type ffn_kernel,@function
ffn_kernel:
    s_cmp_lt_u32 s2, 256
    s_cbranch_scc1 ffn_kernel_go
ffn_kernel_exit:
    s_endpgm
ffn_kernel_go:
    s_load_dwordx2 s[4:5], s[0:1], 96
    s_load_dwordx2 s[6:7], s[0:1], 80
    s_load_dwordx2 s[44:45], s[0:1], 0
    s_load_dwordx4 s[56:59], s[0:1], 32
    v_lshrrev_b32 v1, 6, v0
    s_nop 0
    v_readfirstlane_b32 s3, v1
    v_and_b32 v2, 63, v0
    v_lshlrev_b32 v3, 4, v2
    s_and_b32 s16, s2, 7
    s_lshr_b32 s17, s2, 3
    s_and_b32 s18, s17, 15
    s_lshr_b32 s19, s17, 4
    s_lshl_b32 s20, s16, 1
    s_add_u32 s20, s20, s19
    s_getreg_b32 s41, hwreg(HW_REG_XCC_ID, 0, 4)
    s_add_u32 s41, s41, 1
    s_lshl_b32 s40, s20, 12
    s_add_u32 s40, s40, 32505856
    s_lshl_b32 s42, s18, 8
    s_add_u32 s42, s42, s40
    v_mov_b32 v14, s41
    v_mov_b32 v13, 0
    s_lshl_b32 s21, s16, 3
    s_lshr_b32 s19, s17, 2
    s_add_u32 s21, s21, s19
    s_and_b32 s22, s17, 3
    s_mul_i32 s37, s21, 28
    s_mul_i32 s26, s22, 7
    s_add_u32 s37, s37, s26
    s_lshl_b32 s37, s37, 10
    s_lshl_b32 s28, s3, 10
    s_mul_i32 s24, s18, 207872
    s_add_u32 s24, s24, 25165824
    s_add_u32 s24, s24, s28
    s_mul_i32 s25, s22, 56
    s_mul_i32 s26, s3, 14
    s_add_u32 s25, s25, s26
    s_mul_i32 s25, s25, 7168
    s_add_u32 s25, s25, 29360128
    s_mov_b32 s10, 50331648
    s_mov_b32 s11, 0x00020000
    s_mov_b32 s46, 1835008
    s_mov_b32 s47, 0x00020000
    s_waitcnt lgkmcnt(0)
    s_mov_b32 s8, s4
    s_mov_b32 s9, s5
    s_cmp_lg_u32 s3, 0
    s_cbranch_scc1 ffn_kernel_noxc
    s_mov_b64 exec, 1
    buffer_store_dword v14, v13, s[8:11], s42 offen sc1
    s_mov_b64 exec, -1
ffn_kernel_noxc:
    s_cmp_ge_u32 s2, 224
    s_cbranch_scc1 cv_idle
    s_lshl_b32 s60, s2, 1
    v_lshlrev_b32 v4, 4, v0
    s_mul_i32 s61, s60, 4224
    s_add_u32 s61, s61, 0
    s_add_u32 s62, s61, 4224
    buffer_load_dwordx4 v[24:27], v4, s[8:11], s61 offen offset:0
    buffer_load_dwordx4 v[28:31], v4, s[8:11], s61 offen offset:4
    buffer_load_dwordx4 v[32:35], v4, s[8:11], s61 offen offset:8
    buffer_load_dwordx4 v[36:39], v4, s[8:11], s62 offen offset:0
    buffer_load_dwordx4 v[40:43], v4, s[8:11], s62 offen offset:4
    buffer_load_dwordx4 v[44:47], v4, s[8:11], s62 offen offset:8
    v_mov_b32 v6, 2147483648
    v_mov_b32 v10, 42496
    v_lshrrev_b32 v8, 1, v0
    v_mul_u32_u24 v7, 16640, v8
    v_mul_u32_u24 v8, 4224, v8
    v_and_b32 v5, 1, v0
    v_lshl_add_u32 v8, v5, 4, v8
    v_add_u32 v8, 4096, v8
    v_lshl_add_u32 v7, v5, 4, v7
    v_add_u32 v7, 4096, v7
    v_cmp_gt_u32 vcc, 4, v0
    s_nop 1
    v_cndmask_b32 v8, v6, v8, vcc
    v_cndmask_b32 v7, v10, v7, vcc
    buffer_load_dwordx4 v[64:67], v8, s[8:11], s61 offen offset:0
    buffer_load_dwordx4 v[68:71], v8, s[8:11], s61 offen offset:4
    buffer_load_dwordx4 v[72:75], v8, s[8:11], s61 offen offset:8
    s_lshl_b32 s63, s60, 12
    s_add_u32 s64, s63, 4096
    s_lshl_b32 s50, s2, 2
    s_load_dword s65, s[58:59], s50
    s_mov_b32 s52, s56
    s_mov_b32 s53, s57
    s_mov_b32 s54, 1835008
    s_mov_b32 s55, 0x00020000
    buffer_load_dwordx4 v[100:103], v4, s[52:55], s63 offen
    buffer_load_dwordx4 v[104:107], v4, s[52:55], s64 offen
    s_add_u32 m0, s28, 57344
    s_add_u32 s27, s24, 57344
    buffer_load_dwordx4 v3, s[8:11], s27 offen lds
    s_add_u32 s29, s25, 0
    buffer_load_dwordx4 a[0:3], v3, s[8:11], s29 offen
    s_add_u32 s29, s25, 1024
    buffer_load_dwordx4 a[4:7], v3, s[8:11], s29 offen
    s_add_u32 m0, s28, 61440
    s_add_u32 s27, s24, 61440
    buffer_load_dwordx4 v3, s[8:11], s27 offen lds
    s_add_u32 s29, s25, 2048
    buffer_load_dwordx4 a[8:11], v3, s[8:11], s29 offen
    s_add_u32 m0, s28, 65536
    s_add_u32 s27, s24, 65536
    buffer_load_dwordx4 v3, s[8:11], s27 offen lds
    s_add_u32 s29, s25, 3072
    buffer_load_dwordx4 a[12:15], v3, s[8:11], s29 offen
    s_add_u32 m0, s28, 69632
    s_add_u32 s27, s24, 69632
    buffer_load_dwordx4 v3, s[8:11], s27 offen lds
    v_mov_b32 v108, 0
    v_mov_b32 v109, 0
    v_mov_b32 v110, 0
    v_mov_b32 v111, 0
    v_cmp_lt_u32 vcc, 29, v0
    v_mov_b32 v9, 37376
    v_mov_b32 v11, 41504
    v_cndmask_b32 v9, v9, v11, vcc
    v_add_u32 v9, v9, v4
    v_cmp_gt_u32 vcc, 60, v0
    s_nop 1
    v_cndmask_b32 v9, v10, v9, vcc
    ds_write_b128 v9, v[108:111]
    s_and_b32 s67, s3, 1
    v_and_b32 v10, 15, v2
    v_lshrrev_b32 v11, 4, v2
    v_add_u32 v12, 1, v10
    v_and_b32 v13, 3, v12
    v_mul_u32_u24 v13, 4160, v13
    v_lshl_add_u32 v12, v11, 3, v12
    v_and_b32 v12, 0x7c, v12
    v_lshl_add_u32 v13, v12, 1, v13
    s_mul_i32 s50, s67, 16640
    v_add_u32 v18, s50, v13
    v_lshlrev_b32 v12, 4, v11
    v_lshlrev_b32 v13, 5, v10
    v_sub_u32 v12, v12, v13
    s_mul_i32 s51, s67, 4608
    s_add_u32 s51, s51, 33760
    v_add_u32 v19, s51, v12
    v_lshlrev_b32 v12, 3, v11
    v_lshl_add_u32 v12, v10, 5, v12
    s_add_u32 s50, s50, 32
    v_add_u32 v20, s50, v12
    s_add_u32 s48, s60, s67
    s_mul_i32 s48, s48, 4352
    s_add_u32 s48, s48, 10485760
    v_lshrrev_b32 v21, 1, v11
    v_lshlrev_b32 v21, 4, v21
    v_lshl_add_u32 v21, v10, 5, v21
    v_and_b32 v13, 1, v11
    v_xor_b32 v13, 1, v13
    v_lshl_add_u32 v21, v13, 9, v21
    v_sub_u32 v14, 37360, v4
    s_waitcnt vmcnt(16)
    v_alignbyte_b32 v76, v28, v24, 2
    v_alignbyte_b32 v80, v32, v28, 2
    v_alignbyte_b32 v77, v29, v25, 2
    v_alignbyte_b32 v81, v33, v29, 2
    v_alignbyte_b32 v78, v30, v26, 2
    v_alignbyte_b32 v82, v34, v30, 2
    v_alignbyte_b32 v79, v31, v27, 2
    v_alignbyte_b32 v83, v35, v31, 2
    ds_write_b128 v4, v[24:27] offset:0
    ds_write_b128 v4, v[76:79] offset:4160
    ds_write_b128 v4, v[28:31] offset:8320
    ds_write_b128 v4, v[80:83] offset:12480
    s_waitcnt vmcnt(13)
    v_alignbyte_b32 v84, v40, v36, 2
    v_alignbyte_b32 v88, v44, v40, 2
    v_alignbyte_b32 v85, v41, v37, 2
    v_alignbyte_b32 v89, v45, v41, 2
    v_alignbyte_b32 v86, v42, v38, 2
    v_alignbyte_b32 v90, v46, v42, 2
    v_alignbyte_b32 v87, v43, v39, 2
    v_alignbyte_b32 v91, v47, v43, 2
    ds_write_b128 v4, v[36:39] offset:16640
    ds_write_b128 v4, v[84:87] offset:20800
    ds_write_b128 v4, v[40:43] offset:24960
    ds_write_b128 v4, v[88:91] offset:29120
    s_waitcnt vmcnt(10)
    v_alignbyte_b32 v92, v68, v64, 2
    v_alignbyte_b32 v96, v72, v68, 2
    v_alignbyte_b32 v93, v69, v65, 2
    v_alignbyte_b32 v97, v73, v69, 2
    v_alignbyte_b32 v94, v70, v66, 2
    v_alignbyte_b32 v98, v74, v70, 2
    v_alignbyte_b32 v95, v71, v67, 2
    v_alignbyte_b32 v99, v75, v71, 2
    ds_write_b128 v7, v[64:67] offset:0
    ds_write_b128 v7, v[92:95] offset:4160
    ds_write_b128 v7, v[68:71] offset:8320
    ds_write_b128 v7, v[96:99] offset:12480
    s_waitcnt vmcnt(9)
    v_alignbit_b32 v120, v103, v103, 16
    v_alignbit_b32 v121, v102, v102, 16
    v_alignbit_b32 v122, v101, v101, 16
    v_alignbit_b32 v123, v100, v100, 16
    ds_write_b128 v14, v[120:123] offset:0
    s_waitcnt vmcnt(8)
    v_alignbit_b32 v124, v107, v107, 16
    v_alignbit_b32 v125, v106, v106, 16
    v_alignbit_b32 v126, v105, v105, 16
    v_alignbit_b32 v127, v104, v104, 16
    ds_write_b128 v14, v[124:127] offset:4608
    s_waitcnt lgkmcnt(0)
    s_lshl_b32 s66, s65, 16
    s_and_b32 s65, s65, 0xffff0000
    s_cmp_eq_u32 s67, 0
    s_cselect_b32 s66, s66, s65
    s_barrier
    s_cmp_ge_u32 s3, 2
    s_cbranch_scc1 cv_set1
    ds_read_b64 v[96:97], v18 offset:0
    ds_read_b64 v[98:99], v18 offset:8
    ds_read_b128 v[128:131], v19 offset:0
    ds_read_b128 v[132:135], v19 offset:512
    ds_read_b128 v[136:139], v19 offset:3072
    ds_read_b128 v[140:143], v19 offset:3584
    ds_read_b64 v[100:101], v18 offset:64
    ds_read_b64 v[102:103], v18 offset:72
    ds_read_b128 v[144:147], v19 offset:64
    ds_read_b128 v[148:151], v19 offset:576
    ds_read_b128 v[152:155], v19 offset:3136
    ds_read_b128 v[156:159], v19 offset:3648
    ds_read_b64 v[104:105], v18 offset:128
    ds_read_b64 v[106:107], v18 offset:136
    ds_read_b128 v[160:163], v19 offset:128
    ds_read_b128 v[164:167], v19 offset:640
    ds_read_b128 v[168:171], v19 offset:3200
    ds_read_b128 v[172:175], v19 offset:3712
    ds_read_b64 v[108:109], v18 offset:192
    ds_read_b64 v[110:111], v18 offset:200
    ds_read_b128 v[176:179], v19 offset:192
    ds_read_b128 v[180:183], v19 offset:704
    ds_read_b128 v[184:187], v19 offset:3264
    ds_read_b128 v[188:191], v19 offset:3776
    s_waitcnt lgkmcnt(15)
    v_mfma_f32_16x16x32_bf16 v[48:51], v[96:99], v[128:131], 0
    s_add_u32 s29, s25, 4096
    buffer_load_dwordx4 a[16:19], v3, s[8:11], s29 offen
    v_mfma_f32_16x16x32_bf16 v[52:55], v[96:99], v[132:135], 0
    v_mfma_f32_16x16x32_bf16 v[56:59], v[96:99], v[136:139], 0
    s_add_u32 m0, s28, 73728
    s_add_u32 s27, s24, 73728
    buffer_load_dwordx4 v3, s[8:11], s27 offen lds
    v_mfma_f32_16x16x32_bf16 v[60:63], v[96:99], v[140:143], 0
    ds_read_b64 v[112:113], v18 offset:256
    ds_read_b64 v[114:115], v18 offset:264
    ds_read_b128 v[192:195], v19 offset:256
    ds_read_b128 v[196:199], v19 offset:768
    ds_read_b128 v[200:203], v19 offset:3328
    ds_read_b128 v[204:207], v19 offset:3840
    v_mfma_f32_16x16x32_bf16 v[48:51], v[100:103], v[144:147], v[48:51]
    s_waitcnt lgkmcnt(15)
    v_mfma_f32_16x16x32_bf16 v[52:55], v[100:103], v[148:151], v[52:55]
    s_add_u32 s29, s25, 5120
    buffer_load_dwordx4 a[20:23], v3, s[8:11], s29 offen
    v_mfma_f32_16x16x32_bf16 v[56:59], v[100:103], v[152:155], v[56:59]
    v_mfma_f32_16x16x32_bf16 v[60:63], v[100:103], v[156:159], v[60:63]
    ds_read_b64 v[116:117], v18 offset:320
    ds_read_b64 v[118:119], v18 offset:328
    ds_read_b128 v[208:211], v19 offset:320
    ds_read_b128 v[212:215], v19 offset:832
    ds_read_b128 v[216:219], v19 offset:3392
    ds_read_b128 v[220:223], v19 offset:3904
    v_mfma_f32_16x16x32_bf16 v[48:51], v[104:107], v[160:163], v[48:51]
    s_add_u32 m0, s28, 77824
    s_add_u32 s27, s24, 77824
    buffer_load_dwordx4 v3, s[8:11], s27 offen lds
    s_waitcnt lgkmcnt(15)
    v_mfma_f32_16x16x32_bf16 v[52:55], v[104:107], v[164:167], v[52:55]
    v_mfma_f32_16x16x32_bf16 v[56:59], v[104:107], v[168:171], v[56:59]
    v_mfma_f32_16x16x32_bf16 v[60:63], v[104:107], v[172:175], v[60:63]
    s_add_u32 s29, s25, 6144
    buffer_load_dwordx4 a[24:27], v3, s[8:11], s29 offen
    ds_read_b64 v[96:97], v18 offset:384
    ds_read_b64 v[98:99], v18 offset:392
    ds_read_b128 v[224:227], v19 offset:384
    ds_read_b128 v[228:231], v19 offset:896
    ds_read_b128 v[232:235], v19 offset:3456
    ds_read_b128 v[236:239], v19 offset:3968
    v_mfma_f32_16x16x32_bf16 v[48:51], v[108:111], v[176:179], v[48:51]
    s_waitcnt lgkmcnt(15)
    v_mfma_f32_16x16x32_bf16 v[52:55], v[108:111], v[180:183], v[52:55]
    v_mfma_f32_16x16x32_bf16 v[56:59], v[108:111], v[184:187], v[56:59]
    s_add_u32 s29, s25, 7168
    buffer_load_dwordx4 a[28:31], v3, s[8:11], s29 offen
    v_mfma_f32_16x16x32_bf16 v[60:63], v[108:111], v[188:191], v[60:63]
    ds_read_b64 v[100:101], v18 offset:448
    ds_read_b64 v[102:103], v18 offset:456
    ds_read_b128 v[240:243], v19 offset:448
    ds_read_b128 v[244:247], v19 offset:960
    ds_read_b128 v[248:251], v19 offset:3520
    ds_read_b128 v[252:255], v19 offset:4032
    v_mfma_f32_16x16x32_bf16 v[48:51], v[112:115], v[192:195], v[48:51]
    s_waitcnt lgkmcnt(15)
    v_mfma_f32_16x16x32_bf16 v[52:55], v[112:115], v[196:199], v[52:55]
    s_add_u32 m0, s28, 81920
    s_add_u32 s27, s24, 81920
    buffer_load_dwordx4 v3, s[8:11], s27 offen lds
    v_mfma_f32_16x16x32_bf16 v[56:59], v[112:115], v[200:203], v[56:59]
    v_mfma_f32_16x16x32_bf16 v[60:63], v[112:115], v[204:207], v[60:63]
    ds_read_b64 v[104:105], v18 offset:512
    ds_read_b64 v[106:107], v18 offset:520
    ds_read_b128 v[128:131], v19 offset:1024
    v_mfma_f32_16x16x32_bf16 v[48:51], v[116:119], v[208:211], v[48:51]
    s_add_u32 s29, s25, 8192
    buffer_load_dwordx4 a[32:35], v3, s[8:11], s29 offen
    s_waitcnt lgkmcnt(15)
    v_mfma_f32_16x16x32_bf16 v[52:55], v[116:119], v[212:215], v[52:55]
    v_mfma_f32_16x16x32_bf16 v[56:59], v[116:119], v[216:219], v[56:59]
    v_mfma_f32_16x16x32_bf16 v[60:63], v[116:119], v[220:223], v[60:63]
    s_add_u32 m0, s28, 86016
    s_add_u32 s27, s24, 86016
    buffer_load_dwordx4 v3, s[8:11], s27 offen lds
    ds_read_b64 v[108:109], v18 offset:576
    ds_read_b64 v[110:111], v18 offset:584
    ds_read_b128 v[144:147], v19 offset:1088
    s_waitcnt lgkmcnt(15)
    v_mfma_f32_16x16x32_bf16 v[48:51], v[96:99], v[224:227], v[48:51]
    s_waitcnt lgkmcnt(14)
    v_mfma_f32_16x16x32_bf16 v[52:55], v[96:99], v[228:231], v[52:55]
    s_waitcnt lgkmcnt(13)
    v_mfma_f32_16x16x32_bf16 v[56:59], v[96:99], v[232:235], v[56:59]
    s_add_u32 s29, s25, 9216
    buffer_load_dwordx4 a[36:39], v3, s[8:11], s29 offen
    s_waitcnt lgkmcnt(12)
    v_mfma_f32_16x16x32_bf16 v[60:63], v[96:99], v[236:239], v[60:63]
    ds_read_b64 v[112:113], v18 offset:640
    ds_read_b64 v[114:115], v18 offset:648
    ds_read_b128 v[160:163], v19 offset:1152
    s_waitcnt lgkmcnt(12)
    v_mfma_f32_16x16x32_bf16 v[48:51], v[100:103], v[240:243], v[48:51]
    s_waitcnt lgkmcnt(11)
    v_mfma_f32_16x16x32_bf16 v[52:55], v[100:103], v[244:247], v[52:55]
    s_add_u32 m0, s28, 90112
    s_add_u32 s27, s24, 90112
    buffer_load_dwordx4 v3, s[8:11], s27 offen lds
    s_waitcnt lgkmcnt(10)
    v_mfma_f32_16x16x32_bf16 v[56:59], v[100:103], v[248:251], v[56:59]
    s_waitcnt lgkmcnt(9)
    v_mfma_f32_16x16x32_bf16 v[60:63], v[100:103], v[252:255], v[60:63]
    ds_read_b64 v[116:117], v18 offset:704
    ds_read_b64 v[118:119], v18 offset:712
    ds_read_b128 v[176:179], v19 offset:1216
    s_waitcnt lgkmcnt(10)
    v_mfma_f32_16x16x32_bf16 v[48:51], v[104:107], v[132:135], v[48:51]
    s_add_u32 s29, s25, 10240
    buffer_load_dwordx4 a[40:43], v3, s[8:11], s29 offen
    s_waitcnt lgkmcnt(9)
    v_mfma_f32_16x16x32_bf16 v[52:55], v[104:107], v[128:131], v[52:55]
    v_mfma_f32_16x16x32_bf16 v[56:59], v[104:107], v[140:143], v[56:59]
    ds_read_b64 v[96:97], v18 offset:768
    ds_read_b64 v[98:99], v18 offset:776
    ds_read_b128 v[132:135], v19 offset:1280
    s_waitcnt lgkmcnt(10)
    v_mfma_f32_16x16x32_bf16 v[48:51], v[108:111], v[148:151], v[48:51]
    s_add_u32 m0, s28, 94208
    s_add_u32 s27, s24, 94208
    buffer_load_dwordx4 v3, s[8:11], s27 offen lds
    s_waitcnt lgkmcnt(9)
    v_mfma_f32_16x16x32_bf16 v[52:55], v[108:111], v[144:147], v[52:55]
    v_mfma_f32_16x16x32_bf16 v[56:59], v[108:111], v[156:159], v[56:59]
    ds_read_b64 v[100:101], v18 offset:832
    ds_read_b64 v[102:103], v18 offset:840
    ds_read_b128 v[148:151], v19 offset:1344
    s_waitcnt lgkmcnt(10)
    v_mfma_f32_16x16x32_bf16 v[48:51], v[112:115], v[164:167], v[48:51]
    s_add_u32 s29, s25, 11264
    buffer_load_dwordx4 a[44:47], v3, s[8:11], s29 offen
    s_waitcnt lgkmcnt(9)
    v_mfma_f32_16x16x32_bf16 v[52:55], v[112:115], v[160:163], v[52:55]
    v_mfma_f32_16x16x32_bf16 v[56:59], v[112:115], v[172:175], v[56:59]
    ds_read_b64 v[104:105], v18 offset:896
    ds_read_b64 v[106:107], v18 offset:904
    ds_read_b128 v[164:167], v19 offset:1408
    s_waitcnt lgkmcnt(10)
    v_mfma_f32_16x16x32_bf16 v[48:51], v[116:119], v[180:183], v[48:51]
    s_add_u32 m0, s28, 98304
    s_add_u32 s27, s24, 98304
    buffer_load_dwordx4 v3, s[8:11], s27 offen lds
    s_waitcnt lgkmcnt(9)
    v_mfma_f32_16x16x32_bf16 v[52:55], v[116:119], v[176:179], v[52:55]
    v_mfma_f32_16x16x32_bf16 v[56:59], v[116:119], v[188:191], v[56:59]
    ds_read_b64 v[108:109], v18 offset:960
    ds_read_b64 v[110:111], v18 offset:968
    ds_read_b128 v[180:183], v19 offset:1472
    s_waitcnt lgkmcnt(10)
    v_mfma_f32_16x16x32_bf16 v[48:51], v[96:99], v[196:199], v[48:51]
    s_add_u32 s29, s25, 12288
    buffer_load_dwordx4 a[48:51], v3, s[8:11], s29 offen
    s_waitcnt lgkmcnt(9)
    v_mfma_f32_16x16x32_bf16 v[52:55], v[96:99], v[132:135], v[52:55]
    v_mfma_f32_16x16x32_bf16 v[56:59], v[96:99], v[204:207], v[56:59]
    ds_read_b64 v[112:113], v18 offset:1024
    ds_read_b64 v[114:115], v18 offset:1032
    ds_read_b128 v[192:195], v19 offset:1536
    s_waitcnt lgkmcnt(10)
    v_mfma_f32_16x16x32_bf16 v[48:51], v[100:103], v[212:215], v[48:51]
    s_add_u32 s29, s25, 13312
    buffer_load_dwordx4 a[52:55], v3, s[8:11], s29 offen
    s_waitcnt lgkmcnt(9)
    v_mfma_f32_16x16x32_bf16 v[52:55], v[100:103], v[148:151], v[52:55]
    v_mfma_f32_16x16x32_bf16 v[56:59], v[100:103], v[220:223], v[56:59]
    ds_read_b64 v[116:117], v18 offset:1088
    ds_read_b64 v[118:119], v18 offset:1096
    ds_read_b128 v[196:199], v19 offset:1600
    s_waitcnt lgkmcnt(10)
    v_mfma_f32_16x16x32_bf16 v[48:51], v[104:107], v[228:231], v[48:51]
    s_add_u32 m0, s28, 102400
    s_add_u32 s27, s24, 102400
    buffer_load_dwordx4 v3, s[8:11], s27 offen lds
    s_waitcnt lgkmcnt(9)
    v_mfma_f32_16x16x32_bf16 v[52:55], v[104:107], v[164:167], v[52:55]
    v_mfma_f32_16x16x32_bf16 v[56:59], v[104:107], v[236:239], v[56:59]
    ds_read_b64 v[96:97], v18 offset:1152
    ds_read_b64 v[98:99], v18 offset:1160
    ds_read_b128 v[208:211], v19 offset:1664
    s_waitcnt lgkmcnt(10)
    v_mfma_f32_16x16x32_bf16 v[48:51], v[108:111], v[244:247], v[48:51]
    s_add_u32 s29, s25, 14336
    buffer_load_dwordx4 a[56:59], v3, s[8:11], s29 offen
    s_waitcnt lgkmcnt(9)
    v_mfma_f32_16x16x32_bf16 v[52:55], v[108:111], v[180:183], v[52:55]
    v_mfma_f32_16x16x32_bf16 v[56:59], v[108:111], v[252:255], v[56:59]
    ds_read_b64 v[100:101], v18 offset:1216
    ds_read_b64 v[102:103], v18 offset:1224
    ds_read_b128 v[212:215], v19 offset:1728
    s_waitcnt lgkmcnt(10)
    v_mfma_f32_16x16x32_bf16 v[48:51], v[112:115], v[128:131], v[48:51]
    s_add_u32 m0, s28, 106496
    s_add_u32 s27, s24, 106496
    buffer_load_dwordx4 v3, s[8:11], s27 offen lds
    s_waitcnt lgkmcnt(9)
    v_mfma_f32_16x16x32_bf16 v[52:55], v[112:115], v[192:195], v[52:55]
    ds_read_b64 v[104:105], v18 offset:1280
    ds_read_b64 v[106:107], v18 offset:1288
    ds_read_b128 v[128:131], v19 offset:1792
    s_waitcnt lgkmcnt(10)
    v_mfma_f32_16x16x32_bf16 v[48:51], v[116:119], v[144:147], v[48:51]
    s_waitcnt lgkmcnt(9)
    v_mfma_f32_16x16x32_bf16 v[52:55], v[116:119], v[196:199], v[52:55]
    s_add_u32 s29, s25, 15360
    buffer_load_dwordx4 a[60:63], v3, s[8:11], s29 offen
    ds_read_b64 v[108:109], v18 offset:1344
    ds_read_b64 v[110:111], v18 offset:1352
    ds_read_b128 v[144:147], v19 offset:1856
    s_waitcnt lgkmcnt(10)
    v_mfma_f32_16x16x32_bf16 v[48:51], v[96:99], v[160:163], v[48:51]
    s_waitcnt lgkmcnt(9)
    v_mfma_f32_16x16x32_bf16 v[52:55], v[96:99], v[208:211], v[52:55]
    ds_read_b64 v[112:113], v18 offset:1408
    ds_read_b64 v[114:115], v18 offset:1416
    ds_read_b128 v[160:163], v19 offset:1920
    s_waitcnt lgkmcnt(10)
    v_mfma_f32_16x16x32_bf16 v[48:51], v[100:103], v[176:179], v[48:51]
    s_add_u32 m0, s28, 110592
    s_add_u32 s27, s24, 110592
    buffer_load_dwordx4 v3, s[8:11], s27 offen lds
    s_waitcnt lgkmcnt(9)
    v_mfma_f32_16x16x32_bf16 v[52:55], v[100:103], v[212:215], v[52:55]
    ds_read_b64 v[116:117], v18 offset:1472
    ds_read_b64 v[118:119], v18 offset:1480
    ds_read_b128 v[176:179], v19 offset:1984
    s_waitcnt lgkmcnt(10)
    v_mfma_f32_16x16x32_bf16 v[48:51], v[104:107], v[132:135], v[48:51]
    s_waitcnt lgkmcnt(9)
    v_mfma_f32_16x16x32_bf16 v[52:55], v[104:107], v[128:131], v[52:55]
    s_add_u32 s29, s25, 16384
    buffer_load_dwordx4 a[64:67], v3, s[8:11], s29 offen
    ds_read_b64 v[96:97], v18 offset:1536
    ds_read_b64 v[98:99], v18 offset:1544
    ds_read_b128 v[132:135], v19 offset:2048
    s_waitcnt lgkmcnt(10)
    v_mfma_f32_16x16x32_bf16 v[48:51], v[108:111], v[148:151], v[48:51]
    s_waitcnt lgkmcnt(9)
    v_mfma_f32_16x16x32_bf16 v[52:55], v[108:111], v[144:147], v[52:55]
    ds_read_b64 v[100:101], v18 offset:1600
    ds_read_b64 v[102:103], v18 offset:1608
    ds_read_b128 v[148:151], v19 offset:2112
    s_waitcnt lgkmcnt(10)
    v_mfma_f32_16x16x32_bf16 v[48:51], v[112:115], v[164:167], v[48:51]
    s_add_u32 m0, s28, 114688
    s_add_u32 s27, s24, 114688
    buffer_load_dwordx4 v3, s[8:11], s27 offen lds
    s_waitcnt lgkmcnt(9)
    v_mfma_f32_16x16x32_bf16 v[52:55], v[112:115], v[160:163], v[52:55]
    ds_read_b64 v[104:105], v18 offset:1664
    ds_read_b64 v[106:107], v18 offset:1672
    ds_read_b128 v[164:167], v19 offset:2176
    s_waitcnt lgkmcnt(10)
    v_mfma_f32_16x16x32_bf16 v[48:51], v[116:119], v[180:183], v[48:51]
    s_waitcnt lgkmcnt(9)
    v_mfma_f32_16x16x32_bf16 v[52:55], v[116:119], v[176:179], v[52:55]
    s_add_u32 s29, s25, 17408
    buffer_load_dwordx4 a[68:71], v3, s[8:11], s29 offen
    ds_read_b64 v[108:109], v18 offset:1728
    ds_read_b64 v[110:111], v18 offset:1736
    ds_read_b128 v[180:183], v19 offset:2240
    s_waitcnt lgkmcnt(10)
    v_mfma_f32_16x16x32_bf16 v[48:51], v[96:99], v[192:195], v[48:51]
    s_waitcnt lgkmcnt(9)
    v_mfma_f32_16x16x32_bf16 v[52:55], v[96:99], v[132:135], v[52:55]
    ds_read_b64 v[112:113], v18 offset:1792
    ds_read_b64 v[114:115], v18 offset:1800
    ds_read_b128 v[192:195], v19 offset:2304
    s_waitcnt lgkmcnt(10)
    v_mfma_f32_16x16x32_bf16 v[48:51], v[100:103], v[196:199], v[48:51]
    s_add_u32 m0, s28, 118784
    s_add_u32 s27, s24, 118784
    buffer_load_dwordx4 v3, s[8:11], s27 offen lds
    s_waitcnt lgkmcnt(9)
    v_mfma_f32_16x16x32_bf16 v[52:55], v[100:103], v[148:151], v[52:55]
    ds_read_b64 v[116:117], v18 offset:1856
    ds_read_b64 v[118:119], v18 offset:1864
    ds_read_b128 v[196:199], v19 offset:2368
    s_waitcnt lgkmcnt(10)
    v_mfma_f32_16x16x32_bf16 v[48:51], v[104:107], v[208:211], v[48:51]
    s_waitcnt lgkmcnt(9)
    v_mfma_f32_16x16x32_bf16 v[52:55], v[104:107], v[164:167], v[52:55]
    s_add_u32 s29, s25, 18432
    buffer_load_dwordx4 a[72:75], v3, s[8:11], s29 offen
    ds_read_b64 v[96:97], v18 offset:1920
    ds_read_b64 v[98:99], v18 offset:1928
    ds_read_b128 v[208:211], v19 offset:2432
    s_waitcnt lgkmcnt(10)
    v_mfma_f32_16x16x32_bf16 v[48:51], v[108:111], v[212:215], v[48:51]
    s_waitcnt lgkmcnt(9)
    v_mfma_f32_16x16x32_bf16 v[52:55], v[108:111], v[180:183], v[52:55]
    ds_read_b64 v[100:101], v18 offset:1984
    ds_read_b64 v[102:103], v18 offset:1992
    ds_read_b128 v[212:215], v19 offset:2496
    s_waitcnt lgkmcnt(10)
    v_mfma_f32_16x16x32_bf16 v[48:51], v[112:115], v[128:131], v[48:51]
    s_add_u32 s29, s25, 19456
    buffer_load_dwordx4 a[76:79], v3, s[8:11], s29 offen
    s_waitcnt lgkmcnt(9)
    v_mfma_f32_16x16x32_bf16 v[52:55], v[112:115], v[192:195], v[52:55]
    ds_read_b64 v[104:105], v18 offset:2048
    ds_read_b64 v[106:107], v18 offset:2056
    ds_read_b128 v[128:131], v19 offset:2560
    s_waitcnt lgkmcnt(10)
    v_mfma_f32_16x16x32_bf16 v[48:51], v[116:119], v[144:147], v[48:51]
    s_waitcnt lgkmcnt(9)
    v_mfma_f32_16x16x32_bf16 v[52:55], v[116:119], v[196:199], v[52:55]
    s_add_u32 m0, s28, 122880
    s_add_u32 s27, s24, 122880
    buffer_load_dwordx4 v3, s[8:11], s27 offen lds
    ds_read_b64 v[108:109], v18 offset:2112
    ds_read_b64 v[110:111], v18 offset:2120
    ds_read_b128 v[144:147], v19 offset:2624
    s_waitcnt lgkmcnt(10)
    v_mfma_f32_16x16x32_bf16 v[48:51], v[96:99], v[160:163], v[48:51]
    s_waitcnt lgkmcnt(9)
    v_mfma_f32_16x16x32_bf16 v[52:55], v[96:99], v[208:211], v[52:55]
    ds_read_b64 v[112:113], v18 offset:2176
    ds_read_b64 v[114:115], v18 offset:2184
    ds_read_b128 v[160:163], v19 offset:2688
    s_waitcnt lgkmcnt(10)
    v_mfma_f32_16x16x32_bf16 v[48:51], v[100:103], v[176:179], v[48:51]
    s_add_u32 s29, s25, 20480
    buffer_load_dwordx4 a[80:83], v3, s[8:11], s29 offen
    s_waitcnt lgkmcnt(9)
    v_mfma_f32_16x16x32_bf16 v[52:55], v[100:103], v[212:215], v[52:55]
    ds_read_b64 v[116:117], v18 offset:2240
    ds_read_b64 v[118:119], v18 offset:2248
    ds_read_b128 v[176:179], v19 offset:2752
    s_waitcnt lgkmcnt(10)
    v_mfma_f32_16x16x32_bf16 v[48:51], v[104:107], v[132:135], v[48:51]
    s_waitcnt lgkmcnt(9)
    v_mfma_f32_16x16x32_bf16 v[52:55], v[104:107], v[128:131], v[52:55]
    s_add_u32 m0, s28, 126976
    s_add_u32 s27, s24, 126976
    buffer_load_dwordx4 v3, s[8:11], s27 offen lds
    ds_read_b64 v[96:97], v18 offset:2304
    ds_read_b64 v[98:99], v18 offset:2312
    ds_read_b128 v[132:135], v19 offset:2816
    s_waitcnt lgkmcnt(10)
    v_mfma_f32_16x16x32_bf16 v[48:51], v[108:111], v[148:151], v[48:51]
    s_waitcnt lgkmcnt(9)
    v_mfma_f32_16x16x32_bf16 v[52:55], v[108:111], v[144:147], v[52:55]
    ds_read_b64 v[100:101], v18 offset:2368
    ds_read_b64 v[102:103], v18 offset:2376
    ds_read_b128 v[148:151], v19 offset:2880
    s_waitcnt lgkmcnt(10)
    v_mfma_f32_16x16x32_bf16 v[48:51], v[112:115], v[164:167], v[48:51]
    s_add_u32 s29, s25, 21504
    buffer_load_dwordx4 a[84:87], v3, s[8:11], s29 offen
    s_waitcnt lgkmcnt(9)
    v_mfma_f32_16x16x32_bf16 v[52:55], v[112:115], v[160:163], v[52:55]
    ds_read_b64 v[104:105], v18 offset:2432
    ds_read_b64 v[106:107], v18 offset:2440
    ds_read_b128 v[164:167], v19 offset:2944
    s_waitcnt lgkmcnt(10)
    v_mfma_f32_16x16x32_bf16 v[48:51], v[116:119], v[180:183], v[48:51]
    s_waitcnt lgkmcnt(9)
    v_mfma_f32_16x16x32_bf16 v[52:55], v[116:119], v[176:179], v[52:55]
    s_add_u32 m0, s28, 131072
    s_add_u32 s27, s24, 131072
    buffer_load_dwordx4 v3, s[8:11], s27 offen lds
    ds_read_b64 v[108:109], v18 offset:2496
    ds_read_b64 v[110:111], v18 offset:2504
    ds_read_b128 v[180:183], v19 offset:3008
    s_waitcnt lgkmcnt(10)
    v_mfma_f32_16x16x32_bf16 v[48:51], v[96:99], v[192:195], v[48:51]
    s_waitcnt lgkmcnt(9)
    v_mfma_f32_16x16x32_bf16 v[52:55], v[96:99], v[132:135], v[52:55]
    ds_read_b64 v[112:113], v18 offset:2560
    ds_read_b64 v[114:115], v18 offset:2568
    s_waitcnt lgkmcnt(9)
    v_mfma_f32_16x16x32_bf16 v[48:51], v[100:103], v[196:199], v[48:51]
    s_add_u32 s29, s25, 22528
    buffer_load_dwordx4 a[88:91], v3, s[8:11], s29 offen
    s_waitcnt lgkmcnt(8)
    v_mfma_f32_16x16x32_bf16 v[52:55], v[100:103], v[148:151], v[52:55]
    ds_read_b64 v[116:117], v18 offset:2624
    ds_read_b64 v[118:119], v18 offset:2632
    s_waitcnt lgkmcnt(8)
    v_mfma_f32_16x16x32_bf16 v[48:51], v[104:107], v[208:211], v[48:51]
    s_waitcnt lgkmcnt(7)
    v_mfma_f32_16x16x32_bf16 v[52:55], v[104:107], v[164:167], v[52:55]
    s_add_u32 m0, s28, 135168
    s_add_u32 s27, s24, 135168
    buffer_load_dwordx4 v3, s[8:11], s27 offen lds
    ds_read_b64 v[96:97], v18 offset:2688
    ds_read_b64 v[98:99], v18 offset:2696
    s_waitcnt lgkmcnt(7)
    v_mfma_f32_16x16x32_bf16 v[48:51], v[108:111], v[212:215], v[48:51]
    s_waitcnt lgkmcnt(6)
    v_mfma_f32_16x16x32_bf16 v[52:55], v[108:111], v[180:183], v[52:55]
    ds_read_b64 v[100:101], v18 offset:2752
    ds_read_b64 v[102:103], v18 offset:2760
    s_waitcnt lgkmcnt(6)
    v_mfma_f32_16x16x32_bf16 v[48:51], v[112:115], v[128:131], v[48:51]
    s_add_u32 s29, s25, 23552
    buffer_load_dwordx4 a[92:95], v3, s[8:11], s29 offen
    v_mfma_f32_16x16x32_bf16 v[52:55], v[112:115], v[136:139], v[52:55]
    ds_read_b64 v[104:105], v18 offset:2816
    ds_read_b64 v[106:107], v18 offset:2824
    s_waitcnt lgkmcnt(6)
    v_mfma_f32_16x16x32_bf16 v[48:51], v[116:119], v[144:147], v[48:51]
    v_mfma_f32_16x16x32_bf16 v[52:55], v[116:119], v[152:155], v[52:55]
    s_waitcnt vmcnt(44)
    s_add_u32 m0, s28, 139264
    s_add_u32 s27, s24, 139264
    buffer_load_dwordx4 v3, s[8:11], s27 offen lds
    ds_read_b64 v[108:109], v18 offset:2880
    ds_read_b64 v[110:111], v18 offset:2888
    s_waitcnt lgkmcnt(6)
    v_mfma_f32_16x16x32_bf16 v[48:51], v[96:99], v[160:163], v[48:51]
    v_mfma_f32_16x16x32_bf16 v[52:55], v[96:99], v[168:171], v[52:55]
    ds_read_b64 v[112:113], v18 offset:2944
    ds_read_b64 v[114:115], v18 offset:2952
    s_waitcnt lgkmcnt(6)
    v_mfma_f32_16x16x32_bf16 v[48:51], v[100:103], v[176:179], v[48:51]
    s_add_u32 s29, s25, 24576
    buffer_load_dwordx4 a[96:99], v3, s[8:11], s29 offen
    v_mfma_f32_16x16x32_bf16 v[52:55], v[100:103], v[184:187], v[52:55]
    ds_read_b64 v[116:117], v18 offset:3008
    ds_read_b64 v[118:119], v18 offset:3016
    s_waitcnt lgkmcnt(6)
    v_mfma_f32_16x16x32_bf16 v[48:51], v[104:107], v[132:135], v[48:51]
    v_mfma_f32_16x16x32_bf16 v[52:55], v[104:107], v[200:203], v[52:55]
    s_add_u32 s29, s25, 25600
    buffer_load_dwordx4 a[100:103], v3, s[8:11], s29 offen
    ds_read_b64 v[96:97], v18 offset:3072
    ds_read_b64 v[98:99], v18 offset:3080
    s_waitcnt lgkmcnt(6)
    v_mfma_f32_16x16x32_bf16 v[48:51], v[108:111], v[148:151], v[48:51]
    v_mfma_f32_16x16x32_bf16 v[52:55], v[108:111], v[216:219], v[52:55]
    ds_read_b64 v[100:101], v18 offset:3136
    ds_read_b64 v[102:103], v18 offset:3144
    s_waitcnt lgkmcnt(6)
    v_mfma_f32_16x16x32_bf16 v[48:51], v[112:115], v[164:167], v[48:51]
    s_add_u32 m0, s28, 143360
    s_add_u32 s27, s24, 143360
    buffer_load_dwordx4 v3, s[8:11], s27 offen lds
    v_mfma_f32_16x16x32_bf16 v[52:55], v[112:115], v[232:235], v[52:55]
    ds_read_b64 v[104:105], v18 offset:3200
    ds_read_b64 v[106:107], v18 offset:3208
    s_waitcnt lgkmcnt(6)
    v_mfma_f32_16x16x32_bf16 v[48:51], v[116:119], v[180:183], v[48:51]
    v_mfma_f32_16x16x32_bf16 v[52:55], v[116:119], v[248:251], v[52:55]
    s_waitcnt vmcnt(44)
    s_add_u32 s29, s25, 26624
    buffer_load_dwordx4 a[104:107], v3, s[8:11], s29 offen
    ds_read_b64 v[108:109], v18 offset:3264
    ds_read_b64 v[110:111], v18 offset:3272
    s_waitcnt lgkmcnt(6)
    v_mfma_f32_16x16x32_bf16 v[48:51], v[96:99], v[136:139], v[48:51]
    v_mfma_f32_16x16x32_bf16 v[52:55], v[96:99], v[140:143], v[52:55]
    ds_read_b64 v[112:113], v18 offset:3328
    ds_read_b64 v[114:115], v18 offset:3336
    s_waitcnt lgkmcnt(6)
    v_mfma_f32_16x16x32_bf16 v[48:51], v[100:103], v[152:155], v[48:51]
    s_add_u32 m0, s28, 147456
    s_add_u32 s27, s24, 147456
    buffer_load_dwordx4 v3, s[8:11], s27 offen lds
    v_mfma_f32_16x16x32_bf16 v[52:55], v[100:103], v[156:159], v[52:55]
    ds_read_b64 v[116:117], v18 offset:3392
    ds_read_b64 v[118:119], v18 offset:3400
    s_waitcnt lgkmcnt(6)
    v_mfma_f32_16x16x32_bf16 v[48:51], v[104:107], v[168:171], v[48:51]
    v_mfma_f32_16x16x32_bf16 v[52:55], v[104:107], v[172:175], v[52:55]
    s_add_u32 s29, s25, 27648
    buffer_load_dwordx4 a[108:111], v3, s[8:11], s29 offen
    ds_read_b64 v[96:97], v18 offset:3456
    ds_read_b64 v[98:99], v18 offset:3464
    s_waitcnt lgkmcnt(6)
    v_mfma_f32_16x16x32_bf16 v[48:51], v[108:111], v[184:187], v[48:51]
    v_mfma_f32_16x16x32_bf16 v[52:55], v[108:111], v[188:191], v[52:55]
    ds_read_b64 v[100:101], v18 offset:3520
    ds_read_b64 v[102:103], v18 offset:3528
    s_waitcnt lgkmcnt(6)
    v_mfma_f32_16x16x32_bf16 v[48:51], v[112:115], v[200:203], v[48:51]
    s_add_u32 m0, s28, 151552
    s_add_u32 s27, s24, 151552
    buffer_load_dwordx4 v3, s[8:11], s27 offen lds
    v_mfma_f32_16x16x32_bf16 v[52:55], v[112:115], v[204:207], v[52:55]
    ds_read_b64 v[104:105], v18 offset:3584
    ds_read_b64 v[106:107], v18 offset:3592
    s_waitcnt lgkmcnt(6)
    v_mfma_f32_16x16x32_bf16 v[48:51], v[116:119], v[216:219], v[48:51]
    v_mfma_f32_16x16x32_bf16 v[52:55], v[116:119], v[220:223], v[52:55]
    s_waitcnt vmcnt(44)
    s_add_u32 s29, s25, 35840
    buffer_load_dwordx4 a[112:115], v3, s[8:11], s29 offen
    ds_read_b64 v[108:109], v18 offset:3648
    ds_read_b64 v[110:111], v18 offset:3656
    s_waitcnt lgkmcnt(6)
    v_mfma_f32_16x16x32_bf16 v[48:51], v[96:99], v[232:235], v[48:51]
    v_mfma_f32_16x16x32_bf16 v[52:55], v[96:99], v[236:239], v[52:55]
    ds_read_b64 v[112:113], v18 offset:3712
    ds_read_b64 v[114:115], v18 offset:3720
    s_waitcnt lgkmcnt(6)
    v_mfma_f32_16x16x32_bf16 v[48:51], v[100:103], v[248:251], v[48:51]
    s_add_u32 m0, s28, 155648
    s_add_u32 s27, s24, 155648
    buffer_load_dwordx4 v3, s[8:11], s27 offen lds
    v_mfma_f32_16x16x32_bf16 v[52:55], v[100:103], v[252:255], v[52:55]
    ds_read_b64 v[116:117], v18 offset:3776
    ds_read_b64 v[118:119], v18 offset:3784
    s_waitcnt lgkmcnt(6)
    v_mfma_f32_16x16x32_bf16 v[48:51], v[104:107], v[140:143], v[48:51]
    ds_read_b64 v[96:97], v18 offset:3840
    ds_read_b64 v[98:99], v18 offset:3848
    s_waitcnt lgkmcnt(6)
    v_mfma_f32_16x16x32_bf16 v[48:51], v[108:111], v[156:159], v[48:51]
    s_add_u32 s29, s25, 36864
    buffer_load_dwordx4 a[116:119], v3, s[8:11], s29 offen
    ds_read_b64 v[100:101], v18 offset:3904
    ds_read_b64 v[102:103], v18 offset:3912
    s_waitcnt lgkmcnt(6)
    v_mfma_f32_16x16x32_bf16 v[48:51], v[112:115], v[172:175], v[48:51]
    ds_read_b64 v[104:105], v18 offset:3968
    ds_read_b64 v[106:107], v18 offset:3976
    s_waitcnt lgkmcnt(6)
    v_mfma_f32_16x16x32_bf16 v[48:51], v[116:119], v[188:191], v[48:51]
    ds_read_b64 v[108:109], v18 offset:4032
    ds_read_b64 v[110:111], v18 offset:4040
    s_waitcnt lgkmcnt(6)
    v_mfma_f32_16x16x32_bf16 v[48:51], v[96:99], v[204:207], v[48:51]
    s_waitcnt lgkmcnt(4)
    v_mfma_f32_16x16x32_bf16 v[48:51], v[100:103], v[220:223], v[48:51]
    s_waitcnt lgkmcnt(2)
    v_mfma_f32_16x16x32_bf16 v[48:51], v[104:107], v[236:239], v[48:51]
    s_waitcnt lgkmcnt(0)
    v_mfma_f32_16x16x32_bf16 v[48:51], v[108:111], v[252:255], v[48:51]
    s_nop 7
    ds_read_b64 v[64:65], v20 offset:3584
    ds_read_b64 v[66:67], v20 offset:3072
    ds_read_b64 v[68:69], v20 offset:512
    ds_read_b64 v[70:71], v20 offset:0
    s_waitcnt lgkmcnt(3)
    v_lshlrev_b32 v72, 16, v64
    v_and_b32 v73, 0xffff0000, v64
    v_lshlrev_b32 v74, 16, v65
    v_and_b32 v75, 0xffff0000, v65
    v_mul_f32 v72, s66, v72
    v_mul_f32 v73, s66, v73
    v_mul_f32 v74, s66, v74
    v_mul_f32 v75, s66, v75
    v_cvt_pk_bf16_f32 v76, v72, v73
    v_cvt_pk_bf16_f32 v77, v74, v75
    v_cvt_pk_bf16_f32 v78, v48, v49
    v_cvt_pk_bf16_f32 v79, v50, v51
    v_lshlrev_b32 v72, 16, v76
    v_lshlrev_b32 v80, 16, v78
    v_and_b32 v73, 0xffff0000, v76
    v_and_b32 v81, 0xffff0000, v78
    v_lshlrev_b32 v74, 16, v77
    v_lshlrev_b32 v82, 16, v79
    v_and_b32 v75, 0xffff0000, v77
    v_and_b32 v83, 0xffff0000, v79
    v_add_f32 v72, v72, v80
    v_add_f32 v73, v73, v81
    v_add_f32 v74, v74, v82
    v_add_f32 v75, v75, v83
    v_cvt_pk_bf16_f32 v84, v72, v73
    v_cvt_pk_bf16_f32 v85, v74, v75
    v_min_u32 v84, 0xfffffffe, v84
    v_min_u32 v85, 0xfffffffe, v85
    s_waitcnt lgkmcnt(2)
    v_lshlrev_b32 v72, 16, v66
    v_and_b32 v73, 0xffff0000, v66
    v_lshlrev_b32 v74, 16, v67
    v_and_b32 v75, 0xffff0000, v67
    v_mul_f32 v72, s66, v72
    v_mul_f32 v73, s66, v73
    v_mul_f32 v74, s66, v74
    v_mul_f32 v75, s66, v75
    v_cvt_pk_bf16_f32 v76, v72, v73
    v_cvt_pk_bf16_f32 v77, v74, v75
    v_cvt_pk_bf16_f32 v78, v52, v53
    v_cvt_pk_bf16_f32 v79, v54, v55
    v_lshlrev_b32 v72, 16, v76
    v_lshlrev_b32 v80, 16, v78
    v_and_b32 v73, 0xffff0000, v76
    v_and_b32 v81, 0xffff0000, v78
    v_lshlrev_b32 v74, 16, v77
    v_lshlrev_b32 v82, 16, v79
    v_and_b32 v75, 0xffff0000, v77
    v_and_b32 v83, 0xffff0000, v79
    v_add_f32 v72, v72, v80
    v_add_f32 v73, v73, v81
    v_add_f32 v74, v74, v82
    v_add_f32 v75, v75, v83
    v_cvt_pk_bf16_f32 v86, v72, v73
    v_cvt_pk_bf16_f32 v87, v74, v75
    v_min_u32 v86, 0xfffffffe, v86
    v_min_u32 v87, 0xfffffffe, v87
    s_nop 0
    v_permlane16_swap_b32 v84, v86
    v_permlane16_swap_b32 v85, v87
    buffer_store_dwordx4 v[84:87], v21, s[8:11], s48 offen offset:3072 sc1
    s_waitcnt lgkmcnt(1)
    v_lshlrev_b32 v72, 16, v68
    v_and_b32 v73, 0xffff0000, v68
    v_lshlrev_b32 v74, 16, v69
    v_and_b32 v75, 0xffff0000, v69
    v_mul_f32 v72, s66, v72
    v_mul_f32 v73, s66, v73
    v_mul_f32 v74, s66, v74
    v_mul_f32 v75, s66, v75
    v_cvt_pk_bf16_f32 v76, v72, v73
    v_cvt_pk_bf16_f32 v77, v74, v75
    v_cvt_pk_bf16_f32 v78, v56, v57
    v_cvt_pk_bf16_f32 v79, v58, v59
    v_lshlrev_b32 v72, 16, v76
    v_lshlrev_b32 v80, 16, v78
    v_and_b32 v73, 0xffff0000, v76
    v_and_b32 v81, 0xffff0000, v78
    v_lshlrev_b32 v74, 16, v77
    v_lshlrev_b32 v82, 16, v79
    v_and_b32 v75, 0xffff0000, v77
    v_and_b32 v83, 0xffff0000, v79
    v_add_f32 v72, v72, v80
    v_add_f32 v73, v73, v81
    v_add_f32 v74, v74, v82
    v_add_f32 v75, v75, v83
    v_cvt_pk_bf16_f32 v88, v72, v73
    v_cvt_pk_bf16_f32 v89, v74, v75
    v_min_u32 v88, 0xfffffffe, v88
    v_min_u32 v89, 0xfffffffe, v89
    s_waitcnt lgkmcnt(0)
    v_lshlrev_b32 v72, 16, v70
    v_and_b32 v73, 0xffff0000, v70
    v_lshlrev_b32 v74, 16, v71
    v_and_b32 v75, 0xffff0000, v71
    v_mul_f32 v72, s66, v72
    v_mul_f32 v73, s66, v73
    v_mul_f32 v74, s66, v74
    v_mul_f32 v75, s66, v75
    v_cvt_pk_bf16_f32 v76, v72, v73
    v_cvt_pk_bf16_f32 v77, v74, v75
    v_cvt_pk_bf16_f32 v78, v60, v61
    v_cvt_pk_bf16_f32 v79, v62, v63
    v_lshlrev_b32 v72, 16, v76
    v_lshlrev_b32 v80, 16, v78
    v_and_b32 v73, 0xffff0000, v76
    v_and_b32 v81, 0xffff0000, v78
    v_lshlrev_b32 v74, 16, v77
    v_lshlrev_b32 v82, 16, v79
    v_and_b32 v75, 0xffff0000, v77
    v_and_b32 v83, 0xffff0000, v79
    v_add_f32 v72, v72, v80
    v_add_f32 v73, v73, v81
    v_add_f32 v74, v74, v82
    v_add_f32 v75, v75, v83
    v_cvt_pk_bf16_f32 v90, v72, v73
    v_cvt_pk_bf16_f32 v91, v74, v75
    v_min_u32 v90, 0xfffffffe, v90
    v_min_u32 v91, 0xfffffffe, v91
    s_nop 0
    v_permlane16_swap_b32 v88, v90
    v_permlane16_swap_b32 v89, v91
    buffer_store_dwordx4 v[88:91], v21, s[8:11], s48 offen offset:0 sc1
    s_branch cv_join
cv_set1:
    ds_read_b64 v[96:97], v18 offset:0
    ds_read_b64 v[98:99], v18 offset:8
    ds_read_b128 v[128:131], v19 offset:1024
    ds_read_b128 v[132:135], v19 offset:1536
    ds_read_b128 v[136:139], v19 offset:2048
    ds_read_b128 v[140:143], v19 offset:2560
    ds_read_b64 v[100:101], v18 offset:64
    ds_read_b64 v[102:103], v18 offset:72
    ds_read_b128 v[144:147], v19 offset:1088
    ds_read_b128 v[148:151], v19 offset:1600
    ds_read_b128 v[152:155], v19 offset:2112
    ds_read_b128 v[156:159], v19 offset:2624
    ds_read_b64 v[104:105], v18 offset:128
    ds_read_b64 v[106:107], v18 offset:136
    ds_read_b128 v[160:163], v19 offset:1152
    ds_read_b128 v[164:167], v19 offset:1664
    ds_read_b128 v[168:171], v19 offset:2176
    ds_read_b128 v[172:175], v19 offset:2688
    ds_read_b64 v[108:109], v18 offset:192
    ds_read_b64 v[110:111], v18 offset:200
    ds_read_b128 v[176:179], v19 offset:1216
    ds_read_b128 v[180:183], v19 offset:1728
    ds_read_b128 v[184:187], v19 offset:2240
    ds_read_b128 v[188:191], v19 offset:2752
    s_waitcnt lgkmcnt(15)
    v_mfma_f32_16x16x32_bf16 v[48:51], v[96:99], v[128:131], 0
    s_add_u32 s29, s25, 4096
    buffer_load_dwordx4 a[16:19], v3, s[8:11], s29 offen
    v_mfma_f32_16x16x32_bf16 v[52:55], v[96:99], v[132:135], 0
    v_mfma_f32_16x16x32_bf16 v[56:59], v[96:99], v[136:139], 0
    s_add_u32 m0, s28, 73728
    s_add_u32 s27, s24, 73728
    buffer_load_dwordx4 v3, s[8:11], s27 offen lds
    v_mfma_f32_16x16x32_bf16 v[60:63], v[96:99], v[140:143], 0
    ds_read_b64 v[112:113], v18 offset:256
    ds_read_b64 v[114:115], v18 offset:264
    ds_read_b128 v[192:195], v19 offset:1280
    ds_read_b128 v[196:199], v19 offset:1792
    ds_read_b128 v[200:203], v19 offset:2304
    ds_read_b128 v[204:207], v19 offset:2816
    v_mfma_f32_16x16x32_bf16 v[48:51], v[100:103], v[144:147], v[48:51]
    s_waitcnt lgkmcnt(15)
    v_mfma_f32_16x16x32_bf16 v[52:55], v[100:103], v[148:151], v[52:55]
    s_add_u32 s29, s25, 5120
    buffer_load_dwordx4 a[20:23], v3, s[8:11], s29 offen
    v_mfma_f32_16x16x32_bf16 v[56:59], v[100:103], v[152:155], v[56:59]
    v_mfma_f32_16x16x32_bf16 v[60:63], v[100:103], v[156:159], v[60:63]
    ds_read_b64 v[116:117], v18 offset:320
    ds_read_b64 v[118:119], v18 offset:328
    ds_read_b128 v[208:211], v19 offset:1344
    ds_read_b128 v[212:215], v19 offset:1856
    ds_read_b128 v[216:219], v19 offset:2368
    ds_read_b128 v[220:223], v19 offset:2880
    v_mfma_f32_16x16x32_bf16 v[48:51], v[104:107], v[160:163], v[48:51]
    s_add_u32 m0, s28, 77824
    s_add_u32 s27, s24, 77824
    buffer_load_dwordx4 v3, s[8:11], s27 offen lds
    s_waitcnt lgkmcnt(15)
    v_mfma_f32_16x16x32_bf16 v[52:55], v[104:107], v[164:167], v[52:55]
    v_mfma_f32_16x16x32_bf16 v[56:59], v[104:107], v[168:171], v[56:59]
    v_mfma_f32_16x16x32_bf16 v[60:63], v[104:107], v[172:175], v[60:63]
    s_add_u32 s29, s25, 6144
    buffer_load_dwordx4 a[24:27], v3, s[8:11], s29 offen
    ds_read_b64 v[96:97], v18 offset:384
    ds_read_b64 v[98:99], v18 offset:392
    ds_read_b128 v[224:227], v19 offset:1408
    ds_read_b128 v[228:231], v19 offset:1920
    ds_read_b128 v[232:235], v19 offset:2432
    ds_read_b128 v[236:239], v19 offset:2944
    v_mfma_f32_16x16x32_bf16 v[48:51], v[108:111], v[176:179], v[48:51]
    s_waitcnt lgkmcnt(15)
    v_mfma_f32_16x16x32_bf16 v[52:55], v[108:111], v[180:183], v[52:55]
    v_mfma_f32_16x16x32_bf16 v[56:59], v[108:111], v[184:187], v[56:59]
    s_add_u32 s29, s25, 7168
    buffer_load_dwordx4 a[28:31], v3, s[8:11], s29 offen
    v_mfma_f32_16x16x32_bf16 v[60:63], v[108:111], v[188:191], v[60:63]
    ds_read_b64 v[100:101], v18 offset:448
    ds_read_b64 v[102:103], v18 offset:456
    ds_read_b128 v[240:243], v19 offset:1472
    ds_read_b128 v[244:247], v19 offset:1984
    ds_read_b128 v[248:251], v19 offset:2496
    ds_read_b128 v[252:255], v19 offset:3008
    v_mfma_f32_16x16x32_bf16 v[48:51], v[112:115], v[192:195], v[48:51]
    s_waitcnt lgkmcnt(15)
    v_mfma_f32_16x16x32_bf16 v[52:55], v[112:115], v[196:199], v[52:55]
    s_add_u32 m0, s28, 81920
    s_add_u32 s27, s24, 81920
    buffer_load_dwordx4 v3, s[8:11], s27 offen lds
    v_mfma_f32_16x16x32_bf16 v[56:59], v[112:115], v[200:203], v[56:59]
    v_mfma_f32_16x16x32_bf16 v[60:63], v[112:115], v[204:207], v[60:63]
    ds_read_b64 v[104:105], v18 offset:512
    ds_read_b64 v[106:107], v18 offset:520
    ds_read_b128 v[128:131], v19 offset:3072
    v_mfma_f32_16x16x32_bf16 v[48:51], v[116:119], v[208:211], v[48:51]
    s_add_u32 s29, s25, 8192
    buffer_load_dwordx4 a[32:35], v3, s[8:11], s29 offen
    s_waitcnt lgkmcnt(15)
    v_mfma_f32_16x16x32_bf16 v[52:55], v[116:119], v[212:215], v[52:55]
    v_mfma_f32_16x16x32_bf16 v[56:59], v[116:119], v[216:219], v[56:59]
    v_mfma_f32_16x16x32_bf16 v[60:63], v[116:119], v[220:223], v[60:63]
    s_add_u32 m0, s28, 86016
    s_add_u32 s27, s24, 86016
    buffer_load_dwordx4 v3, s[8:11], s27 offen lds
    ds_read_b64 v[108:109], v18 offset:576
    ds_read_b64 v[110:111], v18 offset:584
    ds_read_b128 v[144:147], v19 offset:3136
    s_waitcnt lgkmcnt(15)
    v_mfma_f32_16x16x32_bf16 v[48:51], v[96:99], v[224:227], v[48:51]
    s_waitcnt lgkmcnt(14)
    v_mfma_f32_16x16x32_bf16 v[52:55], v[96:99], v[228:231], v[52:55]
    s_waitcnt lgkmcnt(13)
    v_mfma_f32_16x16x32_bf16 v[56:59], v[96:99], v[232:235], v[56:59]
    s_add_u32 s29, s25, 9216
    buffer_load_dwordx4 a[36:39], v3, s[8:11], s29 offen
    s_waitcnt lgkmcnt(12)
    v_mfma_f32_16x16x32_bf16 v[60:63], v[96:99], v[236:239], v[60:63]
    ds_read_b64 v[112:113], v18 offset:640
    ds_read_b64 v[114:115], v18 offset:648
    ds_read_b128 v[160:163], v19 offset:3200
    s_waitcnt lgkmcnt(12)
    v_mfma_f32_16x16x32_bf16 v[48:51], v[100:103], v[240:243], v[48:51]
    s_waitcnt lgkmcnt(11)
    v_mfma_f32_16x16x32_bf16 v[52:55], v[100:103], v[244:247], v[52:55]
    s_add_u32 m0, s28, 90112
    s_add_u32 s27, s24, 90112
    buffer_load_dwordx4 v3, s[8:11], s27 offen lds
    s_waitcnt lgkmcnt(10)
    v_mfma_f32_16x16x32_bf16 v[56:59], v[100:103], v[248:251], v[56:59]
    s_waitcnt lgkmcnt(9)
    v_mfma_f32_16x16x32_bf16 v[60:63], v[100:103], v[252:255], v[60:63]
    ds_read_b64 v[116:117], v18 offset:704
    ds_read_b64 v[118:119], v18 offset:712
    ds_read_b128 v[176:179], v19 offset:3264
    s_waitcnt lgkmcnt(10)
    v_mfma_f32_16x16x32_bf16 v[48:51], v[104:107], v[132:135], v[48:51]
    s_add_u32 s29, s25, 10240
    buffer_load_dwordx4 a[40:43], v3, s[8:11], s29 offen
    v_mfma_f32_16x16x32_bf16 v[52:55], v[104:107], v[136:139], v[52:55]
    v_mfma_f32_16x16x32_bf16 v[56:59], v[104:107], v[140:143], v[56:59]
    s_waitcnt lgkmcnt(9)
    v_mfma_f32_16x16x32_bf16 v[60:63], v[104:107], v[128:131], v[60:63]
    s_add_u32 m0, s28, 94208
    s_add_u32 s27, s24, 94208
    buffer_load_dwordx4 v3, s[8:11], s27 offen lds
    ds_read_b64 v[96:97], v18 offset:768
    ds_read_b64 v[98:99], v18 offset:776
    ds_read_b128 v[132:135], v19 offset:3328
    s_waitcnt lgkmcnt(10)
    v_mfma_f32_16x16x32_bf16 v[48:51], v[108:111], v[148:151], v[48:51]
    v_mfma_f32_16x16x32_bf16 v[52:55], v[108:111], v[152:155], v[52:55]
    v_mfma_f32_16x16x32_bf16 v[56:59], v[108:111], v[156:159], v[56:59]
    s_add_u32 s29, s25, 11264
    buffer_load_dwordx4 a[44:47], v3, s[8:11], s29 offen
    s_waitcnt lgkmcnt(9)
    v_mfma_f32_16x16x32_bf16 v[60:63], v[108:111], v[144:147], v[60:63]
    ds_read_b64 v[100:101], v18 offset:832
    ds_read_b64 v[102:103], v18 offset:840
    ds_read_b128 v[148:151], v19 offset:3392
    s_waitcnt lgkmcnt(10)
    v_mfma_f32_16x16x32_bf16 v[48:51], v[112:115], v[164:167], v[48:51]
    v_mfma_f32_16x16x32_bf16 v[52:55], v[112:115], v[168:171], v[52:55]
    s_add_u32 m0, s28, 98304
    s_add_u32 s27, s24, 98304
    buffer_load_dwordx4 v3, s[8:11], s27 offen lds
    v_mfma_f32_16x16x32_bf16 v[56:59], v[112:115], v[172:175], v[56:59]
    s_waitcnt lgkmcnt(9)
    v_mfma_f32_16x16x32_bf16 v[60:63], v[112:115], v[160:163], v[60:63]
    ds_read_b64 v[104:105], v18 offset:896
    ds_read_b64 v[106:107], v18 offset:904
    ds_read_b128 v[164:167], v19 offset:3456
    s_waitcnt lgkmcnt(10)
    v_mfma_f32_16x16x32_bf16 v[48:51], v[116:119], v[180:183], v[48:51]
    s_add_u32 s29, s25, 12288
    buffer_load_dwordx4 a[48:51], v3, s[8:11], s29 offen
    v_mfma_f32_16x16x32_bf16 v[52:55], v[116:119], v[184:187], v[52:55]
    v_mfma_f32_16x16x32_bf16 v[56:59], v[116:119], v[188:191], v[56:59]
    s_waitcnt lgkmcnt(9)
    v_mfma_f32_16x16x32_bf16 v[60:63], v[116:119], v[176:179], v[60:63]
    s_add_u32 s29, s25, 13312
    buffer_load_dwordx4 a[52:55], v3, s[8:11], s29 offen
    ds_read_b64 v[108:109], v18 offset:960
    ds_read_b64 v[110:111], v18 offset:968
    ds_read_b128 v[180:183], v19 offset:3520
    s_waitcnt lgkmcnt(10)
    v_mfma_f32_16x16x32_bf16 v[48:51], v[96:99], v[196:199], v[48:51]
    v_mfma_f32_16x16x32_bf16 v[52:55], v[96:99], v[200:203], v[52:55]
    v_mfma_f32_16x16x32_bf16 v[56:59], v[96:99], v[204:207], v[56:59]
    s_add_u32 m0, s28, 102400
    s_add_u32 s27, s24, 102400
    buffer_load_dwordx4 v3, s[8:11], s27 offen lds
    s_waitcnt lgkmcnt(9)
    v_mfma_f32_16x16x32_bf16 v[60:63], v[96:99], v[132:135], v[60:63]
    ds_read_b64 v[112:113], v18 offset:1024
    ds_read_b64 v[114:115], v18 offset:1032
    ds_read_b128 v[192:195], v19 offset:3584
    s_waitcnt lgkmcnt(10)
    v_mfma_f32_16x16x32_bf16 v[48:51], v[100:103], v[212:215], v[48:51]
    v_mfma_f32_16x16x32_bf16 v[52:55], v[100:103], v[216:219], v[52:55]
    s_add_u32 s29, s25, 14336
    buffer_load_dwordx4 a[56:59], v3, s[8:11], s29 offen
    v_mfma_f32_16x16x32_bf16 v[56:59], v[100:103], v[220:223], v[56:59]
    s_waitcnt lgkmcnt(9)
    v_mfma_f32_16x16x32_bf16 v[60:63], v[100:103], v[148:151], v[60:63]
    ds_read_b64 v[116:117], v18 offset:1088
    ds_read_b64 v[118:119], v18 offset:1096
    ds_read_b128 v[196:199], v19 offset:3648
    s_waitcnt lgkmcnt(10)
    v_mfma_f32_16x16x32_bf16 v[48:51], v[104:107], v[228:231], v[48:51]
    s_add_u32 m0, s28, 106496
    s_add_u32 s27, s24, 106496
    buffer_load_dwordx4 v3, s[8:11], s27 offen lds
    v_mfma_f32_16x16x32_bf16 v[52:55], v[104:107], v[232:235], v[52:55]
    v_mfma_f32_16x16x32_bf16 v[56:59], v[104:107], v[236:239], v[56:59]
    s_waitcnt lgkmcnt(9)
    v_mfma_f32_16x16x32_bf16 v[60:63], v[104:107], v[164:167], v[60:63]
    s_add_u32 s29, s25, 15360
    buffer_load_dwordx4 a[60:63], v3, s[8:11], s29 offen
    ds_read_b64 v[96:97], v18 offset:1152
    ds_read_b64 v[98:99], v18 offset:1160
    ds_read_b128 v[208:211], v19 offset:3712
    s_waitcnt lgkmcnt(10)
    v_mfma_f32_16x16x32_bf16 v[48:51], v[108:111], v[244:247], v[48:51]
    v_mfma_f32_16x16x32_bf16 v[52:55], v[108:111], v[248:251], v[52:55]
    v_mfma_f32_16x16x32_bf16 v[56:59], v[108:111], v[252:255], v[56:59]
    s_add_u32 m0, s28, 110592
    s_add_u32 s27, s24, 110592
    buffer_load_dwordx4 v3, s[8:11], s27 offen lds
    s_waitcnt lgkmcnt(9)
    v_mfma_f32_16x16x32_bf16 v[60:63], v[108:111], v[180:183], v[60:63]
    ds_read_b64 v[100:101], v18 offset:1216
    ds_read_b64 v[102:103], v18 offset:1224
    ds_read_b128 v[212:215], v19 offset:3776
    s_waitcnt lgkmcnt(10)
    v_mfma_f32_16x16x32_bf16 v[48:51], v[112:115], v[136:139], v[48:51]
    v_mfma_f32_16x16x32_bf16 v[52:55], v[112:115], v[140:143], v[52:55]
    s_add_u32 s29, s25, 16384
    buffer_load_dwordx4 a[64:67], v3, s[8:11], s29 offen
    v_mfma_f32_16x16x32_bf16 v[56:59], v[112:115], v[128:131], v[56:59]
    s_waitcnt lgkmcnt(9)
    v_mfma_f32_16x16x32_bf16 v[60:63], v[112:115], v[192:195], v[60:63]
    ds_read_b64 v[104:105], v18 offset:1280
    ds_read_b64 v[106:107], v18 offset:1288
    ds_read_b128 v[136:139], v19 offset:3840
    s_waitcnt lgkmcnt(10)
    v_mfma_f32_16x16x32_bf16 v[48:51], v[116:119], v[152:155], v[48:51]
    s_add_u32 m0, s28, 114688
    s_add_u32 s27, s24, 114688
    buffer_load_dwordx4 v3, s[8:11], s27 offen lds
    v_mfma_f32_16x16x32_bf16 v[52:55], v[116:119], v[156:159], v[52:55]
    v_mfma_f32_16x16x32_bf16 v[56:59], v[116:119], v[144:147], v[56:59]
    s_waitcnt lgkmcnt(9)
    v_mfma_f32_16x16x32_bf16 v[60:63], v[116:119], v[196:199], v[60:63]
    s_add_u32 s29, s25, 17408
    buffer_load_dwordx4 a[68:71], v3, s[8:11], s29 offen
    ds_read_b64 v[108:109], v18 offset:1344
    ds_read_b64 v[110:111], v18 offset:1352
    ds_read_b128 v[152:155], v19 offset:3904
    s_waitcnt lgkmcnt(10)
    v_mfma_f32_16x16x32_bf16 v[48:51], v[96:99], v[168:171], v[48:51]
    v_mfma_f32_16x16x32_bf16 v[52:55], v[96:99], v[172:175], v[52:55]
    v_mfma_f32_16x16x32_bf16 v[56:59], v[96:99], v[160:163], v[56:59]
    s_add_u32 m0, s28, 118784
    s_add_u32 s27, s24, 118784
    buffer_load_dwordx4 v3, s[8:11], s27 offen lds
    s_waitcnt lgkmcnt(9)
    v_mfma_f32_16x16x32_bf16 v[60:63], v[96:99], v[208:211], v[60:63]
    ds_read_b64 v[112:113], v18 offset:1408
    ds_read_b64 v[114:115], v18 offset:1416
    ds_read_b128 v[168:171], v19 offset:3968
    s_waitcnt lgkmcnt(10)
    v_mfma_f32_16x16x32_bf16 v[48:51], v[100:103], v[184:187], v[48:51]
    v_mfma_f32_16x16x32_bf16 v[52:55], v[100:103], v[188:191], v[52:55]
    s_add_u32 s29, s25, 18432
    buffer_load_dwordx4 a[72:75], v3, s[8:11], s29 offen
    v_mfma_f32_16x16x32_bf16 v[56:59], v[100:103], v[176:179], v[56:59]
    s_waitcnt lgkmcnt(9)
    v_mfma_f32_16x16x32_bf16 v[60:63], v[100:103], v[212:215], v[60:63]
    ds_read_b64 v[116:117], v18 offset:1472
    ds_read_b64 v[118:119], v18 offset:1480
    ds_read_b128 v[184:187], v19 offset:4032
    s_waitcnt lgkmcnt(10)
    v_mfma_f32_16x16x32_bf16 v[48:51], v[104:107], v[200:203], v[48:51]
    s_add_u32 s29, s25, 19456
    buffer_load_dwordx4 a[76:79], v3, s[8:11], s29 offen
    v_mfma_f32_16x16x32_bf16 v[52:55], v[104:107], v[204:207], v[52:55]
    v_mfma_f32_16x16x32_bf16 v[56:59], v[104:107], v[132:135], v[56:59]
    s_waitcnt lgkmcnt(9)
    v_mfma_f32_16x16x32_bf16 v[60:63], v[104:107], v[136:139], v[60:63]
    s_add_u32 m0, s28, 122880
    s_add_u32 s27, s24, 122880
    buffer_load_dwordx4 v3, s[8:11], s27 offen lds
    ds_read_b64 v[96:97], v18 offset:1536
    ds_read_b64 v[98:99], v18 offset:1544
    s_waitcnt lgkmcnt(9)
    v_mfma_f32_16x16x32_bf16 v[48:51], v[108:111], v[216:219], v[48:51]
    v_mfma_f32_16x16x32_bf16 v[52:55], v[108:111], v[220:223], v[52:55]
    v_mfma_f32_16x16x32_bf16 v[56:59], v[108:111], v[148:151], v[56:59]
    s_add_u32 s29, s25, 20480
    buffer_load_dwordx4 a[80:83], v3, s[8:11], s29 offen
    s_waitcnt lgkmcnt(8)
    v_mfma_f32_16x16x32_bf16 v[60:63], v[108:111], v[152:155], v[60:63]
    ds_read_b64 v[100:101], v18 offset:1600
    ds_read_b64 v[102:103], v18 offset:1608
    s_waitcnt lgkmcnt(8)
    v_mfma_f32_16x16x32_bf16 v[48:51], v[112:115], v[232:235], v[48:51]
    v_mfma_f32_16x16x32_bf16 v[52:55], v[112:115], v[236:239], v[52:55]
    s_add_u32 m0, s28, 126976
    s_add_u32 s27, s24, 126976
    buffer_load_dwordx4 v3, s[8:11], s27 offen lds
    v_mfma_f32_16x16x32_bf16 v[56:59], v[112:115], v[164:167], v[56:59]
    s_waitcnt lgkmcnt(7)
    v_mfma_f32_16x16x32_bf16 v[60:63], v[112:115], v[168:171], v[60:63]
    ds_read_b64 v[104:105], v18 offset:1664
    ds_read_b64 v[106:107], v18 offset:1672
    s_waitcnt lgkmcnt(7)
    v_mfma_f32_16x16x32_bf16 v[48:51], v[116:119], v[248:251], v[48:51]
    s_add_u32 s29, s25, 21504
    buffer_load_dwordx4 a[84:87], v3, s[8:11], s29 offen
    v_mfma_f32_16x16x32_bf16 v[52:55], v[116:119], v[252:255], v[52:55]
    v_mfma_f32_16x16x32_bf16 v[56:59], v[116:119], v[180:183], v[56:59]
    s_waitcnt lgkmcnt(6)
    v_mfma_f32_16x16x32_bf16 v[60:63], v[116:119], v[184:187], v[60:63]
    s_add_u32 m0, s28, 131072
    s_add_u32 s27, s24, 131072
    buffer_load_dwordx4 v3, s[8:11], s27 offen lds
    ds_read_b64 v[108:109], v18 offset:1728
    ds_read_b64 v[110:111], v18 offset:1736
    s_waitcnt lgkmcnt(6)
    v_mfma_f32_16x16x32_bf16 v[48:51], v[96:99], v[140:143], v[48:51]
    v_mfma_f32_16x16x32_bf16 v[52:55], v[96:99], v[128:131], v[52:55]
    v_mfma_f32_16x16x32_bf16 v[56:59], v[96:99], v[192:195], v[56:59]
    s_add_u32 s29, s25, 22528
    buffer_load_dwordx4 a[88:91], v3, s[8:11], s29 offen
    ds_read_b64 v[112:113], v18 offset:1792
    ds_read_b64 v[114:115], v18 offset:1800
    s_waitcnt lgkmcnt(6)
    v_mfma_f32_16x16x32_bf16 v[48:51], v[100:103], v[156:159], v[48:51]
    v_mfma_f32_16x16x32_bf16 v[52:55], v[100:103], v[144:147], v[52:55]
    v_mfma_f32_16x16x32_bf16 v[56:59], v[100:103], v[196:199], v[56:59]
    s_add_u32 m0, s28, 135168
    s_add_u32 s27, s24, 135168
    buffer_load_dwordx4 v3, s[8:11], s27 offen lds
    ds_read_b64 v[116:117], v18 offset:1856
    ds_read_b64 v[118:119], v18 offset:1864
    s_waitcnt lgkmcnt(6)
    v_mfma_f32_16x16x32_bf16 v[48:51], v[104:107], v[172:175], v[48:51]
    v_mfma_f32_16x16x32_bf16 v[52:55], v[104:107], v[160:163], v[52:55]
    v_mfma_f32_16x16x32_bf16 v[56:59], v[104:107], v[208:211], v[56:59]
    s_add_u32 s29, s25, 23552
    buffer_load_dwordx4 a[92:95], v3, s[8:11], s29 offen
    ds_read_b64 v[96:97], v18 offset:1920
    ds_read_b64 v[98:99], v18 offset:1928
    s_waitcnt lgkmcnt(6)
    v_mfma_f32_16x16x32_bf16 v[48:51], v[108:111], v[188:191], v[48:51]
    v_mfma_f32_16x16x32_bf16 v[52:55], v[108:111], v[176:179], v[52:55]
    v_mfma_f32_16x16x32_bf16 v[56:59], v[108:111], v[212:215], v[56:59]
    s_waitcnt vmcnt(44)
    s_add_u32 m0, s28, 139264
    s_add_u32 s27, s24, 139264
    buffer_load_dwordx4 v3, s[8:11], s27 offen lds
    ds_read_b64 v[100:101], v18 offset:1984
    ds_read_b64 v[102:103], v18 offset:1992
    s_waitcnt lgkmcnt(6)
    v_mfma_f32_16x16x32_bf16 v[48:51], v[112:115], v[204:207], v[48:51]
    v_mfma_f32_16x16x32_bf16 v[52:55], v[112:115], v[132:135], v[52:55]
    v_mfma_f32_16x16x32_bf16 v[56:59], v[112:115], v[136:139], v[56:59]
    s_add_u32 s29, s25, 24576
    buffer_load_dwordx4 a[96:99], v3, s[8:11], s29 offen
    ds_read_b64 v[104:105], v18 offset:2048
    ds_read_b64 v[106:107], v18 offset:2056
    s_waitcnt lgkmcnt(6)
    v_mfma_f32_16x16x32_bf16 v[48:51], v[116:119], v[220:223], v[48:51]
    v_mfma_f32_16x16x32_bf16 v[52:55], v[116:119], v[148:151], v[52:55]
    v_mfma_f32_16x16x32_bf16 v[56:59], v[116:119], v[152:155], v[56:59]
    s_add_u32 s29, s25, 25600
    buffer_load_dwordx4 a[100:103], v3, s[8:11], s29 offen
    ds_read_b64 v[108:109], v18 offset:2112
    ds_read_b64 v[110:111], v18 offset:2120
    s_waitcnt lgkmcnt(6)
    v_mfma_f32_16x16x32_bf16 v[48:51], v[96:99], v[236:239], v[48:51]
    v_mfma_f32_16x16x32_bf16 v[52:55], v[96:99], v[164:167], v[52:55]
    v_mfma_f32_16x16x32_bf16 v[56:59], v[96:99], v[168:171], v[56:59]
    s_add_u32 m0, s28, 143360
    s_add_u32 s27, s24, 143360
    buffer_load_dwordx4 v3, s[8:11], s27 offen lds
    ds_read_b64 v[112:113], v18 offset:2176
    ds_read_b64 v[114:115], v18 offset:2184
    s_waitcnt lgkmcnt(6)
    v_mfma_f32_16x16x32_bf16 v[48:51], v[100:103], v[252:255], v[48:51]
    v_mfma_f32_16x16x32_bf16 v[52:55], v[100:103], v[180:183], v[52:55]
    v_mfma_f32_16x16x32_bf16 v[56:59], v[100:103], v[184:187], v[56:59]
    s_waitcnt vmcnt(44)
    s_add_u32 s29, s25, 26624
    buffer_load_dwordx4 a[104:107], v3, s[8:11], s29 offen
    ds_read_b64 v[116:117], v18 offset:2240
    ds_read_b64 v[118:119], v18 offset:2248
    s_waitcnt lgkmcnt(6)
    v_mfma_f32_16x16x32_bf16 v[48:51], v[104:107], v[128:131], v[48:51]
    v_mfma_f32_16x16x32_bf16 v[52:55], v[104:107], v[192:195], v[52:55]
    ds_read_b64 v[96:97], v18 offset:2304
    ds_read_b64 v[98:99], v18 offset:2312
    s_waitcnt lgkmcnt(6)
    v_mfma_f32_16x16x32_bf16 v[48:51], v[108:111], v[144:147], v[48:51]
    s_add_u32 m0, s28, 147456
    s_add_u32 s27, s24, 147456
    buffer_load_dwordx4 v3, s[8:11], s27 offen lds
    v_mfma_f32_16x16x32_bf16 v[52:55], v[108:111], v[196:199], v[52:55]
    ds_read_b64 v[100:101], v18 offset:2368
    ds_read_b64 v[102:103], v18 offset:2376
    s_waitcnt lgkmcnt(6)
    v_mfma_f32_16x16x32_bf16 v[48:51], v[112:115], v[160:163], v[48:51]
    v_mfma_f32_16x16x32_bf16 v[52:55], v[112:115], v[208:211], v[52:55]
    s_add_u32 s29, s25, 27648
    buffer_load_dwordx4 a[108:111], v3, s[8:11], s29 offen
    ds_read_b64 v[104:105], v18 offset:2432
    ds_read_b64 v[106:107], v18 offset:2440
    s_waitcnt lgkmcnt(6)
    v_mfma_f32_16x16x32_bf16 v[48:51], v[116:119], v[176:179], v[48:51]
    v_mfma_f32_16x16x32_bf16 v[52:55], v[116:119], v[212:215], v[52:55]
    ds_read_b64 v[108:109], v18 offset:2496
    ds_read_b64 v[110:111], v18 offset:2504
    s_waitcnt lgkmcnt(6)
    v_mfma_f32_16x16x32_bf16 v[48:51], v[96:99], v[132:135], v[48:51]
    s_add_u32 m0, s28, 151552
    s_add_u32 s27, s24, 151552
    buffer_load_dwordx4 v3, s[8:11], s27 offen lds
    v_mfma_f32_16x16x32_bf16 v[52:55], v[96:99], v[136:139], v[52:55]
    ds_read_b64 v[112:113], v18 offset:2560
    ds_read_b64 v[114:115], v18 offset:2568
    s_waitcnt lgkmcnt(6)
    v_mfma_f32_16x16x32_bf16 v[48:51], v[100:103], v[148:151], v[48:51]
    v_mfma_f32_16x16x32_bf16 v[52:55], v[100:103], v[152:155], v[52:55]
    s_waitcnt vmcnt(44)
    s_add_u32 s29, s25, 35840
    buffer_load_dwordx4 a[112:115], v3, s[8:11], s29 offen
    ds_read_b64 v[116:117], v18 offset:2624
    ds_read_b64 v[118:119], v18 offset:2632
    s_waitcnt lgkmcnt(6)
    v_mfma_f32_16x16x32_bf16 v[48:51], v[104:107], v[164:167], v[48:51]
    v_mfma_f32_16x16x32_bf16 v[52:55], v[104:107], v[168:171], v[52:55]
    ds_read_b64 v[96:97], v18 offset:2688
    ds_read_b64 v[98:99], v18 offset:2696
    s_waitcnt lgkmcnt(6)
    v_mfma_f32_16x16x32_bf16 v[48:51], v[108:111], v[180:183], v[48:51]
    s_add_u32 m0, s28, 155648
    s_add_u32 s27, s24, 155648
    buffer_load_dwordx4 v3, s[8:11], s27 offen lds
    v_mfma_f32_16x16x32_bf16 v[52:55], v[108:111], v[184:187], v[52:55]
    ds_read_b64 v[100:101], v18 offset:2752
    ds_read_b64 v[102:103], v18 offset:2760
    s_waitcnt lgkmcnt(6)
    v_mfma_f32_16x16x32_bf16 v[48:51], v[112:115], v[192:195], v[48:51]
    ds_read_b64 v[104:105], v18 offset:2816
    ds_read_b64 v[106:107], v18 offset:2824
    s_waitcnt lgkmcnt(6)
    v_mfma_f32_16x16x32_bf16 v[48:51], v[116:119], v[196:199], v[48:51]
    s_add_u32 s29, s25, 36864
    buffer_load_dwordx4 a[116:119], v3, s[8:11], s29 offen
    ds_read_b64 v[108:109], v18 offset:2880
    ds_read_b64 v[110:111], v18 offset:2888
    s_waitcnt lgkmcnt(6)
    v_mfma_f32_16x16x32_bf16 v[48:51], v[96:99], v[208:211], v[48:51]
    ds_read_b64 v[112:113], v18 offset:2944
    ds_read_b64 v[114:115], v18 offset:2952
    s_waitcnt lgkmcnt(6)
    v_mfma_f32_16x16x32_bf16 v[48:51], v[100:103], v[212:215], v[48:51]
    ds_read_b64 v[116:117], v18 offset:3008
    ds_read_b64 v[118:119], v18 offset:3016
    s_waitcnt lgkmcnt(6)
    v_mfma_f32_16x16x32_bf16 v[48:51], v[104:107], v[136:139], v[48:51]
    s_waitcnt lgkmcnt(4)
    v_mfma_f32_16x16x32_bf16 v[48:51], v[108:111], v[152:155], v[48:51]
    s_waitcnt lgkmcnt(2)
    v_mfma_f32_16x16x32_bf16 v[48:51], v[112:115], v[168:171], v[48:51]
    s_waitcnt lgkmcnt(0)
    v_mfma_f32_16x16x32_bf16 v[48:51], v[116:119], v[184:187], v[48:51]
    s_nop 7
    ds_read_b64 v[64:65], v20 offset:2560
    ds_read_b64 v[66:67], v20 offset:2048
    ds_read_b64 v[68:69], v20 offset:1536
    ds_read_b64 v[70:71], v20 offset:1024
    s_waitcnt lgkmcnt(3)
    v_lshlrev_b32 v72, 16, v64
    v_and_b32 v73, 0xffff0000, v64
    v_lshlrev_b32 v74, 16, v65
    v_and_b32 v75, 0xffff0000, v65
    v_mul_f32 v72, s66, v72
    v_mul_f32 v73, s66, v73
    v_mul_f32 v74, s66, v74
    v_mul_f32 v75, s66, v75
    v_cvt_pk_bf16_f32 v76, v72, v73
    v_cvt_pk_bf16_f32 v77, v74, v75
    v_cvt_pk_bf16_f32 v78, v48, v49
    v_cvt_pk_bf16_f32 v79, v50, v51
    v_lshlrev_b32 v72, 16, v76
    v_lshlrev_b32 v80, 16, v78
    v_and_b32 v73, 0xffff0000, v76
    v_and_b32 v81, 0xffff0000, v78
    v_lshlrev_b32 v74, 16, v77
    v_lshlrev_b32 v82, 16, v79
    v_and_b32 v75, 0xffff0000, v77
    v_and_b32 v83, 0xffff0000, v79
    v_add_f32 v72, v72, v80
    v_add_f32 v73, v73, v81
    v_add_f32 v74, v74, v82
    v_add_f32 v75, v75, v83
    v_cvt_pk_bf16_f32 v84, v72, v73
    v_cvt_pk_bf16_f32 v85, v74, v75
    v_min_u32 v84, 0xfffffffe, v84
    v_min_u32 v85, 0xfffffffe, v85
    s_waitcnt lgkmcnt(2)
    v_lshlrev_b32 v72, 16, v66
    v_and_b32 v73, 0xffff0000, v66
    v_lshlrev_b32 v74, 16, v67
    v_and_b32 v75, 0xffff0000, v67
    v_mul_f32 v72, s66, v72
    v_mul_f32 v73, s66, v73
    v_mul_f32 v74, s66, v74
    v_mul_f32 v75, s66, v75
    v_cvt_pk_bf16_f32 v76, v72, v73
    v_cvt_pk_bf16_f32 v77, v74, v75
    v_cvt_pk_bf16_f32 v78, v52, v53
    v_cvt_pk_bf16_f32 v79, v54, v55
    v_lshlrev_b32 v72, 16, v76
    v_lshlrev_b32 v80, 16, v78
    v_and_b32 v73, 0xffff0000, v76
    v_and_b32 v81, 0xffff0000, v78
    v_lshlrev_b32 v74, 16, v77
    v_lshlrev_b32 v82, 16, v79
    v_and_b32 v75, 0xffff0000, v77
    v_and_b32 v83, 0xffff0000, v79
    v_add_f32 v72, v72, v80
    v_add_f32 v73, v73, v81
    v_add_f32 v74, v74, v82
    v_add_f32 v75, v75, v83
    v_cvt_pk_bf16_f32 v86, v72, v73
    v_cvt_pk_bf16_f32 v87, v74, v75
    v_min_u32 v86, 0xfffffffe, v86
    v_min_u32 v87, 0xfffffffe, v87
    s_nop 0
    v_permlane16_swap_b32 v84, v86
    v_permlane16_swap_b32 v85, v87
    buffer_store_dwordx4 v[84:87], v21, s[8:11], s48 offen offset:2048 sc1
    s_waitcnt lgkmcnt(1)
    v_lshlrev_b32 v72, 16, v68
    v_and_b32 v73, 0xffff0000, v68
    v_lshlrev_b32 v74, 16, v69
    v_and_b32 v75, 0xffff0000, v69
    v_mul_f32 v72, s66, v72
    v_mul_f32 v73, s66, v73
    v_mul_f32 v74, s66, v74
    v_mul_f32 v75, s66, v75
    v_cvt_pk_bf16_f32 v76, v72, v73
    v_cvt_pk_bf16_f32 v77, v74, v75
    v_cvt_pk_bf16_f32 v78, v56, v57
    v_cvt_pk_bf16_f32 v79, v58, v59
    v_lshlrev_b32 v72, 16, v76
    v_lshlrev_b32 v80, 16, v78
    v_and_b32 v73, 0xffff0000, v76
    v_and_b32 v81, 0xffff0000, v78
    v_lshlrev_b32 v74, 16, v77
    v_lshlrev_b32 v82, 16, v79
    v_and_b32 v75, 0xffff0000, v77
    v_and_b32 v83, 0xffff0000, v79
    v_add_f32 v72, v72, v80
    v_add_f32 v73, v73, v81
    v_add_f32 v74, v74, v82
    v_add_f32 v75, v75, v83
    v_cvt_pk_bf16_f32 v88, v72, v73
    v_cvt_pk_bf16_f32 v89, v74, v75
    v_min_u32 v88, 0xfffffffe, v88
    v_min_u32 v89, 0xfffffffe, v89
    s_waitcnt lgkmcnt(0)
    v_lshlrev_b32 v72, 16, v70
    v_and_b32 v73, 0xffff0000, v70
    v_lshlrev_b32 v74, 16, v71
    v_and_b32 v75, 0xffff0000, v71
    v_mul_f32 v72, s66, v72
    v_mul_f32 v73, s66, v73
    v_mul_f32 v74, s66, v74
    v_mul_f32 v75, s66, v75
    v_cvt_pk_bf16_f32 v76, v72, v73
    v_cvt_pk_bf16_f32 v77, v74, v75
    v_cvt_pk_bf16_f32 v78, v60, v61
    v_cvt_pk_bf16_f32 v79, v62, v63
    v_lshlrev_b32 v72, 16, v76
    v_lshlrev_b32 v80, 16, v78
    v_and_b32 v73, 0xffff0000, v76
    v_and_b32 v81, 0xffff0000, v78
    v_lshlrev_b32 v74, 16, v77
    v_lshlrev_b32 v82, 16, v79
    v_and_b32 v75, 0xffff0000, v77
    v_and_b32 v83, 0xffff0000, v79
    v_add_f32 v72, v72, v80
    v_add_f32 v73, v73, v81
    v_add_f32 v74, v74, v82
    v_add_f32 v75, v75, v83
    v_cvt_pk_bf16_f32 v90, v72, v73
    v_cvt_pk_bf16_f32 v91, v74, v75
    v_min_u32 v90, 0xfffffffe, v90
    v_min_u32 v91, 0xfffffffe, v91
    s_nop 0
    v_permlane16_swap_b32 v88, v90
    v_permlane16_swap_b32 v89, v91
    buffer_store_dwordx4 v[88:91], v21, s[8:11], s48 offen offset:1024 sc1
    s_branch cv_join
cv_idle:
    s_add_u32 m0, s28, 57344
    s_add_u32 s27, s24, 57344
    buffer_load_dwordx4 v3, s[8:11], s27 offen lds
    s_add_u32 s29, s25, 0
    buffer_load_dwordx4 a[0:3], v3, s[8:11], s29 offen
    s_add_u32 s29, s25, 1024
    buffer_load_dwordx4 a[4:7], v3, s[8:11], s29 offen
    s_add_u32 m0, s28, 61440
    s_add_u32 s27, s24, 61440
    buffer_load_dwordx4 v3, s[8:11], s27 offen lds
    s_add_u32 s29, s25, 2048
    buffer_load_dwordx4 a[8:11], v3, s[8:11], s29 offen
    s_add_u32 m0, s28, 65536
    s_add_u32 s27, s24, 65536
    buffer_load_dwordx4 v3, s[8:11], s27 offen lds
    s_add_u32 s29, s25, 3072
    buffer_load_dwordx4 a[12:15], v3, s[8:11], s29 offen
    s_add_u32 m0, s28, 69632
    s_add_u32 s27, s24, 69632
    buffer_load_dwordx4 v3, s[8:11], s27 offen lds
    s_add_u32 s29, s25, 4096
    buffer_load_dwordx4 a[16:19], v3, s[8:11], s29 offen
    s_add_u32 m0, s28, 73728
    s_add_u32 s27, s24, 73728
    buffer_load_dwordx4 v3, s[8:11], s27 offen lds
    s_add_u32 s29, s25, 5120
    buffer_load_dwordx4 a[20:23], v3, s[8:11], s29 offen
    s_add_u32 m0, s28, 77824
    s_add_u32 s27, s24, 77824
    buffer_load_dwordx4 v3, s[8:11], s27 offen lds
    s_add_u32 s29, s25, 6144
    buffer_load_dwordx4 a[24:27], v3, s[8:11], s29 offen
    s_add_u32 s29, s25, 7168
    buffer_load_dwordx4 a[28:31], v3, s[8:11], s29 offen
    s_add_u32 m0, s28, 81920
    s_add_u32 s27, s24, 81920
    buffer_load_dwordx4 v3, s[8:11], s27 offen lds
    s_add_u32 s29, s25, 8192
    buffer_load_dwordx4 a[32:35], v3, s[8:11], s29 offen
    s_add_u32 m0, s28, 86016
    s_add_u32 s27, s24, 86016
    buffer_load_dwordx4 v3, s[8:11], s27 offen lds
    s_add_u32 s29, s25, 9216
    buffer_load_dwordx4 a[36:39], v3, s[8:11], s29 offen
    s_add_u32 m0, s28, 90112
    s_add_u32 s27, s24, 90112
    buffer_load_dwordx4 v3, s[8:11], s27 offen lds
    s_add_u32 s29, s25, 10240
    buffer_load_dwordx4 a[40:43], v3, s[8:11], s29 offen
    s_add_u32 m0, s28, 94208
    s_add_u32 s27, s24, 94208
    buffer_load_dwordx4 v3, s[8:11], s27 offen lds
    s_add_u32 s29, s25, 11264
    buffer_load_dwordx4 a[44:47], v3, s[8:11], s29 offen
    s_add_u32 m0, s28, 98304
    s_add_u32 s27, s24, 98304
    buffer_load_dwordx4 v3, s[8:11], s27 offen lds
    s_add_u32 s29, s25, 12288
    buffer_load_dwordx4 a[48:51], v3, s[8:11], s29 offen
    s_add_u32 s29, s25, 13312
    buffer_load_dwordx4 a[52:55], v3, s[8:11], s29 offen
    s_add_u32 m0, s28, 102400
    s_add_u32 s27, s24, 102400
    buffer_load_dwordx4 v3, s[8:11], s27 offen lds
    s_add_u32 s29, s25, 14336
    buffer_load_dwordx4 a[56:59], v3, s[8:11], s29 offen
    s_add_u32 m0, s28, 106496
    s_add_u32 s27, s24, 106496
    buffer_load_dwordx4 v3, s[8:11], s27 offen lds
    s_add_u32 s29, s25, 15360
    buffer_load_dwordx4 a[60:63], v3, s[8:11], s29 offen
    s_add_u32 m0, s28, 110592
    s_add_u32 s27, s24, 110592
    buffer_load_dwordx4 v3, s[8:11], s27 offen lds
    s_add_u32 s29, s25, 16384
    buffer_load_dwordx4 a[64:67], v3, s[8:11], s29 offen
    s_add_u32 m0, s28, 114688
    s_add_u32 s27, s24, 114688
    buffer_load_dwordx4 v3, s[8:11], s27 offen lds
    s_add_u32 s29, s25, 17408
    buffer_load_dwordx4 a[68:71], v3, s[8:11], s29 offen
    s_add_u32 m0, s28, 118784
    s_add_u32 s27, s24, 118784
    buffer_load_dwordx4 v3, s[8:11], s27 offen lds
    s_add_u32 s29, s25, 18432
    buffer_load_dwordx4 a[72:75], v3, s[8:11], s29 offen
    s_add_u32 s29, s25, 19456
    buffer_load_dwordx4 a[76:79], v3, s[8:11], s29 offen
    s_add_u32 m0, s28, 122880
    s_add_u32 s27, s24, 122880
    buffer_load_dwordx4 v3, s[8:11], s27 offen lds
    s_add_u32 s29, s25, 20480
    buffer_load_dwordx4 a[80:83], v3, s[8:11], s29 offen
    s_add_u32 m0, s28, 126976
    s_add_u32 s27, s24, 126976
    buffer_load_dwordx4 v3, s[8:11], s27 offen lds
    s_add_u32 s29, s25, 21504
    buffer_load_dwordx4 a[84:87], v3, s[8:11], s29 offen
    s_add_u32 m0, s28, 131072
    s_add_u32 s27, s24, 131072
    buffer_load_dwordx4 v3, s[8:11], s27 offen lds
    s_add_u32 s29, s25, 22528
    buffer_load_dwordx4 a[88:91], v3, s[8:11], s29 offen
    s_add_u32 m0, s28, 135168
    s_add_u32 s27, s24, 135168
    buffer_load_dwordx4 v3, s[8:11], s27 offen lds
    s_add_u32 s29, s25, 23552
    buffer_load_dwordx4 a[92:95], v3, s[8:11], s29 offen
    s_waitcnt vmcnt(44)
    s_add_u32 m0, s28, 139264
    s_add_u32 s27, s24, 139264
    buffer_load_dwordx4 v3, s[8:11], s27 offen lds
    s_add_u32 s29, s25, 24576
    buffer_load_dwordx4 a[96:99], v3, s[8:11], s29 offen
    s_add_u32 s29, s25, 25600
    buffer_load_dwordx4 a[100:103], v3, s[8:11], s29 offen
    s_add_u32 m0, s28, 143360
    s_add_u32 s27, s24, 143360
    buffer_load_dwordx4 v3, s[8:11], s27 offen lds
    s_waitcnt vmcnt(44)
    s_add_u32 s29, s25, 26624
    buffer_load_dwordx4 a[104:107], v3, s[8:11], s29 offen
    s_add_u32 m0, s28, 147456
    s_add_u32 s27, s24, 147456
    buffer_load_dwordx4 v3, s[8:11], s27 offen lds
    s_add_u32 s29, s25, 27648
    buffer_load_dwordx4 a[108:111], v3, s[8:11], s29 offen
    s_add_u32 m0, s28, 151552
    s_add_u32 s27, s24, 151552
    buffer_load_dwordx4 v3, s[8:11], s27 offen lds
    s_waitcnt vmcnt(44)
    s_add_u32 s29, s25, 35840
    buffer_load_dwordx4 a[112:115], v3, s[8:11], s29 offen
    s_add_u32 m0, s28, 155648
    s_add_u32 s27, s24, 155648
    buffer_load_dwordx4 v3, s[8:11], s27 offen lds
    s_add_u32 s29, s25, 36864
    buffer_load_dwordx4 a[116:119], v3, s[8:11], s29 offen
cv_join:
    s_waitcnt vmcnt(0) lgkmcnt(0)
    s_barrier
    s_lshl_b32 s49, s2, 8
    s_add_u32 s49, s49, 32636928
    s_cmp_eq_u32 s3, 0
    s_cselect_b32 s49, s49, 2147483648
    v_mov_b32 v14, 1
    v_mov_b32 v13, 0
    s_mov_b64 exec, 1
    buffer_store_dword v14, v13, s[8:11], s49 offen sc1
    s_mov_b64 exec, -1
    s_add_u32 m0, s28, 0
    s_add_u32 s27, s24, 0
    buffer_load_dwordx4 v3, s[8:11], s27 offen lds
    s_add_u32 m0, s28, 4096
    s_add_u32 s27, s24, 4096
    buffer_load_dwordx4 v3, s[8:11], s27 offen lds
    s_add_u32 m0, s28, 8192
    s_add_u32 s27, s24, 8192
    buffer_load_dwordx4 v3, s[8:11], s27 offen lds
    s_add_u32 m0, s28, 12288
    s_add_u32 s27, s24, 12288
    buffer_load_dwordx4 v3, s[8:11], s27 offen lds
    s_add_u32 m0, s28, 16384
    s_add_u32 s27, s24, 16384
    buffer_load_dwordx4 v3, s[8:11], s27 offen lds
    s_add_u32 m0, s28, 20480
    s_add_u32 s27, s24, 20480
    buffer_load_dwordx4 v3, s[8:11], s27 offen lds
    s_add_u32 m0, s28, 24576
    s_add_u32 s27, s24, 24576
    buffer_load_dwordx4 v3, s[8:11], s27 offen lds
    s_add_u32 m0, s28, 28672
    s_add_u32 s27, s24, 28672
    buffer_load_dwordx4 v3, s[8:11], s27 offen lds
    s_add_u32 m0, s28, 32768
    s_add_u32 s27, s24, 32768
    buffer_load_dwordx4 v3, s[8:11], s27 offen lds
    v_lshlrev_b32 v6, 4, v0
    v_add_u32 v7, 4096, v6
    v_cmp_gt_u32 vcc, 192, v0
    v_mov_b32 v8, 2147483648
    s_nop 0
    v_cndmask_b32 v7, v8, v7, vcc
    v_and_b32 v11, 31, v2
    v_mul_u32_u24 v13, 896, v11
    v_lshrrev_b32 v14, 5, v2
    v_lshl_add_u32 v13, v14, 4, v13
    v_lshl_add_u32 v13, v1, 5, v13
    v_add_u32 v14, 128, v13
    v_cndmask_b32 v14, v8, v14, vcc
    s_mul_i32 s26, s21, 28672
    s_mul_i32 s27, s22, 224
    s_add_u32 s26, s26, s27
    buffer_load_dwordx4 v[32:35], v13, s[44:47], s26 offen
    buffer_load_dwordx4 v[36:39], v14, s[44:47], s26 offen
    v_lshlrev_b32 v11, 3, v11
    s_lshl_b32 s26, s21, 8
    s_add_u32 s26, s26, 2097152
    buffer_load_dwordx2 v[40:41], v11, s[8:11], s26 offen
    v_and_b32 v253, 15, v2
    v_lshlrev_b32 v253, 8, v253
    buffer_load_dword v252, v253, s[8:11], s40 offen sc1
    s_mov_b32 s12, s6
    s_mov_b32 s13, s7
    s_mov_b32 s14, 1835008
    s_mov_b32 s15, 0x00020000
    v_add_u32 v4, 65536, v3
    v_add_u32 v5, 131072, v3
    v_lshrrev_b32 v12, 5, v2
    v_mul_u32_u24 v12, 7168, v12
    v_bfe_u32 v13, v2, 4, 1
    v_lshl_add_u32 v12, v13, 9, v12
    v_and_b32 v13, 15, v2
    v_lshl_add_u32 v12, v13, 4, v12
    s_lshl_b32 s20, s20, 2
    s_add_u32 s20, s20, s3
    s_mul_i32 s23, s20, 28672
    s_add_u32 s23, s23, 8388608
    s_mul_i32 s25, s22, 56
    s_mul_i32 s26, s3, 14
    s_add_u32 s25, s25, s26
    s_mul_i32 s25, s25, 7168
    s_add_u32 s25, s25, 29360128
    s_mul_i32 s30, s21, 112
    s_mul_i32 s26, s3, 28
    s_add_u32 s30, s30, s26
    s_lshl_b32 s30, s30, 10
    s_add_u32 s30, s30, 16777216
    s_lshl_b32 s32, s21, 12
    s_lshl_b32 s26, s3, 10
    s_add_u32 s32, s32, s26
    s_add_u32 s32, s32, 31719424
    s_lshl_b32 s34, s20, 12
    s_lshl_b32 s26, s18, 8
    s_add_u32 s34, s34, s26
    s_add_u32 s34, s34, 31719424
    s_mul_i32 s36, s20, 112
    s_mul_i32 s26, s18, 7
    s_add_u32 s36, s36, s26
    s_lshl_b32 s36, s36, 10
    s_add_u32 s36, s36, 16777216
    s_lshl_b32 s26, s22, 2
    s_add_u32 s26, s26, s3
    s_lshl_b32 s38, s21, 12
    s_lshl_b32 s27, s26, 8
    s_add_u32 s38, s38, s27
    v_bfe_u32 v14, v2, 3, 1
    v_lshlrev_b32 v14, 2, v14
    v_add_u32 v14, s3, v14
    v_cmp_gt_u32 vcc, 7, v14
    s_nop 1
    v_cndmask_b32 v14, 3, v14, vcc
    v_and_b32 v15, 7, v2
    v_lshl_add_u32 v14, v14, 3, v15
    v_lshlrev_b32 v84, 8, v14
    s_mul_i32 s51, s22, 14336
    s_add_u32 s51, s51, 32636928
    v_lshrrev_b32 v9, 2, v2
    v_mul_u32_u24 v9, 4352, v9
    v_and_b32 v10, 3, v2
    v_lshl_add_u32 v9, v10, 4, v9
    s_mul_i32 s50, s22, 112
    s_lshl_b32 s27, s3, 4
    s_add_u32 s50, s50, s27
    s_mul_i32 s50, s50, 4352
    s_lshl_b32 s27, s21, 6
    s_add_u32 s50, s50, s27
    s_add_u32 s50, s50, 10485760
    s_add_u32 s49, s50, 278528
    s_cmp_eq_u32 s3, 3
    s_cselect_b32 s49, 2147483648, s49
    v_add_u32 v13, 159744, v3
    v_add_u32 v13, s28, v13
    v_lshrrev_b32 v14, 5, v2
    v_bfe_u32 v15, v2, 2, 2
    v_lshl_add_u32 v14, v14, 3, v15
    v_lshlrev_b32 v14, 6, v14
    v_bfe_u32 v15, v2, 4, 1
    v_lshl_add_u32 v14, v15, 5, v14
    v_lshl_add_u32 v14, v10, 3, v14
    v_add_u32 v14, 159744, v14
    v_add_u32 v14, s28, v14
    v_lshrrev_b32 v15, 5, v2
    v_lshl_add_u32 v10, v15, 11, v11
    s_waitcnt vmcnt(0)
    s_mov_b32 s61, 0
ffn_kernelf_xcl2:
    v_cmp_eq_u32 vcc, 0, v252
    s_add_u32 s61, s61, 1
    s_cmp_eq_u64 vcc, 0
    s_cbranch_scc1 ffn_kernelf_xcok1
    s_cmp_ge_u32 s61, 4000
    s_cbranch_scc1 ffn_kernelf_xcok1
    s_sleep 1
    buffer_load_dword v252, v253, s[8:11], s40 offen sc1
    s_waitcnt vmcnt(0)
    s_branch ffn_kernelf_xcl2
ffn_kernelf_xcok1:
    v_cmp_ne_u32 vcc, s41, v252
    s_nop 1
    s_cmp_eq_u64 vcc, 0
    s_cbranch_scc0 ffn_slow_T
    buffer_load_dword v85, v84, s[8:11], s51 offen sc1
    v_mov_b32 v42, v40
    v_mov_b32 v43, v40
    v_mov_b32 v40, v41
    v_lshlrev_b32 v68, 16, v32
    v_and_b32 v69, 0xffff0000, v32
    v_pk_add_f32 v[52:53], v[68:69], v[42:43] neg_lo:[0,1] neg_hi:[0,1]
    v_cvt_pk_bf16_f32 v15, v52, v53
    v_lshlrev_b32 v52, 16, v15
    v_and_b32 v53, 0xffff0000, v15
    v_pk_mul_f32 v[52:53], v[52:53], v[40:41]
    v_cvt_pk_bf16_f32 v15, v52, v53
    v_lshlrev_b32 v52, 16, v15
    v_and_b32 v53, 0xffff0000, v15
    v_lshlrev_b32 v70, 16, v33
    v_and_b32 v71, 0xffff0000, v33
    v_pk_add_f32 v[54:55], v[70:71], v[42:43] neg_lo:[0,1] neg_hi:[0,1]
    v_cvt_pk_bf16_f32 v15, v54, v55
    v_lshlrev_b32 v54, 16, v15
    v_and_b32 v55, 0xffff0000, v15
    v_pk_mul_f32 v[54:55], v[54:55], v[40:41]
    v_cvt_pk_bf16_f32 v15, v54, v55
    v_lshlrev_b32 v54, 16, v15
    v_and_b32 v55, 0xffff0000, v15
    v_lshlrev_b32 v72, 16, v34
    v_and_b32 v73, 0xffff0000, v34
    v_pk_add_f32 v[56:57], v[72:73], v[42:43] neg_lo:[0,1] neg_hi:[0,1]
    v_cvt_pk_bf16_f32 v15, v56, v57
    v_lshlrev_b32 v56, 16, v15
    v_and_b32 v57, 0xffff0000, v15
    v_pk_mul_f32 v[56:57], v[56:57], v[40:41]
    v_cvt_pk_bf16_f32 v15, v56, v57
    v_lshlrev_b32 v56, 16, v15
    v_and_b32 v57, 0xffff0000, v15
    v_lshlrev_b32 v74, 16, v35
    v_and_b32 v75, 0xffff0000, v35
    v_pk_add_f32 v[58:59], v[74:75], v[42:43] neg_lo:[0,1] neg_hi:[0,1]
    v_cvt_pk_bf16_f32 v15, v58, v59
    v_lshlrev_b32 v58, 16, v15
    v_and_b32 v59, 0xffff0000, v15
    v_pk_mul_f32 v[58:59], v[58:59], v[40:41]
    v_cvt_pk_bf16_f32 v15, v58, v59
    v_lshlrev_b32 v58, 16, v15
    v_and_b32 v59, 0xffff0000, v15
    v_lshlrev_b32 v76, 16, v36
    v_and_b32 v77, 0xffff0000, v36
    v_pk_add_f32 v[60:61], v[76:77], v[42:43] neg_lo:[0,1] neg_hi:[0,1]
    v_cvt_pk_bf16_f32 v15, v60, v61
    v_lshlrev_b32 v60, 16, v15
    v_and_b32 v61, 0xffff0000, v15
    v_pk_mul_f32 v[60:61], v[60:61], v[40:41]
    v_cvt_pk_bf16_f32 v15, v60, v61
    v_lshlrev_b32 v60, 16, v15
    v_and_b32 v61, 0xffff0000, v15
    v_lshlrev_b32 v78, 16, v37
    v_and_b32 v79, 0xffff0000, v37
    v_pk_add_f32 v[62:63], v[78:79], v[42:43] neg_lo:[0,1] neg_hi:[0,1]
    v_cvt_pk_bf16_f32 v15, v62, v63
    v_lshlrev_b32 v62, 16, v15
    v_and_b32 v63, 0xffff0000, v15
    v_pk_mul_f32 v[62:63], v[62:63], v[40:41]
    v_cvt_pk_bf16_f32 v15, v62, v63
    v_lshlrev_b32 v62, 16, v15
    v_and_b32 v63, 0xffff0000, v15
    v_lshlrev_b32 v80, 16, v38
    v_and_b32 v81, 0xffff0000, v38
    v_pk_add_f32 v[64:65], v[80:81], v[42:43] neg_lo:[0,1] neg_hi:[0,1]
    v_cvt_pk_bf16_f32 v15, v64, v65
    v_lshlrev_b32 v64, 16, v15
    v_and_b32 v65, 0xffff0000, v15
    v_pk_mul_f32 v[64:65], v[64:65], v[40:41]
    v_cvt_pk_bf16_f32 v15, v64, v65
    v_lshlrev_b32 v64, 16, v15
    v_and_b32 v65, 0xffff0000, v15
    v_lshlrev_b32 v82, 16, v39
    v_and_b32 v83, 0xffff0000, v39
    v_pk_add_f32 v[66:67], v[82:83], v[42:43] neg_lo:[0,1] neg_hi:[0,1]
    v_cvt_pk_bf16_f32 v15, v66, v67
    v_lshlrev_b32 v66, 16, v15
    v_and_b32 v67, 0xffff0000, v15
    v_pk_mul_f32 v[66:67], v[66:67], v[40:41]
    v_cvt_pk_bf16_f32 v15, v66, v67
    v_lshlrev_b32 v66, 16, v15
    v_and_b32 v67, 0xffff0000, v15
    s_waitcnt vmcnt(0)
    s_mov_b32 s61, 0
ffn_kernelf_cfl4:
    v_cmp_eq_u32 vcc, 0, v85
    s_add_u32 s61, s61, 1
    s_cmp_eq_u64 vcc, 0
    s_cbranch_scc1 ffn_kernelf_cfok3
    s_cmp_ge_u32 s61, 4000
    s_cbranch_scc1 ffn_kernelf_cfok3
    s_sleep 2
    buffer_load_dword v85, v84, s[8:11], s51 offen sc1
    s_waitcnt vmcnt(0)
    s_branch ffn_kernelf_cfl4
ffn_kernelf_cfok3:
    buffer_load_dwordx4 v[24:27], v9, s[8:11], s50 offen sc1
    buffer_load_dwordx4 v[28:31], v9, s[8:11], s49 offen sc1
    s_add_u32 s26, s37, 8388608
    s_add_u32 s27, s37, 6291456
    s_waitcnt vmcnt(1)
    ds_write_b128 v13, v[24:27]
    s_waitcnt lgkmcnt(0)
    ds_read_b64_tr_b16 v[44:45], v14
    ds_read_b64_tr_b16 v[46:47], v14 offset:256
    s_waitcnt lgkmcnt(0)
    v_lshlrev_b32 v84, 16, v44
    v_and_b32 v85, 0xffff0000, v44
    v_pk_fma_f32 v[84:85], v[84:85], v[52:53], v[68:69]
    v_cvt_pk_bf16_f32 v16, v84, v85
    v_lshlrev_b32 v86, 16, v45
    v_and_b32 v87, 0xffff0000, v45
    v_pk_fma_f32 v[86:87], v[86:87], v[54:55], v[70:71]
    v_cvt_pk_bf16_f32 v17, v86, v87
    v_lshlrev_b32 v84, 16, v46
    v_and_b32 v85, 0xffff0000, v46
    v_pk_fma_f32 v[84:85], v[84:85], v[56:57], v[72:73]
    v_cvt_pk_bf16_f32 v18, v84, v85
    v_lshlrev_b32 v86, 16, v47
    v_and_b32 v87, 0xffff0000, v47
    v_pk_fma_f32 v[86:87], v[86:87], v[58:59], v[74:75]
    v_cvt_pk_bf16_f32 v19, v86, v87
    buffer_store_dwordx4 v[16:19], v6, s[8:11], s26 offen
    s_waitcnt vmcnt(1)
    ds_write_b128 v13, v[28:31]
    s_waitcnt lgkmcnt(0)
    ds_read_b64_tr_b16 v[48:49], v14
    ds_read_b64_tr_b16 v[50:51], v14 offset:256
    s_waitcnt lgkmcnt(0)
    v_lshlrev_b32 v84, 16, v48
    v_and_b32 v85, 0xffff0000, v48
    v_pk_fma_f32 v[84:85], v[84:85], v[60:61], v[76:77]
    v_cvt_pk_bf16_f32 v20, v84, v85
    v_lshlrev_b32 v86, 16, v49
    v_and_b32 v87, 0xffff0000, v49
    v_pk_fma_f32 v[86:87], v[86:87], v[62:63], v[78:79]
    v_cvt_pk_bf16_f32 v21, v86, v87
    v_lshlrev_b32 v84, 16, v50
    v_and_b32 v85, 0xffff0000, v50
    v_pk_fma_f32 v[84:85], v[84:85], v[64:65], v[80:81]
    v_cvt_pk_bf16_f32 v22, v84, v85
    v_lshlrev_b32 v86, 16, v51
    v_and_b32 v87, 0xffff0000, v51
    v_pk_fma_f32 v[86:87], v[86:87], v[66:67], v[82:83]
    v_cvt_pk_bf16_f32 v23, v86, v87
    buffer_store_dwordx4 v[20:23], v7, s[8:11], s26 offen
    v_mov_b32 v8, 0
    v_mov_b32 v9, 0
    s_mov_b32 s26, 0x3f803f80
    v_dot2_f32_bf16 v8, v16, s26, v8
    v_dot2_f32_bf16 v9, v16, v16, v9
    v_dot2_f32_bf16 v8, v17, s26, v8
    v_dot2_f32_bf16 v9, v17, v17, v9
    v_dot2_f32_bf16 v8, v18, s26, v8
    v_dot2_f32_bf16 v9, v18, v18, v9
    v_dot2_f32_bf16 v8, v19, s26, v8
    v_dot2_f32_bf16 v9, v19, v19, v9
    v_dot2_f32_bf16 v8, v20, s26, v8
    v_dot2_f32_bf16 v9, v20, v20, v9
    v_dot2_f32_bf16 v8, v21, s26, v8
    v_dot2_f32_bf16 v9, v21, v21, v9
    v_dot2_f32_bf16 v8, v22, s26, v8
    v_dot2_f32_bf16 v9, v22, v22, v9
    v_dot2_f32_bf16 v8, v23, s26, v8
    v_dot2_f32_bf16 v9, v23, v23, v9
    s_nop 1
    v_mov_b32 v15, v8
    s_nop 1
    v_permlane32_swap_b32 v8, v15
    v_add_f32 v8, v8, v15
    v_mov_b32 v15, v9
    s_nop 1
    v_permlane32_swap_b32 v9, v15
    v_add_f32 v9, v9, v15
    v_or_b32 v9, 1, v9
    s_add_u32 s26, s38, 32243712
    s_waitcnt vmcnt(0)
    s_mov_b32 exec_hi, 0
    buffer_store_dwordx2 v[8:9], v11, s[8:11], s26 offen
    s_mov_b64 exec, -1
    buffer_store_dwordx4 v[44:47], v6, s[8:11], s27 offen
    buffer_store_dwordx4 v[48:51], v7, s[8:11], s27 offen
    v_mov_b32 v6, v10
    s_lshl_b32 s43, s20, 12
    s_add_u32 s43, s43, 32243712
    buffer_load_dwordx2 v[232:233], v6, s[8:11], s43 offen offset:0 sc1
    buffer_load_dwordx2 v[234:235], v6, s[8:11], s43 offen offset:256 sc1
    buffer_load_dwordx2 v[236:237], v6, s[8:11], s43 offen offset:512 sc1
    buffer_load_dwordx2 v[238:239], v6, s[8:11], s43 offen offset:768 sc1
    buffer_load_dwordx2 v[240:241], v6, s[8:11], s43 offen offset:1024 sc1
    buffer_load_dwordx2 v[242:243], v6, s[8:11], s43 offen offset:1280 sc1
    buffer_load_dwordx2 v[244:245], v6, s[8:11], s43 offen offset:1536 sc1
    buffer_load_dwordx2 v[246:247], v6, s[8:11], s43 offen offset:1792 sc1
    s_waitcnt vmcnt(0)
    s_mov_b32 s61, 0
ffn_kernelf_t1l6:
    v_and_b32 v15, v233, v235
    v_and_b32 v15, v15, v237
    v_and_b32 v15, v15, v239
    v_and_b32 v15, v15, v241
    v_and_b32 v15, v15, v243
    v_and_b32 v15, v15, v245
    v_and_b32 v15, v15, v247
    v_and_b32 v15, 1, v15
    v_cmp_eq_u32 vcc, 0, v15
    s_add_u32 s61, s61, 1
    s_cmp_eq_u64 vcc, 0
    s_cbranch_scc1 ffn_kernelf_t1ok5
    s_cmp_ge_u32 s61, 4000
    s_cbranch_scc1 ffn_kernelf_t1ok5
    s_sleep 1
    buffer_load_dwordx2 v[232:233], v6, s[8:11], s43 offen offset:0 sc1
    buffer_load_dwordx2 v[234:235], v6, s[8:11], s43 offen offset:256 sc1
    buffer_load_dwordx2 v[236:237], v6, s[8:11], s43 offen offset:512 sc1
    buffer_load_dwordx2 v[238:239], v6, s[8:11], s43 offen offset:768 sc1
    buffer_load_dwordx2 v[240:241], v6, s[8:11], s43 offen offset:1024 sc1
    buffer_load_dwordx2 v[242:243], v6, s[8:11], s43 offen offset:1280 sc1
    buffer_load_dwordx2 v[244:245], v6, s[8:11], s43 offen offset:1536 sc1
    buffer_load_dwordx2 v[246:247], v6, s[8:11], s43 offen offset:1792 sc1
    s_waitcnt vmcnt(0)
    s_branch ffn_kernelf_t1l6
ffn_kernelf_t1ok5:
    s_add_u32 s26, s23, 0
    buffer_load_dwordx4 v[24:27], v3, s[8:11], s26 offen sc1
    s_add_u32 s26, s23, 1024
    buffer_load_dwordx4 v[28:31], v3, s[8:11], s26 offen sc1
    s_add_u32 s26, s23, 2048
    buffer_load_dwordx4 v[32:35], v3, s[8:11], s26 offen sc1
    s_add_u32 s26, s23, 3072
    buffer_load_dwordx4 v[36:39], v3, s[8:11], s26 offen sc1
    s_add_u32 s26, s23, 4096
    buffer_load_dwordx4 v[40:43], v3, s[8:11], s26 offen sc1
    s_add_u32 s26, s23, 5120
    buffer_load_dwordx4 v[44:47], v3, s[8:11], s26 offen sc1
    s_add_u32 s26, s23, 6144
    buffer_load_dwordx4 v[48:51], v3, s[8:11], s26 offen sc1
    s_add_u32 s26, s23, 7168
    buffer_load_dwordx4 v[52:55], v3, s[8:11], s26 offen sc1
    s_add_u32 s26, s23, 8192
    buffer_load_dwordx4 v[56:59], v3, s[8:11], s26 offen sc1
    s_barrier
    ds_read_b128 v[200:203], v3 offset:0
    ds_read_b128 v[204:207], v3 offset:1024
    ds_read_b128 v[208:211], v3 offset:2048
    ds_read_b128 v[212:215], v3 offset:3072
    ds_read_b128 v[216:219], v3 offset:4096
    ds_read_b128 v[220:223], v3 offset:5120
    ds_read_b128 v[224:227], v3 offset:6144
    s_waitcnt vmcnt(8)
    s_waitcnt lgkmcnt(6)
    v_mfma_f32_32x32x16_bf16 v[136:151], v[200:203], v[24:27], 0
    ds_read_b128 v[228:231], v3 offset:7168
    s_barrier
    s_waitcnt lgkmcnt(6)
    v_mfma_f32_32x32x16_bf16 v[152:167], v[204:207], v[24:27], 0
    ds_read_b128 v[200:203], v3 offset:8192
    s_add_u32 s26, s23, 9216
    buffer_load_dwordx4 v[60:63], v3, s[8:11], s26 offen sc1
    s_waitcnt lgkmcnt(6)
    v_mfma_f32_32x32x16_bf16 v[168:183], v[208:211], v[24:27], 0
    ds_read_b128 v[204:207], v3 offset:9216
    s_waitcnt vmcnt(8)
    s_waitcnt lgkmcnt(6)
    v_mfma_f32_32x32x16_bf16 v[136:151], v[212:215], v[28:31], v[136:151]
    ds_read_b128 v[208:211], v3 offset:10240
    s_add_u32 m0, s28, 36864
    s_add_u32 s27, s24, 36864
    buffer_load_dwordx4 v3, s[8:11], s27 offen lds
    s_waitcnt lgkmcnt(6)
    v_mfma_f32_32x32x16_bf16 v[152:167], v[216:219], v[28:31], v[152:167]
    ds_read_b128 v[212:215], v3 offset:11264
    s_add_u32 m0, s28, 40960
    s_add_u32 s27, s24, 40960
    buffer_load_dwordx4 v3, s[8:11], s27 offen lds
    s_add_u32 m0, s28, 45056
    s_add_u32 s27, s24, 45056
    buffer_load_dwordx4 v3, s[8:11], s27 offen lds
    s_add_u32 m0, s28, 49152
    s_add_u32 s27, s24, 49152
    buffer_load_dwordx4 v3, s[8:11], s27 offen lds
    s_add_u32 m0, s28, 53248
    s_add_u32 s27, s24, 53248
    buffer_load_dwordx4 v3, s[8:11], s27 offen lds
    s_waitcnt lgkmcnt(6)
    v_mfma_f32_32x32x16_bf16 v[168:183], v[220:223], v[28:31], v[168:183]
    ds_read_b128 v[216:219], v3 offset:12288
    s_add_u32 s26, s23, 10240
    buffer_load_dwordx4 v[64:67], v3, s[8:11], s26 offen sc1
    s_waitcnt vmcnt(13)
    s_waitcnt lgkmcnt(6)
    v_mfma_f32_32x32x16_bf16 v[136:151], v[224:227], v[32:35], v[136:151]
    ds_read_b128 v[220:223], v3 offset:13312
    s_waitcnt lgkmcnt(6)
    v_mfma_f32_32x32x16_bf16 v[152:167], v[228:231], v[32:35], v[152:167]
    ds_read_b128 v[224:227], v3 offset:14336
    s_add_u32 s26, s23, 11264
    buffer_load_dwordx4 v[68:71], v3, s[8:11], s26 offen sc1
    s_waitcnt lgkmcnt(6)
    v_mfma_f32_32x32x16_bf16 v[168:183], v[200:203], v[32:35], v[168:183]
    ds_read_b128 v[228:231], v3 offset:15360
    s_waitcnt vmcnt(13)
    s_waitcnt lgkmcnt(6)
    v_mfma_f32_32x32x16_bf16 v[136:151], v[204:207], v[36:39], v[136:151]
    ds_read_b128 v[200:203], v3 offset:16384
    s_add_u32 s26, s23, 12288
    buffer_load_dwordx4 v[72:75], v3, s[8:11], s26 offen sc1
    s_waitcnt lgkmcnt(6)
    v_mfma_f32_32x32x16_bf16 v[152:167], v[208:211], v[36:39], v[152:167]
    ds_read_b128 v[204:207], v3 offset:17408
    s_waitcnt lgkmcnt(6)
    v_mfma_f32_32x32x16_bf16 v[168:183], v[212:215], v[36:39], v[168:183]
    ds_read_b128 v[208:211], v3 offset:18432
    s_add_u32 s26, s23, 13312
    buffer_load_dwordx4 v[76:79], v3, s[8:11], s26 offen sc1
    s_waitcnt vmcnt(14)
    s_waitcnt lgkmcnt(6)
    v_mfma_f32_32x32x16_bf16 v[136:151], v[216:219], v[40:43], v[136:151]
    ds_read_b128 v[212:215], v3 offset:19456
    s_barrier
    s_waitcnt lgkmcnt(6)
    v_mfma_f32_32x32x16_bf16 v[152:167], v[220:223], v[40:43], v[152:167]
    ds_read_b128 v[216:219], v3 offset:20480
    s_add_u32 s26, s23, 14336
    buffer_load_dwordx4 v[80:83], v3, s[8:11], s26 offen sc1
    s_waitcnt lgkmcnt(6)
    v_mfma_f32_32x32x16_bf16 v[168:183], v[224:227], v[40:43], v[168:183]
    ds_read_b128 v[220:223], v3 offset:21504
    s_waitcnt vmcnt(14)
    s_waitcnt lgkmcnt(6)
    v_mfma_f32_32x32x16_bf16 v[136:151], v[228:231], v[44:47], v[136:151]
    ds_read_b128 v[224:227], v3 offset:22528
    s_add_u32 s26, s23, 15360
    buffer_load_dwordx4 v[84:87], v3, s[8:11], s26 offen sc1
    s_waitcnt lgkmcnt(6)
    v_mfma_f32_32x32x16_bf16 v[152:167], v[200:203], v[44:47], v[152:167]
    ds_read_b128 v[228:231], v3 offset:23552
    s_waitcnt lgkmcnt(6)
    v_mfma_f32_32x32x16_bf16 v[168:183], v[204:207], v[44:47], v[168:183]
    ds_read_b128 v[200:203], v3 offset:24576
    s_add_u32 s26, s23, 16384
    buffer_load_dwordx4 v[88:91], v3, s[8:11], s26 offen sc1
    s_waitcnt vmcnt(15)
    s_waitcnt lgkmcnt(6)
    v_mfma_f32_32x32x16_bf16 v[136:151], v[208:211], v[48:51], v[136:151]
    ds_read_b128 v[204:207], v3 offset:25600
    s_waitcnt lgkmcnt(6)
    v_mfma_f32_32x32x16_bf16 v[152:167], v[212:215], v[48:51], v[152:167]
    ds_read_b128 v[208:211], v3 offset:26624
    s_add_u32 s26, s23, 17408
    buffer_load_dwordx4 v[92:95], v3, s[8:11], s26 offen sc1
    s_waitcnt lgkmcnt(6)
    v_mfma_f32_32x32x16_bf16 v[168:183], v[216:219], v[48:51], v[168:183]
    ds_read_b128 v[212:215], v3 offset:27648
    s_waitcnt vmcnt(15)
    s_waitcnt lgkmcnt(6)
    v_mfma_f32_32x32x16_bf16 v[136:151], v[220:223], v[52:55], v[136:151]
    ds_read_b128 v[216:219], v3 offset:28672
    s_add_u32 s26, s23, 18432
    buffer_load_dwordx4 v[96:99], v3, s[8:11], s26 offen sc1
    s_waitcnt lgkmcnt(6)
    v_mfma_f32_32x32x16_bf16 v[152:167], v[224:227], v[52:55], v[152:167]
    ds_read_b128 v[220:223], v3 offset:29696
    s_waitcnt lgkmcnt(6)
    v_mfma_f32_32x32x16_bf16 v[168:183], v[228:231], v[52:55], v[168:183]
    ds_read_b128 v[224:227], v3 offset:30720
    s_add_u32 s26, s23, 19456
    buffer_load_dwordx4 v[100:103], v3, s[8:11], s26 offen sc1
    s_waitcnt vmcnt(16)
    s_waitcnt lgkmcnt(6)
    v_mfma_f32_32x32x16_bf16 v[136:151], v[200:203], v[56:59], v[136:151]
    ds_read_b128 v[228:231], v3 offset:31744
    s_waitcnt lgkmcnt(6)
    v_mfma_f32_32x32x16_bf16 v[152:167], v[204:207], v[56:59], v[152:167]
    ds_read_b128 v[200:203], v3 offset:32768
    s_add_u32 s26, s23, 20480
    buffer_load_dwordx4 v[104:107], v3, s[8:11], s26 offen sc1
    s_waitcnt lgkmcnt(6)
    v_mfma_f32_32x32x16_bf16 v[168:183], v[208:211], v[56:59], v[168:183]
    ds_read_b128 v[204:207], v3 offset:33792
    s_waitcnt vmcnt(16)
    s_waitcnt lgkmcnt(6)
    v_mfma_f32_32x32x16_bf16 v[136:151], v[212:215], v[60:63], v[136:151]
    ds_read_b128 v[208:211], v3 offset:34816
    s_add_u32 s26, s23, 21504
    buffer_load_dwordx4 v[108:111], v3, s[8:11], s26 offen sc1
    s_waitcnt lgkmcnt(6)
    v_mfma_f32_32x32x16_bf16 v[152:167], v[216:219], v[60:63], v[152:167]
    ds_read_b128 v[212:215], v3 offset:35840
    s_waitcnt vmcnt(12)
    s_barrier
    s_waitcnt lgkmcnt(6)
    v_mfma_f32_32x32x16_bf16 v[168:183], v[220:223], v[60:63], v[168:183]
    ds_read_b128 v[216:219], v3 offset:36864
    s_add_u32 s26, s23, 22528
    buffer_load_dwordx4 v[112:115], v3, s[8:11], s26 offen sc1
    s_waitcnt vmcnt(12)
    s_waitcnt lgkmcnt(6)
    v_mfma_f32_32x32x16_bf16 v[136:151], v[224:227], v[64:67], v[136:151]
    ds_read_b128 v[220:223], v3 offset:37888
    s_waitcnt lgkmcnt(6)
    v_mfma_f32_32x32x16_bf16 v[152:167], v[228:231], v[64:67], v[152:167]
    ds_read_b128 v[224:227], v3 offset:38912
    s_add_u32 s26, s23, 23552
    buffer_load_dwordx4 v[116:119], v3, s[8:11], s26 offen sc1
    s_waitcnt lgkmcnt(6)
    v_mfma_f32_32x32x16_bf16 v[168:183], v[200:203], v[64:67], v[168:183]
    ds_read_b128 v[228:231], v3 offset:39936
    s_waitcnt vmcnt(12)
    s_waitcnt lgkmcnt(6)
    v_mfma_f32_32x32x16_bf16 v[136:151], v[204:207], v[68:71], v[136:151]
    ds_read_b128 v[200:203], v3 offset:40960
    s_add_u32 s26, s23, 24576
    buffer_load_dwordx4 v[120:123], v3, s[8:11], s26 offen sc1
    s_waitcnt lgkmcnt(6)
    v_mfma_f32_32x32x16_bf16 v[152:167], v[208:211], v[68:71], v[152:167]
    ds_read_b128 v[204:207], v3 offset:41984
    s_waitcnt lgkmcnt(6)
    v_mfma_f32_32x32x16_bf16 v[168:183], v[212:215], v[68:71], v[168:183]
    ds_read_b128 v[208:211], v3 offset:43008
    s_add_u32 s26, s23, 25600
    buffer_load_dwordx4 v[124:127], v3, s[8:11], s26 offen sc1
    s_waitcnt vmcnt(13)
    s_waitcnt lgkmcnt(6)
    v_mfma_f32_32x32x16_bf16 v[136:151], v[216:219], v[72:75], v[136:151]
    ds_read_b128 v[212:215], v3 offset:44032
    s_waitcnt lgkmcnt(6)
    v_mfma_f32_32x32x16_bf16 v[152:167], v[220:223], v[72:75], v[152:167]
    ds_read_b128 v[216:219], v3 offset:45056
    s_add_u32 s26, s23, 26624
    buffer_load_dwordx4 v[128:131], v3, s[8:11], s26 offen sc1
    s_waitcnt lgkmcnt(6)
    v_mfma_f32_32x32x16_bf16 v[168:183], v[224:227], v[72:75], v[168:183]
    ds_read_b128 v[220:223], v3 offset:46080
    s_waitcnt vmcnt(13)
    s_waitcnt lgkmcnt(6)
    v_mfma_f32_32x32x16_bf16 v[136:151], v[228:231], v[76:79], v[136:151]
    ds_read_b128 v[224:227], v3 offset:47104
    s_add_u32 s26, s23, 27648
    buffer_load_dwordx4 v[132:135], v3, s[8:11], s26 offen sc1
    s_waitcnt lgkmcnt(6)
    v_mfma_f32_32x32x16_bf16 v[152:167], v[200:203], v[76:79], v[152:167]
    ds_read_b128 v[228:231], v3 offset:48128
    v_add_f32 v6, v232, v234
    v_add_f32 v7, v233, v235
    v_add_f32 v6, v6, v236
    v_add_f32 v7, v7, v237
    s_waitcnt lgkmcnt(6)
    v_mfma_f32_32x32x16_bf16 v[168:183], v[204:207], v[76:79], v[168:183]
    ds_read_b128 v[200:203], v3 offset:49152
    v_add_f32 v6, v6, v238
    v_add_f32 v7, v7, v239
    v_add_f32 v6, v6, v240
    v_add_f32 v7, v7, v241
    s_add_u32 s29, s25, 37888
    buffer_load_dwordx4 a[120:123], v3, s[8:11], s29 offen
    s_waitcnt vmcnt(14)
    s_waitcnt lgkmcnt(6)
    v_mfma_f32_32x32x16_bf16 v[136:151], v[208:211], v[80:83], v[136:151]
    ds_read_b128 v[204:207], v3 offset:50176
    v_add_f32 v6, v6, v242
    v_add_f32 v7, v7, v243
    v_add_f32 v6, v6, v244
    v_add_f32 v7, v7, v245
    s_waitcnt lgkmcnt(6)
    v_mfma_f32_32x32x16_bf16 v[152:167], v[212:215], v[80:83], v[152:167]
    ds_read_b128 v[208:211], v3 offset:51200
    v_add_f32 v6, v6, v246
    v_add_f32 v7, v7, v247
    v_mov_b32 v8, v6
    s_nop 1
    v_permlane32_swap_b32 v6, v8
    s_add_u32 s29, s25, 38912
    buffer_load_dwordx4 a[124:127], v3, s[8:11], s29 offen
    s_waitcnt lgkmcnt(6)
    v_mfma_f32_32x32x16_bf16 v[168:183], v[216:219], v[80:83], v[168:183]
    ds_read_b128 v[212:215], v3 offset:52224
    v_add_f32 v6, v6, v8
    v_mov_b32 v9, v7
    s_nop 1
    v_permlane32_swap_b32 v7, v9
    v_add_f32 v7, v7, v9
    s_waitcnt vmcnt(14)
    s_waitcnt lgkmcnt(6)
    v_mfma_f32_32x32x16_bf16 v[136:151], v[220:223], v[84:87], v[136:151]
    ds_read_b128 v[216:219], v3 offset:53248
    v_mul_f32 v6, 0x3b124925, v6
    v_mul_f32 v7, 0x3b124925, v7
    v_fma_f32 v7, -v6, v6, v7
    v_max_f32 v7, 0, v7
    s_add_u32 s29, s25, 39936
    buffer_load_dwordx4 a[128:131], v3, s[8:11], s29 offen
    s_waitcnt lgkmcnt(6)
    v_mfma_f32_32x32x16_bf16 v[152:167], v[224:227], v[84:87], v[152:167]
    ds_read_b128 v[220:223], v3 offset:54272
    v_cvt_pk_bf16_f32 v11, v6, v6
    v_lshlrev_b32 v11, 16, v11
    v_cvt_pk_bf16_f32 v7, v7, v7
    v_lshlrev_b32 v7, 16, v7
    s_waitcnt lgkmcnt(6)
    v_mfma_f32_32x32x16_bf16 v[168:183], v[228:231], v[84:87], v[168:183]
    ds_read_b128 v[224:227], v3 offset:55296
    v_add_f32 v7, 0x3727c5ac, v7
    v_cvt_pk_bf16_f32 v7, v7, v7
    v_lshlrev_b32 v7, 16, v7
    v_sqrt_f32 v7, v7
    s_add_u32 s29, s25, 40960
    buffer_load_dwordx4 a[132:135], v3, s[8:11], s29 offen
    s_waitcnt vmcnt(15)
    s_waitcnt lgkmcnt(6)
    v_mfma_f32_32x32x16_bf16 v[136:151], v[200:203], v[88:91], v[136:151]
    ds_read_b128 v[228:231], v3 offset:56320
    v_cvt_pk_bf16_f32 v7, v7, v7
    v_lshlrev_b32 v7, 16, v7
    v_rcp_f32 v10, v7
    v_cvt_pk_bf16_f32 v248, -v11, -v11
    s_barrier
    s_waitcnt lgkmcnt(6)
    v_mfma_f32_32x32x16_bf16 v[152:167], v[204:207], v[88:91], v[152:167]
    ds_read_b128 v[200:203], v3 offset:57344
    v_mov_b32 v249, v248
    v_mov_b32 v250, v248
    v_mov_b32 v251, v248
    v_mul_f32 v10, v10, v10
    s_add_u32 s29, s25, 41984
    buffer_load_dwordx4 a[136:139], v3, s[8:11], s29 offen
    s_waitcnt lgkmcnt(6)
    v_mfma_f32_32x32x16_bf16 v[168:183], v[208:211], v[88:91], v[168:183]
    ds_read_b128 v[204:207], v3 offset:58368
    s_waitcnt vmcnt(15)
    s_waitcnt lgkmcnt(6)
    v_mfma_f32_32x32x16_bf16 v[136:151], v[212:215], v[92:95], v[136:151]
    ds_read_b128 v[208:211], v3 offset:59392
    s_add_u32 s29, s25, 50176
    buffer_load_dwordx4 a[140:143], v3, s[8:11], s29 offen
    s_waitcnt lgkmcnt(6)
    v_mfma_f32_32x32x16_bf16 v[152:167], v[216:219], v[92:95], v[152:167]
    ds_read_b128 v[212:215], v3 offset:60416
    s_waitcnt lgkmcnt(6)
    v_mfma_f32_32x32x16_bf16 v[168:183], v[220:223], v[92:95], v[168:183]
    ds_read_b128 v[216:219], v3 offset:61440
    s_add_u32 s29, s25, 51200
    buffer_load_dwordx4 a[144:147], v3, s[8:11], s29 offen
    s_waitcnt vmcnt(16)
    s_waitcnt lgkmcnt(6)
    v_mfma_f32_32x32x16_bf16 v[136:151], v[224:227], v[96:99], v[136:151]
    ds_read_b128 v[220:223], v3 offset:62464
    s_waitcnt lgkmcnt(6)
    v_mfma_f32_32x32x16_bf16 v[152:167], v[228:231], v[96:99], v[152:167]
    ds_read_b128 v[224:227], v3 offset:63488
    s_add_u32 s29, s25, 52224
    buffer_load_dwordx4 a[148:151], v3, s[8:11], s29 offen
    s_waitcnt lgkmcnt(6)
    v_mfma_f32_32x32x16_bf16 v[168:183], v[200:203], v[96:99], v[168:183]
    ds_read_b128 v[228:231], v3 offset:64512
    s_waitcnt vmcnt(16)
    s_waitcnt lgkmcnt(6)
    v_mfma_f32_32x32x16_bf16 v[136:151], v[204:207], v[100:103], v[136:151]
    ds_read_b128 v[200:203], v4 offset:0
    s_add_u32 s29, s25, 53248
    buffer_load_dwordx4 a[152:155], v3, s[8:11], s29 offen
    s_waitcnt lgkmcnt(6)
    v_mfma_f32_32x32x16_bf16 v[152:167], v[208:211], v[100:103], v[152:167]
    ds_read_b128 v[204:207], v4 offset:1024
    s_waitcnt lgkmcnt(6)
    v_mfma_f32_32x32x16_bf16 v[168:183], v[212:215], v[100:103], v[168:183]
    ds_read_b128 v[208:211], v4 offset:2048
    s_add_u32 s29, s25, 54272
    buffer_load_dwordx4 a[156:159], v3, s[8:11], s29 offen
    s_waitcnt vmcnt(17)
    s_waitcnt lgkmcnt(6)
    v_mfma_f32_32x32x16_bf16 v[136:151], v[216:219], v[104:107], v[136:151]
    ds_read_b128 v[212:215], v4 offset:3072
    s_waitcnt lgkmcnt(6)
    v_mfma_f32_32x32x16_bf16 v[152:167], v[220:223], v[104:107], v[152:167]
    ds_read_b128 v[216:219], v4 offset:4096
    s_add_u32 s29, s25, 55296
    buffer_load_dwordx4 a[160:163], v3, s[8:11], s29 offen
    s_barrier
    s_waitcnt lgkmcnt(6)
    v_mfma_f32_32x32x16_bf16 v[168:183], v[224:227], v[104:107], v[168:183]
    ds_read_b128 v[220:223], v4 offset:5120
    s_waitcnt vmcnt(17)
    s_waitcnt lgkmcnt(6)
    v_mfma_f32_32x32x16_bf16 v[136:151], v[228:231], v[108:111], v[136:151]
    ds_read_b128 v[224:227], v4 offset:6144
    s_add_u32 m0, s28, 0
    s_add_u32 s27, s24, 159744
    buffer_load_dwordx4 v3, s[8:11], s27 offen lds
    s_waitcnt lgkmcnt(6)
    v_mfma_f32_32x32x16_bf16 v[152:167], v[200:203], v[108:111], v[152:167]
    ds_read_b128 v[228:231], v4 offset:7168
    s_waitcnt lgkmcnt(6)
    v_mfma_f32_32x32x16_bf16 v[168:183], v[204:207], v[108:111], v[168:183]
    ds_read_b128 v[200:203], v4 offset:8192
    s_add_u32 m0, s28, 4096
    s_add_u32 s27, s24, 163840
    buffer_load_dwordx4 v3, s[8:11], s27 offen lds
    s_waitcnt vmcnt(18)
    s_waitcnt lgkmcnt(6)
    v_mfma_f32_32x32x16_bf16 v[136:151], v[208:211], v[112:115], v[136:151]
    ds_read_b128 v[204:207], v4 offset:9216
    s_waitcnt lgkmcnt(6)
    v_mfma_f32_32x32x16_bf16 v[152:167], v[212:215], v[112:115], v[152:167]
    ds_read_b128 v[208:211], v4 offset:10240
    s_add_u32 m0, s28, 8192
    s_add_u32 s27, s24, 167936
    buffer_load_dwordx4 v3, s[8:11], s27 offen lds
    s_waitcnt lgkmcnt(6)
    v_mfma_f32_32x32x16_bf16 v[168:183], v[216:219], v[112:115], v[168:183]
    ds_read_b128 v[212:215], v4 offset:11264
    s_waitcnt vmcnt(18)
    s_waitcnt lgkmcnt(6)
    v_mfma_f32_32x32x16_bf16 v[136:151], v[220:223], v[116:119], v[136:151]
    ds_read_b128 v[216:219], v4 offset:12288
    s_add_u32 m0, s28, 12288
    s_add_u32 s27, s24, 172032
    buffer_load_dwordx4 v3, s[8:11], s27 offen lds
    s_waitcnt lgkmcnt(6)
    v_mfma_f32_32x32x16_bf16 v[152:167], v[224:227], v[116:119], v[152:167]
    ds_read_b128 v[220:223], v4 offset:13312
    s_waitcnt lgkmcnt(6)
    v_mfma_f32_32x32x16_bf16 v[168:183], v[228:231], v[116:119], v[168:183]
    ds_read_b128 v[224:227], v4 offset:14336
    s_add_u32 m0, s28, 16384
    s_add_u32 s27, s24, 176128
    buffer_load_dwordx4 v3, s[8:11], s27 offen lds
    s_waitcnt vmcnt(19)
    s_waitcnt lgkmcnt(6)
    v_mfma_f32_32x32x16_bf16 v[136:151], v[200:203], v[120:123], v[136:151]
    ds_read_b128 v[228:231], v4 offset:15360
    s_waitcnt lgkmcnt(6)
    v_mfma_f32_32x32x16_bf16 v[152:167], v[204:207], v[120:123], v[152:167]
    ds_read_b128 v[200:203], v4 offset:16384
    s_add_u32 m0, s28, 20480
    s_add_u32 s27, s24, 180224
    buffer_load_dwordx4 v3, s[8:11], s27 offen lds
    s_waitcnt lgkmcnt(6)
    v_mfma_f32_32x32x16_bf16 v[168:183], v[208:211], v[120:123], v[168:183]
    ds_read_b128 v[204:207], v4 offset:17408
    s_waitcnt vmcnt(19)
    s_waitcnt lgkmcnt(6)
    v_mfma_f32_32x32x16_bf16 v[136:151], v[212:215], v[124:127], v[136:151]
    ds_read_b128 v[208:211], v4 offset:18432
    s_add_u32 m0, s28, 24576
    s_add_u32 s27, s24, 184320
    buffer_load_dwordx4 v3, s[8:11], s27 offen lds
    s_waitcnt lgkmcnt(6)
    v_mfma_f32_32x32x16_bf16 v[152:167], v[216:219], v[124:127], v[152:167]
    ds_read_b128 v[212:215], v4 offset:19456
    s_barrier
    s_waitcnt lgkmcnt(6)
    v_mfma_f32_32x32x16_bf16 v[168:183], v[220:223], v[124:127], v[168:183]
    ds_read_b128 v[216:219], v4 offset:20480
    s_add_u32 m0, s28, 28672
    s_add_u32 s27, s24, 188416
    buffer_load_dwordx4 v3, s[8:11], s27 offen lds
    s_waitcnt vmcnt(20)
    s_waitcnt lgkmcnt(6)
    v_mfma_f32_32x32x16_bf16 v[136:151], v[224:227], v[128:131], v[136:151]
    ds_read_b128 v[220:223], v4 offset:21504
    s_waitcnt lgkmcnt(6)
    v_mfma_f32_32x32x16_bf16 v[152:167], v[228:231], v[128:131], v[152:167]
    ds_read_b128 v[224:227], v4 offset:22528
    s_add_u32 m0, s28, 32768
    s_add_u32 s27, s24, 192512
    buffer_load_dwordx4 v3, s[8:11], s27 offen lds
    s_waitcnt lgkmcnt(6)
    v_mfma_f32_32x32x16_bf16 v[168:183], v[200:203], v[128:131], v[168:183]
    ds_read_b128 v[228:231], v4 offset:23552
    s_waitcnt vmcnt(20)
    s_waitcnt lgkmcnt(6)
    v_mfma_f32_32x32x16_bf16 v[136:151], v[204:207], v[132:135], v[136:151]
    ds_read_b128 v[200:203], v4 offset:24576
    s_add_u32 m0, s28, 36864
    s_add_u32 s27, s24, 196608
    buffer_load_dwordx4 v3, s[8:11], s27 offen lds
    s_waitcnt lgkmcnt(6)
    v_mfma_f32_32x32x16_bf16 v[152:167], v[208:211], v[132:135], v[152:167]
    ds_read_b128 v[204:207], v4 offset:25600
    s_waitcnt lgkmcnt(6)
    v_mfma_f32_32x32x16_bf16 v[168:183], v[212:215], v[132:135], v[168:183]
    ds_read_b128 v[208:211], v4 offset:26624
    s_add_u32 m0, s28, 40960
    s_add_u32 s27, s24, 200704
    buffer_load_dwordx4 v3, s[8:11], s27 offen lds
    s_waitcnt lgkmcnt(6)
    v_mfma_f32_32x32x16_bf16 v[184:199], v[216:219], v[24:27], 0
    ds_read_b128 v[212:215], v4 offset:27648
    s_waitcnt lgkmcnt(6)
    v_mfma_f32_32x32x16_bf16 v[184:199], v[220:223], v[28:31], v[184:199]
    ds_read_b128 v[216:219], v4 offset:28672
    s_add_u32 m0, s28, 45056
    s_add_u32 s27, s24, 204800
    buffer_load_dwordx4 v3, s[8:11], s27 offen lds
    s_waitcnt lgkmcnt(6)
    v_mfma_f32_32x32x16_bf16 v[184:199], v[224:227], v[32:35], v[184:199]
    ds_read_b128 v[220:223], v4 offset:29696
    s_waitcnt lgkmcnt(6)
    v_mfma_f32_32x32x16_bf16 v[184:199], v[228:231], v[36:39], v[184:199]
    ds_read_b128 v[224:227], v4 offset:30720
    s_add_u32 s29, s25, 56320
    buffer_load_dwordx4 a[164:167], v3, s[8:11], s29 offen
    s_waitcnt lgkmcnt(6)
    v_mfma_f32_32x32x16_bf16 v[184:199], v[200:203], v[40:43], v[184:199]
    ds_read_b128 v[228:231], v4 offset:31744
    s_waitcnt lgkmcnt(6)
    v_mfma_f32_32x32x16_bf16 v[184:199], v[204:207], v[44:47], v[184:199]
    ds_read_b128 v[200:203], v4 offset:32768
    s_add_u32 s29, s25, 64512
    buffer_load_dwordx4 a[168:171], v3, s[8:11], s29 offen
    s_waitcnt lgkmcnt(6)
    v_mfma_f32_32x32x16_bf16 v[184:199], v[208:211], v[48:51], v[184:199]
    ds_read_b128 v[204:207], v4 offset:33792
    s_waitcnt lgkmcnt(6)
    v_mfma_f32_32x32x16_bf16 v[136:151], v[212:215], v[248:251], v[136:151]
    ds_read_b128 v[208:211], v4 offset:34816
    s_add_u32 s29, s25, 65536
    buffer_load_dwordx4 a[172:175], v3, s[8:11], s29 offen
    s_waitcnt lgkmcnt(6)
    v_mfma_f32_32x32x16_bf16 v[152:167], v[216:219], v[248:251], v[152:167]
    ds_read_b128 v[212:215], v4 offset:35840
    s_waitcnt lgkmcnt(6)
    v_mfma_f32_32x32x16_bf16 v[168:183], v[220:223], v[248:251], v[168:183]
    ds_read_b128 v[216:219], v4 offset:36864
    s_add_u32 s29, s25, 66560
    buffer_load_dwordx4 a[176:179], v3, s[8:11], s29 offen
    s_waitcnt lgkmcnt(6)
    v_mfma_f32_32x32x16_bf16 v[184:199], v[224:227], v[52:55], v[184:199]
    ds_read_b128 v[220:223], v4 offset:37888
    v_max_f32 v136, 0, v136
    v_max_f32 v137, 0, v137
    v_max_f32 v138, 0, v138
    v_max_f32 v139, 0, v139
    s_waitcnt lgkmcnt(6)
    v_mfma_f32_32x32x16_bf16 v[184:199], v[228:231], v[56:59], v[184:199]
    ds_read_b128 v[224:227], v4 offset:38912
    v_mul_f32 v140, v10, v140
    v_mul_f32 v141, v10, v141
    v_mul_f32 v142, v10, v142
    v_mul_f32 v143, v10, v143
    s_add_u32 s29, s25, 67584
    buffer_load_dwordx4 a[180:183], v3, s[8:11], s29 offen
    s_waitcnt lgkmcnt(6)
    v_mfma_f32_32x32x16_bf16 v[184:199], v[200:203], v[60:63], v[184:199]
    ds_read_b128 v[228:231], v4 offset:39936
    v_mul_f32 v136, v136, v140
    v_mul_f32 v137, v137, v141
    v_mul_f32 v138, v138, v142
    v_mul_f32 v139, v139, v143
    s_waitcnt lgkmcnt(6)
    v_mfma_f32_32x32x16_bf16 v[184:199], v[204:207], v[64:67], v[184:199]
    ds_read_b128 v[200:203], v4 offset:40960
    v_cvt_pk_bf16_f32 v232, v136, v137
    v_cvt_pk_bf16_f32 v233, v138, v139
    v_max_f32 v144, 0, v144
    v_max_f32 v145, 0, v145
    s_add_u32 s29, s25, 68608
    buffer_load_dwordx4 a[184:187], v3, s[8:11], s29 offen
    s_waitcnt lgkmcnt(6)
    v_mfma_f32_32x32x16_bf16 v[184:199], v[208:211], v[68:71], v[184:199]
    ds_read_b128 v[204:207], v4 offset:41984
    v_max_f32 v146, 0, v146
    v_max_f32 v147, 0, v147
    v_mul_f32 v148, v10, v148
    v_mul_f32 v149, v10, v149
    s_waitcnt lgkmcnt(6)
    v_mfma_f32_32x32x16_bf16 v[184:199], v[212:215], v[72:75], v[184:199]
    ds_read_b128 v[208:211], v4 offset:43008
    v_mul_f32 v150, v10, v150
    v_mul_f32 v151, v10, v151
    v_mul_f32 v144, v144, v148
    v_mul_f32 v145, v145, v149
    s_add_u32 s29, s25, 69632
    buffer_load_dwordx4 a[188:191], v3, s[8:11], s29 offen
    s_waitcnt lgkmcnt(6)
    v_mfma_f32_32x32x16_bf16 v[184:199], v[216:219], v[76:79], v[184:199]
    ds_read_b128 v[212:215], v4 offset:44032
    v_mul_f32 v146, v146, v150
    v_mul_f32 v147, v147, v151
    v_cvt_pk_bf16_f32 v234, v144, v145
    v_cvt_pk_bf16_f32 v235, v146, v147
    s_waitcnt lgkmcnt(6)
    v_mfma_f32_32x32x16_bf16 v[184:199], v[220:223], v[80:83], v[184:199]
    ds_read_b128 v[216:219], v4 offset:45056
    s_add_u32 s26, s36, 0
    buffer_store_dwordx4 v[232:235], v3, s[8:11], s26 offen sc1
    v_max_f32 v152, 0, v152
    v_max_f32 v153, 0, v153
    v_max_f32 v154, 0, v154
    s_add_u32 s29, s25, 70656
    buffer_load_dwordx4 a[192:195], v3, s[8:11], s29 offen
    s_waitcnt lgkmcnt(6)
    v_mfma_f32_32x32x16_bf16 v[184:199], v[224:227], v[84:87], v[184:199]
    ds_read_b128 v[220:223], v4 offset:46080
    v_max_f32 v155, 0, v155
    v_mul_f32 v156, v10, v156
    v_mul_f32 v157, v10, v157
    v_mul_f32 v158, v10, v158
    s_waitcnt lgkmcnt(6)
    v_mfma_f32_32x32x16_bf16 v[184:199], v[228:231], v[88:91], v[184:199]
    ds_read_b128 v[224:227], v4 offset:47104
    v_mul_f32 v159, v10, v159
    v_mul_f32 v152, v152, v156
    v_mul_f32 v153, v153, v157
    v_mul_f32 v154, v154, v158
    s_add_u32 s29, s25, 78848
    buffer_load_dwordx4 a[196:199], v3, s[8:11], s29 offen
    s_waitcnt lgkmcnt(6)
    v_mfma_f32_32x32x16_bf16 v[184:199], v[200:203], v[92:95], v[184:199]
    ds_read_b128 v[228:231], v4 offset:48128
    v_mul_f32 v155, v155, v159
    v_cvt_pk_bf16_f32 v236, v152, v153
    v_cvt_pk_bf16_f32 v237, v154, v155
    v_max_f32 v160, 0, v160
    s_waitcnt lgkmcnt(6)
    v_mfma_f32_32x32x16_bf16 v[184:199], v[204:207], v[96:99], v[184:199]
    ds_read_b128 v[200:203], v4 offset:49152
    v_max_f32 v161, 0, v161
    v_max_f32 v162, 0, v162
    v_max_f32 v163, 0, v163
    v_mul_f32 v164, v10, v164
    s_add_u32 s29, s25, 79872
    buffer_load_dwordx4 a[200:203], v3, s[8:11], s29 offen
    s_waitcnt lgkmcnt(6)
    v_mfma_f32_32x32x16_bf16 v[184:199], v[208:211], v[100:103], v[184:199]
    ds_read_b128 v[204:207], v4 offset:50176
    v_mul_f32 v165, v10, v165
    v_mul_f32 v166, v10, v166
    v_mul_f32 v167, v10, v167
    v_mul_f32 v160, v160, v164
    s_waitcnt lgkmcnt(6)
    v_mfma_f32_32x32x16_bf16 v[184:199], v[212:215], v[104:107], v[184:199]
    ds_read_b128 v[208:211], v4 offset:51200
    v_mul_f32 v161, v161, v165
    v_mul_f32 v162, v162, v166
    v_mul_f32 v163, v163, v167
    v_cvt_pk_bf16_f32 v238, v160, v161
    s_add_u32 s29, s25, 80896
    buffer_load_dwordx4 a[204:207], v3, s[8:11], s29 offen
    s_waitcnt lgkmcnt(6)
    v_mfma_f32_32x32x16_bf16 v[184:199], v[216:219], v[108:111], v[184:199]
    ds_read_b128 v[212:215], v4 offset:52224
    v_cvt_pk_bf16_f32 v239, v162, v163
    s_add_u32 s26, s36, 1024
    buffer_store_dwordx4 v[236:239], v3, s[8:11], s26 offen sc1
    v_max_f32 v168, 0, v168
    v_max_f32 v169, 0, v169
    s_waitcnt lgkmcnt(6)
    v_mfma_f32_32x32x16_bf16 v[184:199], v[220:223], v[112:115], v[184:199]
    ds_read_b128 v[216:219], v4 offset:53248
    v_max_f32 v170, 0, v170
    v_max_f32 v171, 0, v171
    v_mul_f32 v172, v10, v172
    v_mul_f32 v173, v10, v173
    s_add_u32 s29, s25, 81920
    buffer_load_dwordx4 a[208:211], v3, s[8:11], s29 offen
    s_waitcnt lgkmcnt(6)
    v_mfma_f32_32x32x16_bf16 v[184:199], v[224:227], v[116:119], v[184:199]
    ds_read_b128 v[220:223], v4 offset:54272
    v_mul_f32 v174, v10, v174
    v_mul_f32 v175, v10, v175
    v_mul_f32 v168, v168, v172
    v_mul_f32 v169, v169, v173
    s_waitcnt lgkmcnt(6)
    v_mfma_f32_32x32x16_bf16 v[184:199], v[228:231], v[120:123], v[184:199]
    ds_read_b128 v[224:227], v4 offset:55296
    v_mul_f32 v170, v170, v174
    v_mul_f32 v171, v171, v175
    v_cvt_pk_bf16_f32 v232, v168, v169
    v_cvt_pk_bf16_f32 v233, v170, v171
    s_add_u32 s29, s25, 82944
    buffer_load_dwordx4 a[212:215], v3, s[8:11], s29 offen
    s_waitcnt lgkmcnt(6)
    v_mfma_f32_32x32x16_bf16 v[184:199], v[200:203], v[124:127], v[184:199]
    ds_read_b128 v[228:231], v4 offset:56320
    v_max_f32 v176, 0, v176
    v_max_f32 v177, 0, v177
    v_max_f32 v178, 0, v178
    v_max_f32 v179, 0, v179
    s_barrier
    s_waitcnt lgkmcnt(6)
    v_mfma_f32_32x32x16_bf16 v[184:199], v[204:207], v[128:131], v[184:199]
    ds_read_b128 v[200:203], v4 offset:57344
    v_mul_f32 v180, v10, v180
    v_mul_f32 v181, v10, v181
    v_mul_f32 v182, v10, v182
    v_mul_f32 v183, v10, v183
    s_add_u32 s29, s25, 83968
    buffer_load_dwordx4 a[216:219], v3, s[8:11], s29 offen
    s_waitcnt lgkmcnt(6)
    v_mfma_f32_32x32x16_bf16 v[184:199], v[208:211], v[132:135], v[184:199]
    ds_read_b128 v[204:207], v4 offset:58368
    v_mul_f32 v176, v176, v180
    v_mul_f32 v177, v177, v181
    v_mul_f32 v178, v178, v182
    v_mul_f32 v179, v179, v183
    s_waitcnt lgkmcnt(6)
    v_mfma_f32_32x32x16_bf16 v[184:199], v[212:215], v[248:251], v[184:199]
    ds_read_b128 v[208:211], v4 offset:59392
    v_cvt_pk_bf16_f32 v234, v176, v177
    v_cvt_pk_bf16_f32 v235, v178, v179
    s_add_u32 s26, s36, 2048
    buffer_store_dwordx4 v[232:235], v3, s[8:11], s26 offen sc1
    s_add_u32 s29, s25, 84992
    buffer_load_dwordx4 a[220:223], v3, s[8:11], s29 offen
    s_waitcnt lgkmcnt(6)
    v_mfma_f32_32x32x16_bf16 v[136:151], v[216:219], v[24:27], 0
    ds_read_b128 v[212:215], v4 offset:60416
    s_waitcnt lgkmcnt(6)
    v_mfma_f32_32x32x16_bf16 v[152:167], v[220:223], v[24:27], 0
    ds_read_b128 v[216:219], v4 offset:61440
    s_add_u32 s29, s25, 86016
    buffer_load_dwordx4 a[224:227], v3, s[8:11], s29 offen
    s_waitcnt lgkmcnt(6)
    v_mfma_f32_32x32x16_bf16 v[168:183], v[224:227], v[24:27], 0
    ds_read_b128 v[220:223], v4 offset:62464
    v_max_f32 v184, 0, v184
    v_max_f32 v185, 0, v185
    v_max_f32 v186, 0, v186
    v_max_f32 v187, 0, v187
    s_waitcnt lgkmcnt(6)
    v_mfma_f32_32x32x16_bf16 v[136:151], v[228:231], v[28:31], v[136:151]
    ds_read_b128 v[224:227], v4 offset:63488
    v_mul_f32 v188, v10, v188
    v_mul_f32 v189, v10, v189
    v_mul_f32 v190, v10, v190
    v_mul_f32 v191, v10, v191
    s_add_u32 s29, s25, 87040
    buffer_load_dwordx4 a[228:231], v3, s[8:11], s29 offen
    s_waitcnt lgkmcnt(6)
    v_mfma_f32_32x32x16_bf16 v[152:167], v[200:203], v[28:31], v[152:167]
    ds_read_b128 v[228:231], v4 offset:64512
    v_mul_f32 v184, v184, v188
    v_mul_f32 v185, v185, v189
    v_mul_f32 v186, v186, v190
    v_mul_f32 v187, v187, v191
    s_waitcnt lgkmcnt(6)
    v_mfma_f32_32x32x16_bf16 v[168:183], v[204:207], v[28:31], v[168:183]
    ds_read_b128 v[200:203], v5 offset:0
    v_cvt_pk_bf16_f32 v236, v184, v185
    v_cvt_pk_bf16_f32 v237, v186, v187
    v_max_f32 v192, 0, v192
    v_max_f32 v193, 0, v193
    s_add_u32 s29, s25, 28672
    buffer_load_dwordx4 v[24:27], v3, s[8:11], s29 offen
    s_waitcnt lgkmcnt(6)
    v_mfma_f32_32x32x16_bf16 v[136:151], v[208:211], v[32:35], v[136:151]
    ds_read_b128 v[204:207], v5 offset:1024
    v_max_f32 v194, 0, v194
    v_max_f32 v195, 0, v195
    v_mul_f32 v196, v10, v196
    v_mul_f32 v197, v10, v197
    s_waitcnt lgkmcnt(6)
    v_mfma_f32_32x32x16_bf16 v[152:167], v[212:215], v[32:35], v[152:167]
    ds_read_b128 v[208:211], v5 offset:2048
    v_mul_f32 v198, v10, v198
    v_mul_f32 v199, v10, v199
    v_mul_f32 v192, v192, v196
    v_mul_f32 v193, v193, v197
    s_add_u32 s29, s25, 29696
    buffer_load_dwordx4 v[28:31], v3, s[8:11], s29 offen
    s_waitcnt lgkmcnt(6)
    v_mfma_f32_32x32x16_bf16 v[168:183], v[216:219], v[32:35], v[168:183]
    ds_read_b128 v[212:215], v5 offset:3072
    v_mul_f32 v194, v194, v198
    v_mul_f32 v195, v195, v199
    v_cvt_pk_bf16_f32 v238, v192, v193
    v_cvt_pk_bf16_f32 v239, v194, v195
    s_waitcnt lgkmcnt(6)
    v_mfma_f32_32x32x16_bf16 v[136:151], v[220:223], v[36:39], v[136:151]
    ds_read_b128 v[216:219], v5 offset:4096
    s_add_u32 s26, s36, 3072
    buffer_store_dwordx4 v[236:239], v3, s[8:11], s26 offen sc1
    s_add_u32 s29, s25, 88064
    buffer_load_dwordx4 a[232:235], v3, s[8:11], s29 offen
    s_waitcnt lgkmcnt(6)
    v_mfma_f32_32x32x16_bf16 v[152:167], v[224:227], v[36:39], v[152:167]
    ds_read_b128 v[220:223], v5 offset:5120
    s_waitcnt lgkmcnt(6)
    v_mfma_f32_32x32x16_bf16 v[168:183], v[228:231], v[36:39], v[168:183]
    ds_read_b128 v[224:227], v5 offset:6144
    s_add_u32 s29, s25, 30720
    buffer_load_dwordx4 v[32:35], v3, s[8:11], s29 offen
    s_waitcnt lgkmcnt(6)
    v_mfma_f32_32x32x16_bf16 v[136:151], v[200:203], v[40:43], v[136:151]
    ds_read_b128 v[228:231], v5 offset:7168
    s_waitcnt lgkmcnt(6)
    v_mfma_f32_32x32x16_bf16 v[152:167], v[204:207], v[40:43], v[152:167]
    ds_read_b128 v[200:203], v5 offset:8192
    s_add_u32 s29, s25, 31744
    buffer_load_dwordx4 v[36:39], v3, s[8:11], s29 offen
    s_waitcnt lgkmcnt(6)
    v_mfma_f32_32x32x16_bf16 v[168:183], v[208:211], v[40:43], v[168:183]
    ds_read_b128 v[204:207], v5 offset:9216
    s_waitcnt lgkmcnt(6)
    v_mfma_f32_32x32x16_bf16 v[136:151], v[212:215], v[44:47], v[136:151]
    ds_read_b128 v[208:211], v5 offset:10240
    s_add_u32 s29, s25, 89088
    buffer_load_dwordx4 a[236:239], v3, s[8:11], s29 offen
    s_waitcnt lgkmcnt(6)
    v_mfma_f32_32x32x16_bf16 v[152:167], v[216:219], v[44:47], v[152:167]
    ds_read_b128 v[212:215], v5 offset:11264
    s_waitcnt lgkmcnt(6)
    v_mfma_f32_32x32x16_bf16 v[168:183], v[220:223], v[44:47], v[168:183]
    ds_read_b128 v[216:219], v5 offset:12288
    s_add_u32 s29, s25, 32768
    buffer_load_dwordx4 v[40:43], v3, s[8:11], s29 offen
    s_waitcnt lgkmcnt(6)
    v_mfma_f32_32x32x16_bf16 v[136:151], v[224:227], v[48:51], v[136:151]
    ds_read_b128 v[220:223], v5 offset:13312
    s_waitcnt lgkmcnt(6)
    v_mfma_f32_32x32x16_bf16 v[152:167], v[228:231], v[48:51], v[152:167]
    ds_read_b128 v[224:227], v5 offset:14336
    s_add_u32 s29, s25, 33792
    buffer_load_dwordx4 v[44:47], v3, s[8:11], s29 offen
    s_waitcnt lgkmcnt(6)
    v_mfma_f32_32x32x16_bf16 v[168:183], v[200:203], v[48:51], v[168:183]
    ds_read_b128 v[228:231], v5 offset:15360
    s_waitcnt lgkmcnt(6)
    v_mfma_f32_32x32x16_bf16 v[136:151], v[204:207], v[52:55], v[136:151]
    ds_read_b128 v[200:203], v5 offset:16384
    s_add_u32 s29, s25, 90112
    buffer_load_dwordx4 a[240:243], v3, s[8:11], s29 offen
    s_waitcnt lgkmcnt(6)
    v_mfma_f32_32x32x16_bf16 v[152:167], v[208:211], v[52:55], v[152:167]
    ds_read_b128 v[204:207], v5 offset:17408
    s_waitcnt lgkmcnt(6)
    v_mfma_f32_32x32x16_bf16 v[168:183], v[212:215], v[52:55], v[168:183]
    ds_read_b128 v[208:211], v5 offset:18432
    s_add_u32 s29, s25, 34816
    buffer_load_dwordx4 v[48:51], v3, s[8:11], s29 offen
    s_waitcnt lgkmcnt(6)
    v_mfma_f32_32x32x16_bf16 v[136:151], v[216:219], v[56:59], v[136:151]
    ds_read_b128 v[212:215], v5 offset:19456
    s_waitcnt lgkmcnt(6)
    v_mfma_f32_32x32x16_bf16 v[152:167], v[220:223], v[56:59], v[152:167]
    ds_read_b128 v[216:219], v5 offset:20480
    s_add_u32 s29, s25, 43008
    buffer_load_dwordx4 v[52:55], v3, s[8:11], s29 offen
    s_waitcnt lgkmcnt(6)
    v_mfma_f32_32x32x16_bf16 v[168:183], v[224:227], v[56:59], v[168:183]
    ds_read_b128 v[220:223], v5 offset:21504
    s_waitcnt lgkmcnt(6)
    v_mfma_f32_32x32x16_bf16 v[136:151], v[228:231], v[60:63], v[136:151]
    ds_read_b128 v[224:227], v5 offset:22528
    s_add_u32 s29, s25, 91136
    buffer_load_dwordx4 a[244:247], v3, s[8:11], s29 offen
    s_waitcnt lgkmcnt(6)
    v_mfma_f32_32x32x16_bf16 v[152:167], v[200:203], v[60:63], v[152:167]
    ds_read_b128 v[228:231], v5 offset:23552
    s_waitcnt lgkmcnt(6)
    v_mfma_f32_32x32x16_bf16 v[168:183], v[204:207], v[60:63], v[168:183]
    ds_read_b128 v[200:203], v5 offset:24576
    s_add_u32 s29, s25, 44032
    buffer_load_dwordx4 v[56:59], v3, s[8:11], s29 offen
    s_waitcnt lgkmcnt(6)
    v_mfma_f32_32x32x16_bf16 v[136:151], v[208:211], v[64:67], v[136:151]
    ds_read_b128 v[204:207], v5 offset:25600
    s_waitcnt lgkmcnt(6)
    v_mfma_f32_32x32x16_bf16 v[152:167], v[212:215], v[64:67], v[152:167]
    ds_read_b128 v[208:211], v5 offset:26624
    s_add_u32 s29, s25, 45056
    buffer_load_dwordx4 v[60:63], v3, s[8:11], s29 offen
    s_waitcnt lgkmcnt(6)
    v_mfma_f32_32x32x16_bf16 v[168:183], v[216:219], v[64:67], v[168:183]
    ds_read_b128 v[212:215], v5 offset:27648
    s_waitcnt vmcnt(35)
    s_barrier
    s_waitcnt lgkmcnt(6)
    v_mfma_f32_32x32x16_bf16 v[136:151], v[220:223], v[68:71], v[136:151]
    ds_read_b128 v[216:219], v3 offset:0
    s_add_u32 s29, s25, 92160
    buffer_load_dwordx4 a[248:251], v3, s[8:11], s29 offen
    s_waitcnt vmcnt(13)
    v_mov_b32 v14, 4
    v_mov_b32 v13, 0
    s_add_u32 s35, s34, 0
    s_mov_b64 exec, 1
    buffer_store_dword v14, v13, s[8:11], s35 offen
    s_mov_b64 exec, -1
    s_waitcnt lgkmcnt(6)
    v_mfma_f32_32x32x16_bf16 v[152:167], v[224:227], v[68:71], v[152:167]
    ds_read_b128 v[220:223], v3 offset:1024
    s_waitcnt lgkmcnt(6)
    v_mfma_f32_32x32x16_bf16 v[168:183], v[228:231], v[68:71], v[168:183]
    ds_read_b128 v[224:227], v3 offset:2048
    s_add_u32 s29, s25, 46080
    buffer_load_dwordx4 v[64:67], v3, s[8:11], s29 offen
    s_waitcnt lgkmcnt(6)
    v_mfma_f32_32x32x16_bf16 v[136:151], v[200:203], v[72:75], v[136:151]
    ds_read_b128 v[228:231], v3 offset:3072
    s_waitcnt lgkmcnt(6)
    v_mfma_f32_32x32x16_bf16 v[152:167], v[204:207], v[72:75], v[152:167]
    ds_read_b128 v[200:203], v3 offset:4096
    s_add_u32 s29, s25, 47104
    buffer_load_dwordx4 v[68:71], v3, s[8:11], s29 offen
    s_waitcnt lgkmcnt(6)
    v_mfma_f32_32x32x16_bf16 v[168:183], v[208:211], v[72:75], v[168:183]
    ds_read_b128 v[204:207], v3 offset:5120
    s_waitcnt lgkmcnt(6)
    v_mfma_f32_32x32x16_bf16 v[136:151], v[212:215], v[76:79], v[136:151]
    ds_read_b128 v[208:211], v3 offset:6144
    s_waitcnt lgkmcnt(6)
    v_mfma_f32_32x32x16_bf16 v[152:167], v[216:219], v[76:79], v[152:167]
    ds_read_b128 v[212:215], v3 offset:7168
    s_add_u32 s29, s25, 48128
    buffer_load_dwordx4 v[72:75], v3, s[8:11], s29 offen
    s_waitcnt lgkmcnt(6)
    v_mfma_f32_32x32x16_bf16 v[168:183], v[220:223], v[76:79], v[168:183]
    ds_read_b128 v[216:219], v3 offset:8192
    s_waitcnt lgkmcnt(6)
    v_mfma_f32_32x32x16_bf16 v[136:151], v[224:227], v[80:83], v[136:151]
    ds_read_b128 v[220:223], v3 offset:9216
    s_waitcnt lgkmcnt(6)
    v_mfma_f32_32x32x16_bf16 v[152:167], v[228:231], v[80:83], v[152:167]
    ds_read_b128 v[224:227], v3 offset:10240
    s_add_u32 s29, s25, 49152
    buffer_load_dwordx4 v[76:79], v3, s[8:11], s29 offen
    s_add_u32 s33, s32, 0
    v_and_b32 v245, 3, v2
    v_lshlrev_b32 v245, 8, v245
    buffer_load_dword v244, v245, s[8:11], s33 offen sc1
    s_waitcnt lgkmcnt(6)
    v_mfma_f32_32x32x16_bf16 v[168:183], v[200:203], v[80:83], v[168:183]
    ds_read_b128 v[228:231], v3 offset:11264
    s_waitcnt lgkmcnt(6)
    v_mfma_f32_32x32x16_bf16 v[136:151], v[204:207], v[84:87], v[136:151]
    ds_read_b128 v[200:203], v3 offset:12288
    s_waitcnt lgkmcnt(6)
    v_mfma_f32_32x32x16_bf16 v[152:167], v[208:211], v[84:87], v[152:167]
    ds_read_b128 v[204:207], v3 offset:13312
    s_waitcnt lgkmcnt(6)
    v_mfma_f32_32x32x16_bf16 v[168:183], v[212:215], v[84:87], v[168:183]
    ds_read_b128 v[208:211], v3 offset:14336
    s_waitcnt lgkmcnt(6)
    v_mfma_f32_32x32x16_bf16 v[136:151], v[216:219], v[88:91], v[136:151]
    ds_read_b128 v[212:215], v3 offset:15360
    s_waitcnt lgkmcnt(6)
    v_mfma_f32_32x32x16_bf16 v[152:167], v[220:223], v[88:91], v[152:167]
    ds_read_b128 v[216:219], v3 offset:16384
    s_waitcnt lgkmcnt(6)
    v_mfma_f32_32x32x16_bf16 v[168:183], v[224:227], v[88:91], v[168:183]
    ds_read_b128 v[220:223], v3 offset:17408
    s_waitcnt lgkmcnt(6)
    v_mfma_f32_32x32x16_bf16 v[136:151], v[228:231], v[92:95], v[136:151]
    ds_read_b128 v[224:227], v3 offset:18432
    s_waitcnt lgkmcnt(6)
    v_mfma_f32_32x32x16_bf16 v[152:167], v[200:203], v[92:95], v[152:167]
    ds_read_b128 v[228:231], v3 offset:19456
    s_waitcnt lgkmcnt(6)
    v_mfma_f32_32x32x16_bf16 v[168:183], v[204:207], v[92:95], v[168:183]
    ds_read_b128 v[200:203], v3 offset:20480
    s_waitcnt lgkmcnt(6)
    v_mfma_f32_32x32x16_bf16 v[136:151], v[208:211], v[96:99], v[136:151]
    ds_read_b128 v[204:207], v3 offset:21504
    s_waitcnt lgkmcnt(6)
    v_mfma_f32_32x32x16_bf16 v[152:167], v[212:215], v[96:99], v[152:167]
    ds_read_b128 v[208:211], v3 offset:22528
    s_waitcnt lgkmcnt(6)
    v_mfma_f32_32x32x16_bf16 v[168:183], v[216:219], v[96:99], v[168:183]
    ds_read_b128 v[212:215], v3 offset:23552
    s_waitcnt lgkmcnt(6)
    v_mfma_f32_32x32x16_bf16 v[136:151], v[220:223], v[100:103], v[136:151]
    ds_read_b128 v[216:219], v3 offset:24576
    s_waitcnt lgkmcnt(6)
    v_mfma_f32_32x32x16_bf16 v[152:167], v[224:227], v[100:103], v[152:167]
    ds_read_b128 v[220:223], v3 offset:25600
    s_waitcnt lgkmcnt(6)
    v_mfma_f32_32x32x16_bf16 v[168:183], v[228:231], v[100:103], v[168:183]
    ds_read_b128 v[224:227], v3 offset:26624
    s_waitcnt vmcnt(0)
    s_mov_b32 s61, 0
ffn_kernelf_fhl8:
    v_cmp_gt_u32 vcc, 4, v244
    s_add_u32 s61, s61, 1
    s_cmp_eq_u64 vcc, 0
    s_cbranch_scc1 ffn_kernelf_fhok7
    s_cmp_ge_u32 s61, 4000
    s_cbranch_scc1 ffn_kernelf_fhok7
    s_sleep 1
    buffer_load_dword v244, v245, s[8:11], s33 offen sc1
    s_waitcnt vmcnt(0)
    s_branch ffn_kernelf_fhl8
ffn_kernelf_fhok7:
    s_waitcnt lgkmcnt(6)
    v_mfma_f32_32x32x16_bf16 v[136:151], v[200:203], v[104:107], v[136:151]
    ds_read_b128 v[228:231], v3 offset:27648
    s_waitcnt lgkmcnt(6)
    v_mfma_f32_32x32x16_bf16 v[152:167], v[204:207], v[104:107], v[152:167]
    ds_read_b128 v[200:203], v3 offset:28672
    s_add_u32 s31, s30, 0
    buffer_load_dwordx4 v[80:83], v12, s[8:11], s31 offen offset:0 sc1
    s_waitcnt lgkmcnt(6)
    v_mfma_f32_32x32x16_bf16 v[168:183], v[208:211], v[104:107], v[168:183]
    ds_read_b128 v[204:207], v3 offset:29696
    s_add_u32 s31, s30, 0
    buffer_load_dwordx4 v[84:87], v12, s[8:11], s31 offen offset:256 sc1
    s_waitcnt lgkmcnt(6)
    v_mfma_f32_32x32x16_bf16 v[136:151], v[212:215], v[108:111], v[136:151]
    ds_read_b128 v[208:211], v3 offset:30720
    s_add_u32 s31, s30, 14336
    buffer_load_dwordx4 v[88:91], v12, s[8:11], s31 offen offset:0 sc1
    s_waitcnt lgkmcnt(6)
    v_mfma_f32_32x32x16_bf16 v[136:151], v[216:219], v[112:115], v[136:151]
    ds_read_b128 v[212:215], v3 offset:31744
    s_add_u32 s31, s30, 14336
    buffer_load_dwordx4 v[92:95], v12, s[8:11], s31 offen offset:256 sc1
    s_waitcnt lgkmcnt(6)
    v_mfma_f32_32x32x16_bf16 v[136:151], v[220:223], v[116:119], v[136:151]
    ds_read_b128 v[216:219], v3 offset:32768
    s_add_u32 s31, s30, 1024
    buffer_load_dwordx4 v[96:99], v12, s[8:11], s31 offen offset:0 sc1
    s_waitcnt lgkmcnt(6)
    v_mfma_f32_32x32x16_bf16 v[136:151], v[224:227], v[120:123], v[136:151]
    ds_read_b128 v[220:223], v3 offset:33792
    s_waitcnt lgkmcnt(6)
    v_mfma_f32_32x32x16_bf16 v[136:151], v[228:231], v[124:127], v[136:151]
    ds_read_b128 v[224:227], v3 offset:34816
    s_add_u32 s31, s30, 1024
    buffer_load_dwordx4 v[100:103], v12, s[8:11], s31 offen offset:256 sc1
    s_waitcnt lgkmcnt(6)
    v_mfma_f32_32x32x16_bf16 v[136:151], v[200:203], v[128:131], v[136:151]
    ds_read_b128 v[228:231], v3 offset:35840
    s_waitcnt lgkmcnt(6)
    v_mfma_f32_32x32x16_bf16 v[136:151], v[204:207], v[132:135], v[136:151]
    ds_read_b128 v[200:203], v3 offset:36864
    s_add_u32 s31, s30, 15360
    buffer_load_dwordx4 v[104:107], v12, s[8:11], s31 offen offset:0 sc1
    s_waitcnt lgkmcnt(6)
    v_mfma_f32_32x32x16_bf16 v[136:151], v[208:211], v[248:251], v[136:151]
    ds_read_b128 v[204:207], v3 offset:37888
    s_waitcnt lgkmcnt(6)
    v_mfma_f32_32x32x16_bf16 v[152:167], v[212:215], v[108:111], v[152:167]
    ds_read_b128 v[208:211], v3 offset:38912
    s_waitcnt lgkmcnt(6)
    v_mfma_f32_32x32x16_bf16 v[152:167], v[216:219], v[112:115], v[152:167]
    ds_read_b128 v[212:215], v3 offset:39936
    s_nop 4
    v_max_f32 v136, 0, v136
    v_max_f32 v137, 0, v137
    v_max_f32 v138, 0, v138
    v_max_f32 v139, 0, v139
    s_waitcnt lgkmcnt(6)
    v_mfma_f32_32x32x16_bf16 v[152:167], v[220:223], v[116:119], v[152:167]
    ds_read_b128 v[216:219], v3 offset:40960
    v_mul_f32 v140, v10, v140
    v_mul_f32 v141, v10, v141
    v_mul_f32 v142, v10, v142
    v_mul_f32 v143, v10, v143
    s_waitcnt lgkmcnt(6)
    v_mfma_f32_32x32x16_bf16 v[152:167], v[224:227], v[120:123], v[152:167]
    ds_read_b128 v[220:223], v3 offset:41984
    v_mul_f32 v136, v136, v140
    v_mul_f32 v137, v137, v141
    v_mul_f32 v138, v138, v142
    v_mul_f32 v139, v139, v143
    s_waitcnt lgkmcnt(6)
    v_mfma_f32_32x32x16_bf16 v[152:167], v[228:231], v[124:127], v[152:167]
    ds_read_b128 v[224:227], v3 offset:43008
    v_cvt_pk_bf16_f32 v232, v136, v137
    v_cvt_pk_bf16_f32 v233, v138, v139
    v_max_f32 v144, 0, v144
    v_max_f32 v145, 0, v145
    s_waitcnt lgkmcnt(6)
    v_mfma_f32_32x32x16_bf16 v[152:167], v[200:203], v[128:131], v[152:167]
    ds_read_b128 v[228:231], v3 offset:44032
    v_max_f32 v146, 0, v146
    v_max_f32 v147, 0, v147
    v_mul_f32 v148, v10, v148
    v_mul_f32 v149, v10, v149
    s_waitcnt lgkmcnt(6)
    v_mfma_f32_32x32x16_bf16 v[152:167], v[204:207], v[132:135], v[152:167]
    ds_read_b128 v[200:203], v3 offset:45056
    v_mul_f32 v150, v10, v150
    v_mul_f32 v151, v10, v151
    v_mul_f32 v144, v144, v148
    v_mul_f32 v145, v145, v149
    s_waitcnt lgkmcnt(6)
    v_mfma_f32_32x32x16_bf16 v[152:167], v[208:211], v[248:251], v[152:167]
    ds_read_b128 v[204:207], v3 offset:46080
    v_mul_f32 v146, v146, v150
    v_mul_f32 v147, v147, v151
    v_cvt_pk_bf16_f32 v234, v144, v145
    v_cvt_pk_bf16_f32 v235, v146, v147
    s_waitcnt lgkmcnt(6)
    v_mfma_f32_32x32x16_bf16 v[168:183], v[212:215], v[108:111], v[168:183]
    ds_read_b128 v[208:211], v3 offset:47104
    s_add_u32 s26, s36, 4096
    buffer_store_dwordx4 v[232:235], v3, s[8:11], s26 offen sc1
    s_waitcnt lgkmcnt(6)
    v_mfma_f32_32x32x16_bf16 v[168:183], v[216:219], v[112:115], v[168:183]
    v_max_f32 v152, 0, v152
    v_max_f32 v153, 0, v153
    v_max_f32 v154, 0, v154
    v_max_f32 v155, 0, v155
    s_waitcnt lgkmcnt(5)
    v_mfma_f32_32x32x16_bf16 v[168:183], v[220:223], v[116:119], v[168:183]
    v_mul_f32 v156, v10, v156
    v_mul_f32 v157, v10, v157
    v_mul_f32 v158, v10, v158
    v_mul_f32 v159, v10, v159
    s_add_u32 s31, s30, 15360
    buffer_load_dwordx4 v[108:111], v12, s[8:11], s31 offen offset:256 sc1
    s_waitcnt lgkmcnt(4)
    v_mfma_f32_32x32x16_bf16 v[168:183], v[224:227], v[120:123], v[168:183]
    v_mul_f32 v152, v152, v156
    v_mul_f32 v153, v153, v157
    v_mul_f32 v154, v154, v158
    v_mul_f32 v155, v155, v159
    s_add_u32 s31, s30, 2048
    buffer_load_dwordx4 v[112:115], v12, s[8:11], s31 offen offset:0 sc1
    s_waitcnt lgkmcnt(3)
    v_mfma_f32_32x32x16_bf16 v[168:183], v[228:231], v[124:127], v[168:183]
    v_cvt_pk_bf16_f32 v236, v152, v153
    v_cvt_pk_bf16_f32 v237, v154, v155
    v_max_f32 v160, 0, v160
    v_max_f32 v161, 0, v161
    s_add_u32 s31, s30, 2048
    buffer_load_dwordx4 v[116:119], v12, s[8:11], s31 offen offset:256 sc1
    s_waitcnt lgkmcnt(2)
    v_mfma_f32_32x32x16_bf16 v[168:183], v[200:203], v[128:131], v[168:183]
    v_max_f32 v162, 0, v162
    v_max_f32 v163, 0, v163
    v_mul_f32 v164, v10, v164
    v_mul_f32 v165, v10, v165
    s_add_u32 s31, s30, 16384
    buffer_load_dwordx4 v[120:123], v12, s[8:11], s31 offen offset:0 sc1
    s_waitcnt lgkmcnt(1)
    v_mfma_f32_32x32x16_bf16 v[168:183], v[204:207], v[132:135], v[168:183]
    v_mul_f32 v166, v10, v166
    v_mul_f32 v167, v10, v167
    v_mul_f32 v160, v160, v164
    v_mul_f32 v161, v161, v165
    s_add_u32 s31, s30, 16384
    buffer_load_dwordx4 v[124:127], v12, s[8:11], s31 offen offset:256 sc1
    s_waitcnt lgkmcnt(0)
    v_mfma_f32_32x32x16_bf16 v[168:183], v[208:211], v[248:251], v[168:183]
    v_mul_f32 v162, v162, v166
    v_mul_f32 v163, v163, v167
    v_cvt_pk_bf16_f32 v238, v160, v161
    v_cvt_pk_bf16_f32 v239, v162, v163
    s_add_u32 s26, s36, 5120
    buffer_store_dwordx4 v[236:239], v3, s[8:11], s26 offen sc1
    s_nop 5
    v_max_f32 v168, 0, v168
    v_max_f32 v169, 0, v169
    v_max_f32 v170, 0, v170
    v_max_f32 v171, 0, v171
    v_mul_f32 v172, v10, v172
    v_mul_f32 v173, v10, v173
    v_mul_f32 v174, v10, v174
    v_mul_f32 v175, v10, v175
    v_mul_f32 v168, v168, v172
    v_mul_f32 v169, v169, v173
    v_mul_f32 v170, v170, v174
    v_mul_f32 v171, v171, v175
    v_cvt_pk_bf16_f32 v232, v168, v169
    v_cvt_pk_bf16_f32 v233, v170, v171
    v_max_f32 v176, 0, v176
    v_max_f32 v177, 0, v177
    v_max_f32 v178, 0, v178
    v_max_f32 v179, 0, v179
    v_mul_f32 v180, v10, v180
    v_mul_f32 v181, v10, v181
    v_mul_f32 v182, v10, v182
    v_mul_f32 v183, v10, v183
    v_mul_f32 v176, v176, v180
    v_mul_f32 v177, v177, v181
    v_mul_f32 v178, v178, v182
    v_mul_f32 v179, v179, v183
    v_cvt_pk_bf16_f32 v234, v176, v177
    v_cvt_pk_bf16_f32 v235, v178, v179
    s_add_u32 s26, s36, 6144
    buffer_store_dwordx4 v[232:235], v3, s[8:11], s26 offen sc1
    s_waitcnt vmcnt(14)
    v_mfma_f32_16x16x32_bf16 v[200:203], a[0:3], v[80:83], 0
    s_waitcnt vmcnt(13)
    v_mfma_f32_16x16x32_bf16 v[204:207], a[0:3], v[84:87], 0
    s_add_u32 s29, s25, 57344
    buffer_load_dwordx4 v[128:131], v3, s[8:11], s29 offen
    v_mfma_f32_16x16x32_bf16 v[208:211], a[4:7], v[80:83], 0
    v_mfma_f32_16x16x32_bf16 v[212:215], a[4:7], v[84:87], 0
    v_mfma_f32_16x16x32_bf16 v[216:219], a[8:11], v[80:83], 0
    v_mfma_f32_16x16x32_bf16 v[220:223], a[8:11], v[84:87], 0
    s_add_u32 s29, s25, 58368
    buffer_load_dwordx4 v[132:135], v3, s[8:11], s29 offen
    v_mfma_f32_16x16x32_bf16 v[224:227], a[12:15], v[80:83], 0
    v_mfma_f32_16x16x32_bf16 v[228:231], a[12:15], v[84:87], 0
    v_mfma_f32_16x16x32_bf16 v[184:187], a[16:19], v[80:83], 0
    v_mfma_f32_16x16x32_bf16 v[188:191], a[16:19], v[84:87], 0
    s_add_u32 s29, s25, 59392
    buffer_load_dwordx4 v[136:139], v3, s[8:11], s29 offen
    v_mfma_f32_16x16x32_bf16 v[192:195], a[20:23], v[80:83], 0
    v_mfma_f32_16x16x32_bf16 v[196:199], a[20:23], v[84:87], 0
    v_mfma_f32_16x16x32_bf16 v[248:251], a[24:27], v[80:83], 0
    v_mfma_f32_16x16x32_bf16 v[252:255], a[24:27], v[84:87], 0
    s_add_u32 s29, s25, 60416
    buffer_load_dwordx4 v[140:143], v3, s[8:11], s29 offen
    s_waitcnt vmcnt(16)
    v_mfma_f32_16x16x32_bf16 v[200:203], a[28:31], v[88:91], v[200:203]
    s_waitcnt vmcnt(15)
    v_mfma_f32_16x16x32_bf16 v[204:207], a[28:31], v[92:95], v[204:207]
    v_mfma_f32_16x16x32_bf16 v[208:211], a[32:35], v[88:91], v[208:211]
    v_mfma_f32_16x16x32_bf16 v[212:215], a[32:35], v[92:95], v[212:215]
    s_add_u32 s29, s25, 61440
    buffer_load_dwordx4 v[144:147], v3, s[8:11], s29 offen
    v_mfma_f32_16x16x32_bf16 v[216:219], a[36:39], v[88:91], v[216:219]
    v_mfma_f32_16x16x32_bf16 v[220:223], a[36:39], v[92:95], v[220:223]
    v_mfma_f32_16x16x32_bf16 v[224:227], a[40:43], v[88:91], v[224:227]
    v_mfma_f32_16x16x32_bf16 v[228:231], a[40:43], v[92:95], v[228:231]
    s_add_u32 s29, s25, 62464
    buffer_load_dwordx4 v[148:151], v3, s[8:11], s29 offen
    v_mfma_f32_16x16x32_bf16 v[184:187], a[44:47], v[88:91], v[184:187]
    v_mfma_f32_16x16x32_bf16 v[188:191], a[44:47], v[92:95], v[188:191]
    v_mfma_f32_16x16x32_bf16 v[192:195], a[48:51], v[88:91], v[192:195]
    v_mfma_f32_16x16x32_bf16 v[196:199], a[48:51], v[92:95], v[196:199]
    s_add_u32 s29, s25, 63488
    buffer_load_dwordx4 v[152:155], v3, s[8:11], s29 offen
    v_mfma_f32_16x16x32_bf16 v[248:251], a[52:55], v[88:91], v[248:251]
    v_mfma_f32_16x16x32_bf16 v[252:255], a[52:55], v[92:95], v[252:255]
    s_waitcnt vmcnt(7)
    v_mov_b32 v14, 7
    v_mov_b32 v13, 0
    s_add_u32 s35, s34, 0
    s_mov_b64 exec, 1
    buffer_store_dword v14, v13, s[8:11], s35 offen
    s_mov_b64 exec, -1
    v_mfma_f32_16x16x32_bf16 v[200:203], a[56:59], v[96:99], v[200:203]
    v_mfma_f32_16x16x32_bf16 v[204:207], a[56:59], v[100:103], v[204:207]
    s_add_u32 s31, s30, 3072
    buffer_load_dwordx4 v[156:159], v12, s[8:11], s31 offen offset:0 sc1
    v_mfma_f32_16x16x32_bf16 v[208:211], a[60:63], v[96:99], v[208:211]
    v_mfma_f32_16x16x32_bf16 v[212:215], a[60:63], v[100:103], v[212:215]
    v_mfma_f32_16x16x32_bf16 v[216:219], a[64:67], v[96:99], v[216:219]
    v_mfma_f32_16x16x32_bf16 v[220:223], a[64:67], v[100:103], v[220:223]
    s_add_u32 s31, s30, 3072
    buffer_load_dwordx4 v[160:163], v12, s[8:11], s31 offen offset:256 sc1
    v_mfma_f32_16x16x32_bf16 v[224:227], a[68:71], v[96:99], v[224:227]
    v_mfma_f32_16x16x32_bf16 v[228:231], a[68:71], v[100:103], v[228:231]
    s_add_u32 s33, s32, 0
    v_and_b32 v245, 3, v2
    v_lshlrev_b32 v245, 8, v245
    buffer_load_dword v244, v245, s[8:11], s33 offen sc1
    v_mfma_f32_16x16x32_bf16 v[184:187], a[72:75], v[96:99], v[184:187]
    v_mfma_f32_16x16x32_bf16 v[188:191], a[72:75], v[100:103], v[188:191]
    s_add_u32 s31, s30, 17408
    buffer_load_dwordx4 v[164:167], v12, s[8:11], s31 offen offset:0 sc1
    v_mfma_f32_16x16x32_bf16 v[192:195], a[76:79], v[96:99], v[192:195]
    v_mfma_f32_16x16x32_bf16 v[196:199], a[76:79], v[100:103], v[196:199]
    v_mfma_f32_16x16x32_bf16 v[248:251], a[80:83], v[96:99], v[248:251]
    v_mfma_f32_16x16x32_bf16 v[252:255], a[80:83], v[100:103], v[252:255]
    s_add_u32 s31, s30, 17408
    buffer_load_dwordx4 v[168:171], v12, s[8:11], s31 offen offset:256 sc1
    v_mfma_f32_16x16x32_bf16 v[200:203], a[84:87], v[104:107], v[200:203]
    v_mfma_f32_16x16x32_bf16 v[204:207], a[84:87], v[108:111], v[204:207]
    v_mfma_f32_16x16x32_bf16 v[208:211], a[88:91], v[104:107], v[208:211]
    v_mfma_f32_16x16x32_bf16 v[212:215], a[88:91], v[108:111], v[212:215]
    s_add_u32 s29, s25, 71680
    buffer_load_dwordx4 v[172:175], v3, s[8:11], s29 offen
    v_mfma_f32_16x16x32_bf16 v[216:219], a[92:95], v[104:107], v[216:219]
    v_mfma_f32_16x16x32_bf16 v[220:223], a[92:95], v[108:111], v[220:223]
    v_mfma_f32_16x16x32_bf16 v[224:227], a[96:99], v[104:107], v[224:227]
    v_mfma_f32_16x16x32_bf16 v[228:231], a[96:99], v[108:111], v[228:231]
    s_add_u32 s29, s25, 72704
    buffer_load_dwordx4 v[176:179], v3, s[8:11], s29 offen
    v_mfma_f32_16x16x32_bf16 v[184:187], a[100:103], v[104:107], v[184:187]
    v_mfma_f32_16x16x32_bf16 v[188:191], a[100:103], v[108:111], v[188:191]
    v_mfma_f32_16x16x32_bf16 v[192:195], a[104:107], v[104:107], v[192:195]
    v_mfma_f32_16x16x32_bf16 v[196:199], a[104:107], v[108:111], v[196:199]
    s_add_u32 s29, s25, 73728
    buffer_load_dwordx4 v[180:183], v3, s[8:11], s29 offen
    v_mfma_f32_16x16x32_bf16 v[248:251], a[108:111], v[104:107], v[248:251]
    v_mfma_f32_16x16x32_bf16 v[252:255], a[108:111], v[108:111], v[252:255]
    s_waitcnt vmcnt(5)
    s_mov_b32 s61, 0
ffn_kernelf_fhl10:
    v_cmp_gt_u32 vcc, 7, v244
    s_add_u32 s61, s61, 1
    s_cmp_eq_u64 vcc, 0
    s_cbranch_scc1 ffn_kernelf_fhok9
    s_cmp_ge_u32 s61, 4000
    s_cbranch_scc1 ffn_kernelf_fhok9
    s_sleep 1
    buffer_load_dword v244, v245, s[8:11], s33 offen sc1
    s_waitcnt vmcnt(0)
    s_branch ffn_kernelf_fhl10
ffn_kernelf_fhok9:
    v_mfma_f32_16x16x32_bf16 v[200:203], v[24:27], v[112:115], v[200:203]
    v_mfma_f32_16x16x32_bf16 v[204:207], v[24:27], v[116:119], v[204:207]
    s_add_u32 s29, s25, 74752
    buffer_load_dwordx4 v[80:83], v3, s[8:11], s29 offen
    v_mfma_f32_16x16x32_bf16 v[208:211], v[28:31], v[112:115], v[208:211]
    v_mfma_f32_16x16x32_bf16 v[212:215], v[28:31], v[116:119], v[212:215]
    v_mfma_f32_16x16x32_bf16 v[216:219], v[32:35], v[112:115], v[216:219]
    v_mfma_f32_16x16x32_bf16 v[220:223], v[32:35], v[116:119], v[220:223]
    s_add_u32 s29, s25, 75776
    buffer_load_dwordx4 v[84:87], v3, s[8:11], s29 offen
    v_mfma_f32_16x16x32_bf16 v[224:227], v[36:39], v[112:115], v[224:227]
    v_mfma_f32_16x16x32_bf16 v[228:231], v[36:39], v[116:119], v[228:231]
    v_mfma_f32_16x16x32_bf16 v[184:187], v[40:43], v[112:115], v[184:187]
    s_add_u32 s31, s30, 4096
    buffer_load_dwordx4 v[96:99], v12, s[8:11], s31 offen offset:0 sc1
    v_mfma_f32_16x16x32_bf16 v[188:191], v[40:43], v[116:119], v[188:191]
    s_add_u32 s31, s30, 4096
    buffer_load_dwordx4 v[100:103], v12, s[8:11], s31 offen offset:256 sc1
    v_mfma_f32_16x16x32_bf16 v[192:195], v[44:47], v[112:115], v[192:195]
    v_mfma_f32_16x16x32_bf16 v[196:199], v[44:47], v[116:119], v[196:199]
    v_mfma_f32_16x16x32_bf16 v[248:251], v[48:51], v[112:115], v[248:251]
    v_mfma_f32_16x16x32_bf16 v[252:255], v[48:51], v[116:119], v[252:255]
    s_add_u32 s29, s25, 76800
    buffer_load_dwordx4 v[88:91], v3, s[8:11], s29 offen
    v_mfma_f32_16x16x32_bf16 v[200:203], a[112:115], v[120:123], v[200:203]
    v_mfma_f32_16x16x32_bf16 v[204:207], a[112:115], v[124:127], v[204:207]
    v_mfma_f32_16x16x32_bf16 v[208:211], a[116:119], v[120:123], v[208:211]
    v_mfma_f32_16x16x32_bf16 v[212:215], a[116:119], v[124:127], v[212:215]
    s_add_u32 s29, s25, 77824
    buffer_load_dwordx4 v[92:95], v3, s[8:11], s29 offen
    v_mfma_f32_16x16x32_bf16 v[216:219], a[120:123], v[120:123], v[216:219]
    v_mfma_f32_16x16x32_bf16 v[220:223], a[120:123], v[124:127], v[220:223]
    v_mfma_f32_16x16x32_bf16 v[224:227], a[124:127], v[120:123], v[224:227]
    v_mfma_f32_16x16x32_bf16 v[228:231], a[124:127], v[124:127], v[228:231]
    s_add_u32 s31, s30, 18432
    buffer_load_dwordx4 v[104:107], v12, s[8:11], s31 offen offset:0 sc1
    v_mfma_f32_16x16x32_bf16 v[184:187], a[128:131], v[120:123], v[184:187]
    v_mfma_f32_16x16x32_bf16 v[188:191], a[128:131], v[124:127], v[188:191]
    s_add_u32 s31, s30, 18432
    buffer_load_dwordx4 v[108:111], v12, s[8:11], s31 offen offset:256 sc1
    v_mfma_f32_16x16x32_bf16 v[192:195], a[132:135], v[120:123], v[192:195]
    v_mfma_f32_16x16x32_bf16 v[196:199], a[132:135], v[124:127], v[196:199]
    v_mfma_f32_16x16x32_bf16 v[248:251], a[136:139], v[120:123], v[248:251]
    v_mfma_f32_16x16x32_bf16 v[252:255], a[136:139], v[124:127], v[252:255]
    s_add_u32 s31, s30, 5120
    buffer_load_dwordx4 v[24:27], v12, s[8:11], s31 offen offset:0 sc1
    v_mfma_f32_16x16x32_bf16 v[200:203], v[52:55], v[156:159], v[200:203]
    v_mfma_f32_16x16x32_bf16 v[204:207], v[52:55], v[160:163], v[204:207]
    v_mfma_f32_16x16x32_bf16 v[208:211], v[56:59], v[156:159], v[208:211]
    v_mfma_f32_16x16x32_bf16 v[212:215], v[56:59], v[160:163], v[212:215]
    s_add_u32 s31, s30, 5120
    buffer_load_dwordx4 v[28:31], v12, s[8:11], s31 offen offset:256 sc1
    v_mfma_f32_16x16x32_bf16 v[216:219], v[60:63], v[156:159], v[216:219]
    v_mfma_f32_16x16x32_bf16 v[220:223], v[60:63], v[160:163], v[220:223]
    v_mfma_f32_16x16x32_bf16 v[224:227], v[64:67], v[156:159], v[224:227]
    v_mfma_f32_16x16x32_bf16 v[228:231], v[64:67], v[160:163], v[228:231]
    s_add_u32 s29, s25, 93184
    buffer_load_dwordx4 v[32:35], v3, s[8:11], s29 offen
    v_mfma_f32_16x16x32_bf16 v[184:187], v[68:71], v[156:159], v[184:187]
    v_mfma_f32_16x16x32_bf16 v[188:191], v[68:71], v[160:163], v[188:191]
    v_mfma_f32_16x16x32_bf16 v[192:195], v[72:75], v[156:159], v[192:195]
    v_mfma_f32_16x16x32_bf16 v[196:199], v[72:75], v[160:163], v[196:199]
    s_add_u32 s29, s25, 94208
    buffer_load_dwordx4 v[36:39], v3, s[8:11], s29 offen
    v_mfma_f32_16x16x32_bf16 v[248:251], v[76:79], v[156:159], v[248:251]
    v_mfma_f32_16x16x32_bf16 v[252:255], v[76:79], v[160:163], v[252:255]
    s_waitcnt vmcnt(16)
    v_mfma_f32_16x16x32_bf16 v[200:203], a[140:143], v[164:167], v[200:203]
    s_waitcnt vmcnt(15)
    v_mfma_f32_16x16x32_bf16 v[204:207], a[140:143], v[168:171], v[204:207]
    s_add_u32 s29, s25, 95232
    buffer_load_dwordx4 v[40:43], v3, s[8:11], s29 offen
    v_mfma_f32_16x16x32_bf16 v[208:211], a[144:147], v[164:167], v[208:211]
    v_mfma_f32_16x16x32_bf16 v[212:215], a[144:147], v[168:171], v[212:215]
    v_mfma_f32_16x16x32_bf16 v[216:219], a[148:151], v[164:167], v[216:219]
    v_mfma_f32_16x16x32_bf16 v[220:223], a[148:151], v[168:171], v[220:223]
    s_add_u32 s29, s25, 96256
    buffer_load_dwordx4 v[44:47], v3, s[8:11], s29 offen
    v_mfma_f32_16x16x32_bf16 v[224:227], a[152:155], v[164:167], v[224:227]
    v_mfma_f32_16x16x32_bf16 v[228:231], a[152:155], v[168:171], v[228:231]
    v_mfma_f32_16x16x32_bf16 v[184:187], a[156:159], v[164:167], v[184:187]
    s_add_u32 s31, s30, 19456
    buffer_load_dwordx4 v[120:123], v12, s[8:11], s31 offen offset:0 sc1
    v_mfma_f32_16x16x32_bf16 v[188:191], a[156:159], v[168:171], v[188:191]
    s_add_u32 s31, s30, 19456
    buffer_load_dwordx4 v[124:127], v12, s[8:11], s31 offen offset:256 sc1
    v_mfma_f32_16x16x32_bf16 v[192:195], a[160:163], v[164:167], v[192:195]
    s_add_u32 s31, s30, 6144
    buffer_load_dwordx4 v[52:55], v12, s[8:11], s31 offen offset:0 sc1
    v_mfma_f32_16x16x32_bf16 v[196:199], a[160:163], v[168:171], v[196:199]
    s_add_u32 s31, s30, 6144
    buffer_load_dwordx4 v[56:59], v12, s[8:11], s31 offen offset:256 sc1
    v_mfma_f32_16x16x32_bf16 v[248:251], a[164:167], v[164:167], v[248:251]
    s_add_u32 s31, s30, 20480
    buffer_load_dwordx4 v[60:63], v12, s[8:11], s31 offen offset:0 sc1
    v_mfma_f32_16x16x32_bf16 v[252:255], a[164:167], v[168:171], v[252:255]
    s_add_u32 s31, s30, 20480
    buffer_load_dwordx4 v[64:67], v12, s[8:11], s31 offen offset:256 sc1
    s_barrier
    s_waitcnt vmcnt(17)
    v_mfma_f32_16x16x32_bf16 v[200:203], v[128:131], v[96:99], v[200:203]
    s_waitcnt vmcnt(16)
    v_mfma_f32_16x16x32_bf16 v[204:207], v[128:131], v[100:103], v[204:207]
    v_mfma_f32_16x16x32_bf16 v[208:211], v[132:135], v[96:99], v[208:211]
    v_mfma_f32_16x16x32_bf16 v[212:215], v[132:135], v[100:103], v[212:215]
    s_add_u32 s29, s25, 97280
    buffer_load_dwordx4 v[48:51], v3, s[8:11], s29 offen
    v_mfma_f32_16x16x32_bf16 v[216:219], v[136:139], v[96:99], v[216:219]
    v_mfma_f32_16x16x32_bf16 v[220:223], v[136:139], v[100:103], v[220:223]
    v_mfma_f32_16x16x32_bf16 v[224:227], v[140:143], v[96:99], v[224:227]
    v_mfma_f32_16x16x32_bf16 v[228:231], v[140:143], v[100:103], v[228:231]
    s_add_u32 s29, s25, 98304
    buffer_load_dwordx4 v[112:115], v3, s[8:11], s29 offen
    v_mfma_f32_16x16x32_bf16 v[184:187], v[144:147], v[96:99], v[184:187]
    v_mfma_f32_16x16x32_bf16 v[188:191], v[144:147], v[100:103], v[188:191]
    v_mfma_f32_16x16x32_bf16 v[192:195], v[148:151], v[96:99], v[192:195]
    v_mfma_f32_16x16x32_bf16 v[196:199], v[148:151], v[100:103], v[196:199]
    s_add_u32 s29, s25, 99328
    buffer_load_dwordx4 v[116:119], v3, s[8:11], s29 offen
    v_mfma_f32_16x16x32_bf16 v[248:251], v[152:155], v[96:99], v[248:251]
    v_mfma_f32_16x16x32_bf16 v[252:255], v[152:155], v[100:103], v[252:255]
    s_waitcnt vmcnt(16)
    v_mfma_f32_16x16x32_bf16 v[200:203], a[168:171], v[104:107], v[200:203]
    s_waitcnt vmcnt(15)
    v_mfma_f32_16x16x32_bf16 v[204:207], a[168:171], v[108:111], v[204:207]
    s_add_u32 s26, s37, 6291456
    v_lshlrev_b32 v13, 4, v0
    buffer_load_dwordx4 v[68:71], v13, s[8:11], s26 offen sc1
    v_mfma_f32_16x16x32_bf16 v[208:211], a[172:175], v[104:107], v[208:211]
    s_add_u32 s26, s37, 6295552
    v_lshlrev_b32 v13, 4, v0
    v_mov_b32 v14, 2147483648
    v_cmp_gt_u32 vcc, 192, v0
    s_nop 1
    v_cndmask_b32 v13, v14, v13, vcc
    buffer_load_dwordx4 v[72:75], v13, s[8:11], s26 offen sc1
    v_mfma_f32_16x16x32_bf16 v[212:215], a[172:175], v[108:111], v[212:215]
    v_mfma_f32_16x16x32_bf16 v[216:219], a[176:179], v[104:107], v[216:219]
    v_mfma_f32_16x16x32_bf16 v[220:223], a[176:179], v[108:111], v[220:223]
    v_mfma_f32_16x16x32_bf16 v[224:227], a[180:183], v[104:107], v[224:227]
    v_mfma_f32_16x16x32_bf16 v[228:231], a[180:183], v[108:111], v[228:231]
    v_mfma_f32_16x16x32_bf16 v[184:187], a[184:187], v[104:107], v[184:187]
    v_mfma_f32_16x16x32_bf16 v[188:191], a[184:187], v[108:111], v[188:191]
    v_mfma_f32_16x16x32_bf16 v[192:195], a[188:191], v[104:107], v[192:195]
    v_mfma_f32_16x16x32_bf16 v[196:199], a[188:191], v[108:111], v[196:199]
    v_mfma_f32_16x16x32_bf16 v[248:251], a[192:195], v[104:107], v[248:251]
    v_mfma_f32_16x16x32_bf16 v[252:255], a[192:195], v[108:111], v[252:255]
    s_waitcnt vmcnt(16)
    v_mfma_f32_16x16x32_bf16 v[200:203], v[172:175], v[24:27], v[200:203]
    s_waitcnt vmcnt(15)
    v_mfma_f32_16x16x32_bf16 v[204:207], v[172:175], v[28:31], v[204:207]
    v_mfma_f32_16x16x32_bf16 v[208:211], v[176:179], v[24:27], v[208:211]
    v_mfma_f32_16x16x32_bf16 v[212:215], v[176:179], v[28:31], v[212:215]
    v_mfma_f32_16x16x32_bf16 v[216:219], v[180:183], v[24:27], v[216:219]
    v_mfma_f32_16x16x32_bf16 v[220:223], v[180:183], v[28:31], v[220:223]
    v_mfma_f32_16x16x32_bf16 v[224:227], v[80:83], v[24:27], v[224:227]
    v_mfma_f32_16x16x32_bf16 v[228:231], v[80:83], v[28:31], v[228:231]
    v_mfma_f32_16x16x32_bf16 v[184:187], v[84:87], v[24:27], v[184:187]
    v_mfma_f32_16x16x32_bf16 v[188:191], v[84:87], v[28:31], v[188:191]
    v_mfma_f32_16x16x32_bf16 v[192:195], v[88:91], v[24:27], v[192:195]
    v_mfma_f32_16x16x32_bf16 v[196:199], v[88:91], v[28:31], v[196:199]
    v_mfma_f32_16x16x32_bf16 v[248:251], v[92:95], v[24:27], v[248:251]
    v_mfma_f32_16x16x32_bf16 v[252:255], v[92:95], v[28:31], v[252:255]
    s_waitcnt vmcnt(10)
    v_mfma_f32_16x16x32_bf16 v[200:203], a[196:199], v[120:123], v[200:203]
    s_mul_i32 s26, s3, 14336
    v_add_u32 v6, s26, v3
    s_waitcnt vmcnt(9)
    v_mfma_f32_16x16x32_bf16 v[204:207], a[196:199], v[124:127], v[204:207]
    s_waitcnt vmcnt(8)
    v_mfma_f32_16x16x32_bf16 v[200:203], a[224:227], v[52:55], v[200:203]
    s_waitcnt vmcnt(7)
    v_mfma_f32_16x16x32_bf16 v[204:207], a[224:227], v[56:59], v[204:207]
    s_waitcnt vmcnt(6)
    v_mfma_f32_16x16x32_bf16 v[200:203], v[32:35], v[60:63], v[200:203]
    s_waitcnt vmcnt(5)
    v_mfma_f32_16x16x32_bf16 v[204:207], v[32:35], v[64:67], v[204:207]
    v_mfma_f32_16x16x32_bf16 v[208:211], a[200:203], v[120:123], v[208:211]
    v_mfma_f32_16x16x32_bf16 v[212:215], a[200:203], v[124:127], v[212:215]
    v_mfma_f32_16x16x32_bf16 v[208:211], a[228:231], v[52:55], v[208:211]
    s_nop 2
    ds_write_b128 v6, v[200:203] offset:0
    v_mfma_f32_16x16x32_bf16 v[212:215], a[228:231], v[56:59], v[212:215]
    ds_write_b128 v6, v[204:207] offset:1024
    v_mfma_f32_16x16x32_bf16 v[208:211], v[36:39], v[60:63], v[208:211]
    v_mfma_f32_16x16x32_bf16 v[212:215], v[36:39], v[64:67], v[212:215]
    v_mfma_f32_16x16x32_bf16 v[216:219], a[204:207], v[120:123], v[216:219]
    v_mfma_f32_16x16x32_bf16 v[220:223], a[204:207], v[124:127], v[220:223]
    v_mfma_f32_16x16x32_bf16 v[216:219], a[232:235], v[52:55], v[216:219]
    s_nop 3
    ds_write_b128 v6, v[208:211] offset:2048
    v_mfma_f32_16x16x32_bf16 v[220:223], a[232:235], v[56:59], v[220:223]
    ds_write_b128 v6, v[212:215] offset:3072
    v_mfma_f32_16x16x32_bf16 v[216:219], v[40:43], v[60:63], v[216:219]
    v_mfma_f32_16x16x32_bf16 v[220:223], v[40:43], v[64:67], v[220:223]
    v_mfma_f32_16x16x32_bf16 v[224:227], a[208:211], v[120:123], v[224:227]
    v_mfma_f32_16x16x32_bf16 v[228:231], a[208:211], v[124:127], v[228:231]
    v_mfma_f32_16x16x32_bf16 v[224:227], a[236:239], v[52:55], v[224:227]
    s_nop 3
    ds_write_b128 v6, v[216:219] offset:4096
    v_mfma_f32_16x16x32_bf16 v[228:231], a[236:239], v[56:59], v[228:231]
    ds_write_b128 v6, v[220:223] offset:5120
    v_mfma_f32_16x16x32_bf16 v[224:227], v[44:47], v[60:63], v[224:227]
    v_mfma_f32_16x16x32_bf16 v[228:231], v[44:47], v[64:67], v[228:231]
    v_mfma_f32_16x16x32_bf16 v[184:187], a[212:215], v[120:123], v[184:187]
    v_mfma_f32_16x16x32_bf16 v[188:191], a[212:215], v[124:127], v[188:191]
    v_mfma_f32_16x16x32_bf16 v[184:187], a[240:243], v[52:55], v[184:187]
    s_nop 3
    ds_write_b128 v6, v[224:227] offset:6144
    v_mfma_f32_16x16x32_bf16 v[188:191], a[240:243], v[56:59], v[188:191]
    ds_write_b128 v6, v[228:231] offset:7168
    s_waitcnt vmcnt(4)
    v_mfma_f32_16x16x32_bf16 v[184:187], v[48:51], v[60:63], v[184:187]
    v_mfma_f32_16x16x32_bf16 v[188:191], v[48:51], v[64:67], v[188:191]
    v_mfma_f32_16x16x32_bf16 v[192:195], a[216:219], v[120:123], v[192:195]
    v_mfma_f32_16x16x32_bf16 v[196:199], a[216:219], v[124:127], v[196:199]
    v_mfma_f32_16x16x32_bf16 v[192:195], a[244:247], v[52:55], v[192:195]
    s_nop 3
    ds_write_b128 v6, v[184:187] offset:8192
    v_mfma_f32_16x16x32_bf16 v[196:199], a[244:247], v[56:59], v[196:199]
    ds_write_b128 v6, v[188:191] offset:9216
    s_waitcnt vmcnt(3)
    v_mfma_f32_16x16x32_bf16 v[192:195], v[112:115], v[60:63], v[192:195]
    v_mfma_f32_16x16x32_bf16 v[196:199], v[112:115], v[64:67], v[196:199]
    v_mfma_f32_16x16x32_bf16 v[248:251], a[220:223], v[120:123], v[248:251]
    v_mfma_f32_16x16x32_bf16 v[252:255], a[220:223], v[124:127], v[252:255]
    v_mfma_f32_16x16x32_bf16 v[248:251], a[248:251], v[52:55], v[248:251]
    s_nop 3
    ds_write_b128 v6, v[192:195] offset:10240
    v_mfma_f32_16x16x32_bf16 v[252:255], a[248:251], v[56:59], v[252:255]
    ds_write_b128 v6, v[196:199] offset:11264
    s_waitcnt vmcnt(2)
    v_mfma_f32_16x16x32_bf16 v[248:251], v[116:119], v[60:63], v[248:251]
    v_mfma_f32_16x16x32_bf16 v[252:255], v[116:119], v[64:67], v[252:255]
    v_mov_b32 v13, v6
    v_lshlrev_b32 v6, 4, v0
    v_add_u32 v7, 4096, v6
    v_cmp_gt_u32 vcc, 192, v0
    v_mov_b32 v8, 2147483648
    s_nop 0
    v_cndmask_b32 v7, v8, v7, vcc
    v_and_b32 v9, 15, v2
    v_bfe_u32 v14, v2, 4, 1
    v_lshl_add_u32 v14, v1, 1, v14
    v_lshlrev_b32 v14, 10, v14
    v_lshrrev_b32 v15, 5, v2
    v_lshl_add_u32 v14, v15, 9, v14
    v_lshl_add_u32 v14, v9, 4, v14
    ds_write_b128 v13, v[248:251] offset:12288
    ds_write_b128 v13, v[252:255] offset:13312
    s_waitcnt lgkmcnt(0)
    s_barrier
    ds_read_b128 v[76:79], v14 offset:0
    ds_read_b128 v[80:83], v14 offset:256
    ds_read_b128 v[84:87], v14 offset:14336
    ds_read_b128 v[88:91], v14 offset:14592
    ds_read_b128 v[92:95], v14 offset:28672
    ds_read_b128 v[96:99], v14 offset:28928
    ds_read_b128 v[100:103], v14 offset:43008
    ds_read_b128 v[104:107], v14 offset:43264
    ds_read_b128 v[108:111], v14 offset:8192
    ds_read_b128 v[112:115], v14 offset:8448
    ds_read_b128 v[116:119], v14 offset:22528
    ds_read_b128 v[120:123], v14 offset:22784
    ds_read_b128 v[124:127], v14 offset:36864
    ds_read_b128 v[128:131], v14 offset:37120
    ds_read_b128 v[132:135], v14 offset:51200
    ds_read_b128 v[136:139], v14 offset:51456
    s_waitcnt vmcnt(0)
    s_waitcnt lgkmcnt(8)
    v_pk_add_f32 v[76:77], v[76:77], v[84:85]
    v_pk_add_f32 v[92:93], v[92:93], v[100:101]
    v_pk_add_f32 v[78:79], v[78:79], v[86:87]
    v_pk_add_f32 v[94:95], v[94:95], v[102:103]
    v_pk_add_f32 v[80:81], v[80:81], v[88:89]
    v_pk_add_f32 v[96:97], v[96:97], v[104:105]
    v_pk_add_f32 v[82:83], v[82:83], v[90:91]
    v_pk_add_f32 v[98:99], v[98:99], v[106:107]
    v_pk_add_f32 v[76:77], v[76:77], v[92:93]
    v_pk_add_f32 v[78:79], v[78:79], v[94:95]
    v_pk_add_f32 v[80:81], v[80:81], v[96:97]
    v_pk_add_f32 v[82:83], v[82:83], v[98:99]
    v_cvt_pk_bf16_f32 v84, v76, v77
    v_cvt_pk_bf16_f32 v85, v78, v79
    v_cvt_pk_bf16_f32 v86, v80, v81
    v_cvt_pk_bf16_f32 v87, v82, v83
    v_lshlrev_b32 v76, 16, v84
    v_and_b32 v77, 0xffff0000, v84
    v_lshlrev_b32 v92, 16, v16
    v_and_b32 v93, 0xffff0000, v16
    v_lshlrev_b32 v78, 16, v85
    v_and_b32 v79, 0xffff0000, v85
    v_lshlrev_b32 v94, 16, v17
    v_and_b32 v95, 0xffff0000, v17
    v_lshlrev_b32 v80, 16, v86
    v_and_b32 v81, 0xffff0000, v86
    v_lshlrev_b32 v96, 16, v18
    v_and_b32 v97, 0xffff0000, v18
    v_lshlrev_b32 v82, 16, v87
    v_and_b32 v83, 0xffff0000, v87
    v_lshlrev_b32 v98, 16, v19
    v_and_b32 v99, 0xffff0000, v19
    v_pk_add_f32 v[76:77], v[76:77], v[92:93]
    v_pk_add_f32 v[78:79], v[78:79], v[94:95]
    v_pk_add_f32 v[80:81], v[80:81], v[96:97]
    v_pk_add_f32 v[82:83], v[82:83], v[98:99]
    v_cvt_pk_bf16_f32 v16, v76, v77
    v_cvt_pk_bf16_f32 v17, v78, v79
    v_cvt_pk_bf16_f32 v18, v80, v81
    v_cvt_pk_bf16_f32 v19, v82, v83
    s_waitcnt lgkmcnt(0)
    v_pk_add_f32 v[108:109], v[108:109], v[116:117]
    v_pk_add_f32 v[124:125], v[124:125], v[132:133]
    v_pk_add_f32 v[110:111], v[110:111], v[118:119]
    v_pk_add_f32 v[126:127], v[126:127], v[134:135]
    v_pk_add_f32 v[112:113], v[112:113], v[120:121]
    v_pk_add_f32 v[128:129], v[128:129], v[136:137]
    v_pk_add_f32 v[114:115], v[114:115], v[122:123]
    v_pk_add_f32 v[130:131], v[130:131], v[138:139]
    v_pk_add_f32 v[108:109], v[108:109], v[124:125]
    v_pk_add_f32 v[110:111], v[110:111], v[126:127]
    v_pk_add_f32 v[112:113], v[112:113], v[128:129]
    v_pk_add_f32 v[114:115], v[114:115], v[130:131]
    v_cvt_pk_bf16_f32 v116, v108, v109
    v_cvt_pk_bf16_f32 v117, v110, v111
    v_cvt_pk_bf16_f32 v118, v112, v113
    v_cvt_pk_bf16_f32 v119, v114, v115
    v_lshlrev_b32 v108, 16, v116
    v_and_b32 v109, 0xffff0000, v116
    v_lshlrev_b32 v124, 16, v20
    v_and_b32 v125, 0xffff0000, v20
    v_lshlrev_b32 v110, 16, v117
    v_and_b32 v111, 0xffff0000, v117
    v_lshlrev_b32 v126, 16, v21
    v_and_b32 v127, 0xffff0000, v21
    v_lshlrev_b32 v112, 16, v118
    v_and_b32 v113, 0xffff0000, v118
    v_lshlrev_b32 v128, 16, v22
    v_and_b32 v129, 0xffff0000, v22
    v_lshlrev_b32 v114, 16, v119
    v_and_b32 v115, 0xffff0000, v119
    v_lshlrev_b32 v130, 16, v23
    v_and_b32 v131, 0xffff0000, v23
    v_pk_add_f32 v[108:109], v[108:109], v[124:125]
    v_pk_add_f32 v[110:111], v[110:111], v[126:127]
    v_pk_add_f32 v[112:113], v[112:113], v[128:129]
    v_pk_add_f32 v[114:115], v[114:115], v[130:131]
    v_cvt_pk_bf16_f32 v20, v108, v109
    v_cvt_pk_bf16_f32 v21, v110, v111
    v_cvt_pk_bf16_f32 v22, v112, v113
    v_cvt_pk_bf16_f32 v23, v114, v115
    v_and_b32 v11, 31, v2
    v_lshlrev_b32 v11, 3, v11
    v_lshrrev_b32 v15, 5, v2
    v_lshl_add_u32 v10, v15, 11, v11
    v_mov_b32 v8, 0
    v_mov_b32 v9, 0
    s_mov_b32 s27, 0x3f803f80
    v_dot2_f32_bf16 v8, v16, s27, v8
    v_dot2_f32_bf16 v9, v16, v16, v9
    v_dot2_f32_bf16 v8, v17, s27, v8
    v_dot2_f32_bf16 v9, v17, v17, v9
    v_dot2_f32_bf16 v8, v18, s27, v8
    v_dot2_f32_bf16 v9, v18, v18, v9
    v_dot2_f32_bf16 v8, v19, s27, v8
    v_dot2_f32_bf16 v9, v19, v19, v9
    s_cmp_eq_u32 s3, 3
    s_cbranch_scc1 ffn_kernelf_sk11
    v_dot2_f32_bf16 v8, v20, s27, v8
    v_dot2_f32_bf16 v9, v20, v20, v9
    v_dot2_f32_bf16 v8, v21, s27, v8
    v_dot2_f32_bf16 v9, v21, v21, v9
    v_dot2_f32_bf16 v8, v22, s27, v8
    v_dot2_f32_bf16 v9, v22, v22, v9
    v_dot2_f32_bf16 v8, v23, s27, v8
    v_dot2_f32_bf16 v9, v23, v23, v9
ffn_kernelf_sk11:
    s_nop 2
    v_mov_b32 v15, v8
    s_nop 1
    v_permlane32_swap_b32 v8, v15
    v_add_f32 v8, v8, v15
    v_mov_b32 v15, v9
    s_nop 1
    v_permlane32_swap_b32 v9, v15
    v_add_f32 v9, v9, v15
    v_or_b32 v9, 1, v9
    s_add_u32 s26, s38, 31457280
    s_mov_b32 exec_hi, 0
    buffer_store_dwordx2 v[8:9], v11, s[8:11], s26 offen
    s_mov_b64 exec, -1
    s_lshl_b32 s26, s21, 12
    s_add_u32 s26, s26, 31457280
    v_lshlrev_b32 v76, 16, v16
    v_and_b32 v77, 0xffff0000, v16
    v_lshlrev_b32 v84, 16, v68
    v_and_b32 v85, 0xffff0000, v68
    v_lshlrev_b32 v78, 16, v17
    v_and_b32 v79, 0xffff0000, v17
    v_lshlrev_b32 v86, 16, v69
    v_and_b32 v87, 0xffff0000, v69
    v_lshlrev_b32 v80, 16, v18
    v_and_b32 v81, 0xffff0000, v18
    v_lshlrev_b32 v88, 16, v70
    v_and_b32 v89, 0xffff0000, v70
    v_lshlrev_b32 v82, 16, v19
    v_and_b32 v83, 0xffff0000, v19
    v_lshlrev_b32 v90, 16, v71
    v_and_b32 v91, 0xffff0000, v71
    v_lshlrev_b32 v108, 16, v20
    v_and_b32 v109, 0xffff0000, v20
    v_lshlrev_b32 v116, 16, v72
    v_and_b32 v117, 0xffff0000, v72
    v_lshlrev_b32 v110, 16, v21
    v_and_b32 v111, 0xffff0000, v21
    v_lshlrev_b32 v118, 16, v73
    v_and_b32 v119, 0xffff0000, v73
    v_lshlrev_b32 v112, 16, v22
    v_and_b32 v113, 0xffff0000, v22
    v_lshlrev_b32 v120, 16, v74
    v_and_b32 v121, 0xffff0000, v74
    v_lshlrev_b32 v114, 16, v23
    v_and_b32 v115, 0xffff0000, v23
    v_lshlrev_b32 v122, 16, v75
    v_and_b32 v123, 0xffff0000, v75
    buffer_load_dwordx2 v[140:141], v10, s[8:11], s26 offen offset:0 sc1
    buffer_load_dwordx2 v[142:143], v10, s[8:11], s26 offen offset:256 sc1
    buffer_load_dwordx2 v[144:145], v10, s[8:11], s26 offen offset:512 sc1
    buffer_load_dwordx2 v[146:147], v10, s[8:11], s26 offen offset:768 sc1
    buffer_load_dwordx2 v[148:149], v10, s[8:11], s26 offen offset:1024 sc1
    buffer_load_dwordx2 v[150:151], v10, s[8:11], s26 offen offset:1280 sc1
    buffer_load_dwordx2 v[152:153], v10, s[8:11], s26 offen offset:1536 sc1
    buffer_load_dwordx2 v[154:155], v10, s[8:11], s26 offen offset:1792 sc1
    s_barrier
    s_add_u32 m0, s28, 0
    s_add_u32 s27, s24, 0
    buffer_load_dwordx4 v3, s[8:11], s27 offen lds
    s_add_u32 m0, s28, 4096
    s_add_u32 s27, s24, 4096
    buffer_load_dwordx4 v3, s[8:11], s27 offen lds
    s_add_u32 m0, s28, 8192
    s_add_u32 s27, s24, 8192
    buffer_load_dwordx4 v3, s[8:11], s27 offen lds
    s_waitcnt vmcnt(3)
    s_mov_b32 s61, 0
ffn_kernelf_stl13:
    v_and_b32 v15, v141, v143
    v_and_b32 v15, v15, v145
    v_and_b32 v15, v15, v147
    v_and_b32 v15, v15, v149
    v_and_b32 v15, v15, v151
    v_and_b32 v15, v15, v153
    v_and_b32 v15, v15, v155
    v_and_b32 v15, 1, v15
    v_cmp_eq_u32 vcc, 0, v15
    s_add_u32 s61, s61, 1
    s_cmp_eq_u64 vcc, 0
    s_cbranch_scc1 ffn_kernelf_stok12
    s_cmp_ge_u32 s61, 4000
    s_cbranch_scc1 ffn_kernelf_stok12
    s_sleep 1
    buffer_load_dwordx2 v[140:141], v10, s[8:11], s26 offen offset:0 sc1
    buffer_load_dwordx2 v[142:143], v10, s[8:11], s26 offen offset:256 sc1
    buffer_load_dwordx2 v[144:145], v10, s[8:11], s26 offen offset:512 sc1
    buffer_load_dwordx2 v[146:147], v10, s[8:11], s26 offen offset:768 sc1
    buffer_load_dwordx2 v[148:149], v10, s[8:11], s26 offen offset:1024 sc1
    buffer_load_dwordx2 v[150:151], v10, s[8:11], s26 offen offset:1280 sc1
    buffer_load_dwordx2 v[152:153], v10, s[8:11], s26 offen offset:1536 sc1
    buffer_load_dwordx2 v[154:155], v10, s[8:11], s26 offen offset:1792 sc1
    s_waitcnt vmcnt(0)
    s_branch ffn_kernelf_stl13
ffn_kernelf_stok12:
    v_pk_add_f32 v[140:141], v[140:141], v[148:149]
    v_pk_add_f32 v[142:143], v[142:143], v[150:151]
    v_pk_add_f32 v[144:145], v[144:145], v[152:153]
    v_pk_add_f32 v[146:147], v[146:147], v[154:155]
    v_pk_add_f32 v[140:141], v[140:141], v[144:145]
    v_pk_add_f32 v[142:143], v[142:143], v[146:147]
    v_pk_add_f32 v[140:141], v[140:141], v[142:143]
    v_mov_b32 v15, v140
    s_nop 1
    v_permlane32_swap_b32 v140, v15
    v_add_f32 v140, v140, v15
    v_mov_b32 v15, v141
    s_nop 1
    v_permlane32_swap_b32 v141, v15
    v_add_f32 v141, v141, v15
    v_mul_f32 v140, 0x3b124925, v140
    v_mul_f32 v141, 0x3b124925, v141
    v_fma_f32 v141, -v140, v140, v141
    v_max_f32 v141, 0, v141
    v_cvt_pk_bf16_f32 v142, v140, v140
    v_lshlrev_b32 v142, 16, v142
    v_cvt_pk_bf16_f32 v141, v141, v141
    v_lshlrev_b32 v141, 16, v141
    v_add_f32 v141, 0x3727c5ac, v141
    v_cvt_pk_bf16_f32 v141, v141, v141
    v_lshlrev_b32 v141, 16, v141
    v_sqrt_f32 v141, v141
    s_nop 0
    v_cvt_pk_bf16_f32 v141, v141, v141
    v_lshlrev_b32 v141, 16, v141
    v_rcp_f32 v144, v141
    s_nop 0
    v_mul_f32 v142, v142, v144
    v_mov_b32 v145, v144
    v_sub_f32 v142, 0, v142
    v_mov_b32 v143, v142
    v_pk_fma_f32 v[92:93], v[76:77], v[144:145], v[142:143]
    v_pk_fma_f32 v[94:95], v[78:79], v[144:145], v[142:143]
    v_pk_fma_f32 v[96:97], v[80:81], v[144:145], v[142:143]
    v_pk_fma_f32 v[98:99], v[82:83], v[144:145], v[142:143]
    v_pk_fma_f32 v[92:93], v[92:93], v[84:85], v[76:77]
    v_pk_fma_f32 v[94:95], v[94:95], v[86:87], v[78:79]
    v_pk_fma_f32 v[96:97], v[96:97], v[88:89], v[80:81]
    v_pk_fma_f32 v[98:99], v[98:99], v[90:91], v[82:83]
    v_cvt_pk_bf16_f32 v16, v92, v93
    v_cvt_pk_bf16_f32 v17, v94, v95
    v_cvt_pk_bf16_f32 v18, v96, v97
    v_cvt_pk_bf16_f32 v19, v98, v99
    s_add_u32 s26, s37, 12582912
    buffer_store_dwordx4 v[16:19], v6, s[8:11], s26 offen
    v_pk_fma_f32 v[124:125], v[108:109], v[144:145], v[142:143]
    v_pk_fma_f32 v[126:127], v[110:111], v[144:145], v[142:143]
    v_pk_fma_f32 v[128:129], v[112:113], v[144:145], v[142:143]
    v_pk_fma_f32 v[130:131], v[114:115], v[144:145], v[142:143]
    v_pk_fma_f32 v[124:125], v[124:125], v[116:117], v[108:109]
    v_pk_fma_f32 v[126:127], v[126:127], v[118:119], v[110:111]
    v_pk_fma_f32 v[128:129], v[128:129], v[120:121], v[112:113]
    v_pk_fma_f32 v[130:131], v[130:131], v[122:123], v[114:115]
    v_cvt_pk_bf16_f32 v20, v124, v125
    v_cvt_pk_bf16_f32 v21, v126, v127
    v_cvt_pk_bf16_f32 v22, v128, v129
    v_cvt_pk_bf16_f32 v23, v130, v131
    buffer_store_dwordx4 v[20:23], v7, s[8:11], s26 offen
    v_mov_b32 v8, 0
    v_mov_b32 v9, 0
    s_mov_b32 s27, 0x3f803f80
    v_dot2_f32_bf16 v8, v16, s27, v8
    v_dot2_f32_bf16 v9, v16, v16, v9
    v_dot2_f32_bf16 v8, v17, s27, v8
    v_dot2_f32_bf16 v9, v17, v17, v9
    v_dot2_f32_bf16 v8, v18, s27, v8
    v_dot2_f32_bf16 v9, v18, v18, v9
    v_dot2_f32_bf16 v8, v19, s27, v8
    v_dot2_f32_bf16 v9, v19, v19, v9
    s_cmp_eq_u32 s3, 3
    s_cbranch_scc1 ffn_kernelf_sk14
    v_dot2_f32_bf16 v8, v20, s27, v8
    v_dot2_f32_bf16 v9, v20, v20, v9
    v_dot2_f32_bf16 v8, v21, s27, v8
    v_dot2_f32_bf16 v9, v21, v21, v9
    v_dot2_f32_bf16 v8, v22, s27, v8
    v_dot2_f32_bf16 v9, v22, v22, v9
    v_dot2_f32_bf16 v8, v23, s27, v8
    v_dot2_f32_bf16 v9, v23, v23, v9
ffn_kernelf_sk14:
    s_nop 2
    v_mov_b32 v15, v8
    s_nop 1
    v_permlane32_swap_b32 v8, v15
    v_add_f32 v8, v8, v15
    v_mov_b32 v15, v9
    s_nop 1
    v_permlane32_swap_b32 v9, v15
    v_add_f32 v9, v9, v15
    v_or_b32 v9, 1, v9
    s_add_u32 s26, s38, 32768000
    s_waitcnt vmcnt(0)
    s_mov_b32 exec_hi, 0
    buffer_store_dwordx2 v[8:9], v11, s[8:11], s26 offen
    s_mov_b64 exec, -1
    v_mov_b32 v6, v10
    s_lshl_b32 s43, s20, 12
    s_add_u32 s43, s43, 32768000
    buffer_load_dwordx2 v[232:233], v6, s[8:11], s43 offen offset:0 sc1
    buffer_load_dwordx2 v[234:235], v6, s[8:11], s43 offen offset:256 sc1
    buffer_load_dwordx2 v[236:237], v6, s[8:11], s43 offen offset:512 sc1
    buffer_load_dwordx2 v[238:239], v6, s[8:11], s43 offen offset:768 sc1
    buffer_load_dwordx2 v[240:241], v6, s[8:11], s43 offen offset:1024 sc1
    buffer_load_dwordx2 v[242:243], v6, s[8:11], s43 offen offset:1280 sc1
    buffer_load_dwordx2 v[244:245], v6, s[8:11], s43 offen offset:1536 sc1
    buffer_load_dwordx2 v[246:247], v6, s[8:11], s43 offen offset:1792 sc1
    s_add_u32 m0, s28, 12288
    s_add_u32 s27, s24, 12288
    buffer_load_dwordx4 v3, s[8:11], s27 offen lds
    s_add_u32 m0, s28, 16384
    s_add_u32 s27, s24, 16384
    buffer_load_dwordx4 v3, s[8:11], s27 offen lds
    s_add_u32 m0, s28, 20480
    s_add_u32 s27, s24, 20480
    buffer_load_dwordx4 v3, s[8:11], s27 offen lds
    s_waitcnt vmcnt(3)
    s_mov_b32 s61, 0
ffn_kernelf_fxl16:
    v_and_b32 v15, v233, v235
    v_and_b32 v15, v15, v237
    v_and_b32 v15, v15, v239
    v_and_b32 v15, v15, v241
    v_and_b32 v15, v15, v243
    v_and_b32 v15, v15, v245
    v_and_b32 v15, v15, v247
    v_and_b32 v15, 1, v15
    v_cmp_eq_u32 vcc, 0, v15
    s_add_u32 s61, s61, 1
    s_cmp_eq_u64 vcc, 0
    s_cbranch_scc1 ffn_kernelf_fxok15
    s_cmp_ge_u32 s61, 4000
    s_cbranch_scc1 ffn_kernelf_fxok15
    s_sleep 1
    buffer_load_dwordx2 v[232:233], v6, s[8:11], s43 offen offset:0 sc1
    buffer_load_dwordx2 v[234:235], v6, s[8:11], s43 offen offset:256 sc1
    buffer_load_dwordx2 v[236:237], v6, s[8:11], s43 offen offset:512 sc1
    buffer_load_dwordx2 v[238:239], v6, s[8:11], s43 offen offset:768 sc1
    buffer_load_dwordx2 v[240:241], v6, s[8:11], s43 offen offset:1024 sc1
    buffer_load_dwordx2 v[242:243], v6, s[8:11], s43 offen offset:1280 sc1
    buffer_load_dwordx2 v[244:245], v6, s[8:11], s43 offen offset:1536 sc1
    buffer_load_dwordx2 v[246:247], v6, s[8:11], s43 offen offset:1792 sc1
    s_waitcnt vmcnt(0)
    s_branch ffn_kernelf_fxl16
ffn_kernelf_fxok15:
    s_add_u32 s26, s23, 4194304
    buffer_load_dwordx4 v[24:27], v3, s[8:11], s26 offen sc1
    s_add_u32 s26, s23, 4195328
    buffer_load_dwordx4 v[28:31], v3, s[8:11], s26 offen sc1
    s_add_u32 s26, s23, 4196352
    buffer_load_dwordx4 v[32:35], v3, s[8:11], s26 offen sc1
    s_add_u32 s26, s23, 4197376
    buffer_load_dwordx4 v[36:39], v3, s[8:11], s26 offen sc1
    s_add_u32 s26, s23, 4198400
    buffer_load_dwordx4 v[40:43], v3, s[8:11], s26 offen sc1
    s_add_u32 s26, s23, 4199424
    buffer_load_dwordx4 v[44:47], v3, s[8:11], s26 offen sc1
    s_add_u32 m0, s28, 24576
    s_add_u32 s27, s24, 24576
    buffer_load_dwordx4 v3, s[8:11], s27 offen lds
    s_add_u32 m0, s28, 28672
    s_add_u32 s27, s24, 28672
    buffer_load_dwordx4 v3, s[8:11], s27 offen lds
    s_add_u32 m0, s28, 32768
    s_add_u32 s27, s24, 32768
    buffer_load_dwordx4 v3, s[8:11], s27 offen lds
    s_add_u32 m0, s28, 36864
    s_add_u32 s27, s24, 36864
    buffer_load_dwordx4 v3, s[8:11], s27 offen lds
    s_add_u32 m0, s28, 40960
    s_add_u32 s27, s24, 40960
    buffer_load_dwordx4 v3, s[8:11], s27 offen lds
    s_add_u32 m0, s28, 45056
    s_add_u32 s27, s24, 45056
    buffer_load_dwordx4 v3, s[8:11], s27 offen lds
    s_add_u32 m0, s28, 49152
    s_add_u32 s27, s24, 49152
    buffer_load_dwordx4 v3, s[8:11], s27 offen lds
    s_add_u32 m0, s28, 53248
    s_add_u32 s27, s24, 53248
    buffer_load_dwordx4 v3, s[8:11], s27 offen lds
    s_add_u32 s26, s23, 4200448
    buffer_load_dwordx4 v[48:51], v3, s[8:11], s26 offen sc1
    s_add_u32 s26, s23, 4201472
    buffer_load_dwordx4 v[52:55], v3, s[8:11], s26 offen sc1
    s_add_u32 s26, s23, 4202496
    buffer_load_dwordx4 v[56:59], v3, s[8:11], s26 offen sc1
    s_add_u32 s26, s23, 4203520
    buffer_load_dwordx4 v[60:63], v3, s[8:11], s26 offen sc1
    s_add_u32 s26, s23, 4204544
    buffer_load_dwordx4 v[64:67], v3, s[8:11], s26 offen sc1
    s_waitcnt vmcnt(19)
    s_barrier
    ds_read_b128 v[200:203], v3 offset:0
    ds_read_b128 v[204:207], v3 offset:1024
    ds_read_b128 v[208:211], v3 offset:2048
    ds_read_b128 v[212:215], v3 offset:3072
    ds_read_b128 v[216:219], v3 offset:4096
    ds_read_b128 v[220:223], v3 offset:5120
    ds_read_b128 v[224:227], v3 offset:6144
    s_waitcnt vmcnt(18)
    s_waitcnt lgkmcnt(6)
    v_mfma_f32_32x32x16_bf16 v[136:151], v[200:203], v[24:27], 0
    ds_read_b128 v[228:231], v3 offset:7168
    s_waitcnt lgkmcnt(6)
    v_mfma_f32_32x32x16_bf16 v[152:167], v[204:207], v[24:27], 0
    ds_read_b128 v[200:203], v3 offset:8192
    s_add_u32 s26, s23, 4205568
    buffer_load_dwordx4 v[68:71], v3, s[8:11], s26 offen sc1
    s_waitcnt lgkmcnt(6)
    v_mfma_f32_32x32x16_bf16 v[168:183], v[208:211], v[24:27], 0
    ds_read_b128 v[204:207], v3 offset:9216
    s_waitcnt vmcnt(18)
    s_waitcnt lgkmcnt(6)
    v_mfma_f32_32x32x16_bf16 v[136:151], v[212:215], v[28:31], v[136:151]
    ds_read_b128 v[208:211], v3 offset:10240
    s_add_u32 s26, s23, 4206592
    buffer_load_dwordx4 v[72:75], v3, s[8:11], s26 offen sc1
    s_waitcnt lgkmcnt(6)
    v_mfma_f32_32x32x16_bf16 v[152:167], v[216:219], v[28:31], v[152:167]
    ds_read_b128 v[212:215], v3 offset:11264
    s_waitcnt lgkmcnt(6)
    v_mfma_f32_32x32x16_bf16 v[168:183], v[220:223], v[28:31], v[168:183]
    ds_read_b128 v[216:219], v3 offset:12288
    s_add_u32 s26, s23, 4207616
    buffer_load_dwordx4 v[76:79], v3, s[8:11], s26 offen sc1
    s_waitcnt vmcnt(19)
    s_waitcnt lgkmcnt(6)
    v_mfma_f32_32x32x16_bf16 v[136:151], v[224:227], v[32:35], v[136:151]
    ds_read_b128 v[220:223], v3 offset:13312
    s_waitcnt lgkmcnt(6)
    v_mfma_f32_32x32x16_bf16 v[152:167], v[228:231], v[32:35], v[152:167]
    ds_read_b128 v[224:227], v3 offset:14336
    s_add_u32 s26, s23, 4208640
    buffer_load_dwordx4 v[80:83], v3, s[8:11], s26 offen sc1
    s_waitcnt lgkmcnt(6)
    v_mfma_f32_32x32x16_bf16 v[168:183], v[200:203], v[32:35], v[168:183]
    ds_read_b128 v[228:231], v3 offset:15360
    s_waitcnt vmcnt(19)
    s_waitcnt lgkmcnt(6)
    v_mfma_f32_32x32x16_bf16 v[136:151], v[204:207], v[36:39], v[136:151]
    ds_read_b128 v[200:203], v3 offset:16384
    s_add_u32 s26, s23, 4209664
    buffer_load_dwordx4 v[84:87], v3, s[8:11], s26 offen sc1
    s_waitcnt lgkmcnt(6)
    v_mfma_f32_32x32x16_bf16 v[152:167], v[208:211], v[36:39], v[152:167]
    ds_read_b128 v[204:207], v3 offset:17408
    s_waitcnt lgkmcnt(6)
    v_mfma_f32_32x32x16_bf16 v[168:183], v[212:215], v[36:39], v[168:183]
    ds_read_b128 v[208:211], v3 offset:18432
    s_add_u32 s26, s23, 4210688
    buffer_load_dwordx4 v[88:91], v3, s[8:11], s26 offen sc1
    s_waitcnt vmcnt(20)
    s_waitcnt lgkmcnt(6)
    v_mfma_f32_32x32x16_bf16 v[136:151], v[216:219], v[40:43], v[136:151]
    ds_read_b128 v[212:215], v3 offset:19456
    s_waitcnt lgkmcnt(6)
    v_mfma_f32_32x32x16_bf16 v[152:167], v[220:223], v[40:43], v[152:167]
    ds_read_b128 v[216:219], v3 offset:20480
    s_add_u32 s26, s23, 4211712
    buffer_load_dwordx4 v[92:95], v3, s[8:11], s26 offen sc1
    s_waitcnt lgkmcnt(6)
    v_mfma_f32_32x32x16_bf16 v[168:183], v[224:227], v[40:43], v[168:183]
    ds_read_b128 v[220:223], v3 offset:21504
    s_waitcnt vmcnt(20)
    s_waitcnt lgkmcnt(6)
    v_mfma_f32_32x32x16_bf16 v[136:151], v[228:231], v[44:47], v[136:151]
    ds_read_b128 v[224:227], v3 offset:22528
    s_add_u32 s26, s23, 4212736
    buffer_load_dwordx4 v[96:99], v3, s[8:11], s26 offen sc1
    s_waitcnt lgkmcnt(6)
    v_mfma_f32_32x32x16_bf16 v[152:167], v[200:203], v[44:47], v[152:167]
    ds_read_b128 v[228:231], v3 offset:23552
    s_waitcnt vmcnt(13)
    s_barrier
    s_waitcnt lgkmcnt(6)
    v_mfma_f32_32x32x16_bf16 v[168:183], v[204:207], v[44:47], v[168:183]
    ds_read_b128 v[200:203], v3 offset:24576
    s_add_u32 s26, s23, 4213760
    buffer_load_dwordx4 v[100:103], v3, s[8:11], s26 offen sc1
    s_waitcnt vmcnt(13)
    s_waitcnt lgkmcnt(6)
    v_mfma_f32_32x32x16_bf16 v[136:151], v[208:211], v[48:51], v[136:151]
    ds_read_b128 v[204:207], v3 offset:25600
    s_waitcnt lgkmcnt(6)
    v_mfma_f32_32x32x16_bf16 v[152:167], v[212:215], v[48:51], v[152:167]
    ds_read_b128 v[208:211], v3 offset:26624
    s_add_u32 s26, s23, 4214784
    buffer_load_dwordx4 v[104:107], v3, s[8:11], s26 offen sc1
    s_waitcnt lgkmcnt(6)
    v_mfma_f32_32x32x16_bf16 v[168:183], v[216:219], v[48:51], v[168:183]
    ds_read_b128 v[212:215], v3 offset:27648
    s_waitcnt vmcnt(13)
    s_waitcnt lgkmcnt(6)
    v_mfma_f32_32x32x16_bf16 v[136:151], v[220:223], v[52:55], v[136:151]
    ds_read_b128 v[216:219], v3 offset:28672
    s_add_u32 s26, s23, 4215808
    buffer_load_dwordx4 v[108:111], v3, s[8:11], s26 offen sc1
    s_waitcnt lgkmcnt(6)
    v_mfma_f32_32x32x16_bf16 v[152:167], v[224:227], v[52:55], v[152:167]
    ds_read_b128 v[220:223], v3 offset:29696
    s_waitcnt lgkmcnt(6)
    v_mfma_f32_32x32x16_bf16 v[168:183], v[228:231], v[52:55], v[168:183]
    ds_read_b128 v[224:227], v3 offset:30720
    s_add_u32 s26, s23, 4216832
    buffer_load_dwordx4 v[112:115], v3, s[8:11], s26 offen sc1
    s_waitcnt vmcnt(14)
    s_waitcnt lgkmcnt(6)
    v_mfma_f32_32x32x16_bf16 v[136:151], v[200:203], v[56:59], v[136:151]
    ds_read_b128 v[228:231], v3 offset:31744
    s_waitcnt lgkmcnt(6)
    v_mfma_f32_32x32x16_bf16 v[152:167], v[204:207], v[56:59], v[152:167]
    ds_read_b128 v[200:203], v3 offset:32768
    s_add_u32 s26, s23, 4217856
    buffer_load_dwordx4 v[116:119], v3, s[8:11], s26 offen sc1
    s_waitcnt lgkmcnt(6)
    v_mfma_f32_32x32x16_bf16 v[168:183], v[208:211], v[56:59], v[168:183]
    ds_read_b128 v[204:207], v3 offset:33792
    s_waitcnt vmcnt(14)
    s_waitcnt lgkmcnt(6)
    v_mfma_f32_32x32x16_bf16 v[136:151], v[212:215], v[60:63], v[136:151]
    ds_read_b128 v[208:211], v3 offset:34816
    s_add_u32 s26, s23, 4218880
    buffer_load_dwordx4 v[120:123], v3, s[8:11], s26 offen sc1
    s_waitcnt lgkmcnt(6)
    v_mfma_f32_32x32x16_bf16 v[152:167], v[216:219], v[60:63], v[152:167]
    ds_read_b128 v[212:215], v3 offset:35840
    s_waitcnt lgkmcnt(6)
    v_mfma_f32_32x32x16_bf16 v[168:183], v[220:223], v[60:63], v[168:183]
    ds_read_b128 v[216:219], v3 offset:36864
    s_add_u32 s26, s23, 4219904
    buffer_load_dwordx4 v[124:127], v3, s[8:11], s26 offen sc1
    s_waitcnt vmcnt(15)
    s_waitcnt lgkmcnt(6)
    v_mfma_f32_32x32x16_bf16 v[136:151], v[224:227], v[64:67], v[136:151]
    ds_read_b128 v[220:223], v3 offset:37888
    s_waitcnt lgkmcnt(6)
    v_mfma_f32_32x32x16_bf16 v[152:167], v[228:231], v[64:67], v[152:167]
    ds_read_b128 v[224:227], v3 offset:38912
    s_add_u32 s26, s23, 4220928
    buffer_load_dwordx4 v[128:131], v3, s[8:11], s26 offen sc1
    s_waitcnt lgkmcnt(6)
    v_mfma_f32_32x32x16_bf16 v[168:183], v[200:203], v[64:67], v[168:183]
    ds_read_b128 v[228:231], v3 offset:39936
    s_waitcnt vmcnt(15)
    s_waitcnt lgkmcnt(6)
    v_mfma_f32_32x32x16_bf16 v[136:151], v[204:207], v[68:71], v[136:151]
    ds_read_b128 v[200:203], v3 offset:40960
    s_add_u32 s26, s23, 4221952
    buffer_load_dwordx4 v[132:135], v3, s[8:11], s26 offen sc1
    s_waitcnt lgkmcnt(6)
    v_mfma_f32_32x32x16_bf16 v[152:167], v[208:211], v[68:71], v[152:167]
    ds_read_b128 v[204:207], v3 offset:41984
    s_waitcnt lgkmcnt(6)
    v_mfma_f32_32x32x16_bf16 v[168:183], v[212:215], v[68:71], v[168:183]
    ds_read_b128 v[208:211], v3 offset:43008
    s_waitcnt vmcnt(15)
    s_waitcnt lgkmcnt(6)
    v_mfma_f32_32x32x16_bf16 v[136:151], v[216:219], v[72:75], v[136:151]
    ds_read_b128 v[212:215], v3 offset:44032
    s_waitcnt lgkmcnt(6)
    v_mfma_f32_32x32x16_bf16 v[152:167], v[220:223], v[72:75], v[152:167]
    ds_read_b128 v[216:219], v3 offset:45056
    s_waitcnt lgkmcnt(6)
    v_mfma_f32_32x32x16_bf16 v[168:183], v[224:227], v[72:75], v[168:183]
    ds_read_b128 v[220:223], v3 offset:46080
    s_waitcnt vmcnt(14)
    s_waitcnt lgkmcnt(6)
    v_mfma_f32_32x32x16_bf16 v[136:151], v[228:231], v[76:79], v[136:151]
    ds_read_b128 v[224:227], v3 offset:47104
    s_waitcnt lgkmcnt(6)
    v_mfma_f32_32x32x16_bf16 v[152:167], v[200:203], v[76:79], v[152:167]
    ds_read_b128 v[228:231], v3 offset:48128
    v_add_f32 v6, v232, v234
    v_add_f32 v7, v233, v235
    v_add_f32 v6, v6, v236
    v_add_f32 v7, v7, v237
    s_waitcnt lgkmcnt(6)
    v_mfma_f32_32x32x16_bf16 v[168:183], v[204:207], v[76:79], v[168:183]
    ds_read_b128 v[200:203], v3 offset:49152
    v_add_f32 v6, v6, v238
    v_add_f32 v7, v7, v239
    v_add_f32 v6, v6, v240
    v_add_f32 v7, v7, v241
    s_waitcnt vmcnt(13)
    s_waitcnt lgkmcnt(6)
    v_mfma_f32_32x32x16_bf16 v[136:151], v[208:211], v[80:83], v[136:151]
    ds_read_b128 v[204:207], v3 offset:50176
    v_add_f32 v6, v6, v242
    v_add_f32 v7, v7, v243
    v_add_f32 v6, v6, v244
    v_add_f32 v7, v7, v245
    s_waitcnt lgkmcnt(6)
    v_mfma_f32_32x32x16_bf16 v[152:167], v[212:215], v[80:83], v[152:167]
    ds_read_b128 v[208:211], v3 offset:51200
    v_add_f32 v6, v6, v246
    v_add_f32 v7, v7, v247
    v_mov_b32 v8, v6
    s_nop 1
    v_permlane32_swap_b32 v6, v8
    s_waitcnt lgkmcnt(6)
    v_mfma_f32_32x32x16_bf16 v[168:183], v[216:219], v[80:83], v[168:183]
    ds_read_b128 v[212:215], v3 offset:52224
    v_add_f32 v6, v6, v8
    v_mov_b32 v9, v7
    s_nop 1
    v_permlane32_swap_b32 v7, v9
    v_add_f32 v7, v7, v9
    s_waitcnt vmcnt(12)
    s_waitcnt lgkmcnt(6)
    v_mfma_f32_32x32x16_bf16 v[136:151], v[220:223], v[84:87], v[136:151]
    ds_read_b128 v[216:219], v3 offset:53248
    v_mul_f32 v6, 0x3b124925, v6
    v_mul_f32 v7, 0x3b124925, v7
    v_fma_f32 v7, -v6, v6, v7
    v_max_f32 v7, 0, v7
    s_waitcnt lgkmcnt(6)
    v_mfma_f32_32x32x16_bf16 v[152:167], v[224:227], v[84:87], v[152:167]
    ds_read_b128 v[220:223], v3 offset:54272
    v_cvt_pk_bf16_f32 v11, v6, v6
    v_lshlrev_b32 v11, 16, v11
    v_cvt_pk_bf16_f32 v7, v7, v7
    v_lshlrev_b32 v7, 16, v7
    s_waitcnt lgkmcnt(6)
    v_mfma_f32_32x32x16_bf16 v[168:183], v[228:231], v[84:87], v[168:183]
    ds_read_b128 v[224:227], v3 offset:55296
    v_add_f32 v7, 0x3727c5ac, v7
    v_cvt_pk_bf16_f32 v7, v7, v7
    v_lshlrev_b32 v7, 16, v7
    v_sqrt_f32 v7, v7
    s_waitcnt vmcnt(11)
    s_waitcnt lgkmcnt(6)
    v_mfma_f32_32x32x16_bf16 v[136:151], v[200:203], v[88:91], v[136:151]
    ds_read_b128 v[228:231], v3 offset:56320
    v_cvt_pk_bf16_f32 v7, v7, v7
    v_lshlrev_b32 v7, 16, v7
    v_rcp_f32 v10, v7
    v_cvt_pk_bf16_f32 v248, -v11, -v11
    s_waitcnt lgkmcnt(6)
    v_mfma_f32_32x32x16_bf16 v[152:167], v[204:207], v[88:91], v[152:167]
    ds_read_b128 v[200:203], v3 offset:57344
    v_mov_b32 v249, v248
    v_mov_b32 v250, v248
    v_mov_b32 v251, v248
    v_mul_f32 v10, v10, v10
    s_waitcnt lgkmcnt(6)
    v_mfma_f32_32x32x16_bf16 v[168:183], v[208:211], v[88:91], v[168:183]
    ds_read_b128 v[204:207], v3 offset:58368
    s_waitcnt vmcnt(10)
    s_waitcnt lgkmcnt(6)
    v_mfma_f32_32x32x16_bf16 v[136:151], v[212:215], v[92:95], v[136:151]
    ds_read_b128 v[208:211], v3 offset:59392
    s_waitcnt lgkmcnt(6)
    v_mfma_f32_32x32x16_bf16 v[152:167], v[216:219], v[92:95], v[152:167]
    ds_read_b128 v[212:215], v3 offset:60416
    s_waitcnt lgkmcnt(6)
    v_mfma_f32_32x32x16_bf16 v[168:183], v[220:223], v[92:95], v[168:183]
    ds_read_b128 v[216:219], v3 offset:61440
    s_waitcnt vmcnt(9)
    s_waitcnt lgkmcnt(6)
    v_mfma_f32_32x32x16_bf16 v[136:151], v[224:227], v[96:99], v[136:151]
    ds_read_b128 v[220:223], v3 offset:62464
    s_waitcnt lgkmcnt(6)
    v_mfma_f32_32x32x16_bf16 v[152:167], v[228:231], v[96:99], v[152:167]
    ds_read_b128 v[224:227], v3 offset:63488
    s_waitcnt lgkmcnt(6)
    v_mfma_f32_32x32x16_bf16 v[168:183], v[200:203], v[96:99], v[168:183]
    ds_read_b128 v[228:231], v3 offset:64512
    s_waitcnt vmcnt(8)
    s_waitcnt lgkmcnt(6)
    v_mfma_f32_32x32x16_bf16 v[136:151], v[204:207], v[100:103], v[136:151]
    ds_read_b128 v[200:203], v4 offset:0
    s_waitcnt lgkmcnt(6)
    v_mfma_f32_32x32x16_bf16 v[152:167], v[208:211], v[100:103], v[152:167]
    ds_read_b128 v[204:207], v4 offset:1024
    s_waitcnt lgkmcnt(6)
    v_mfma_f32_32x32x16_bf16 v[168:183], v[212:215], v[100:103], v[168:183]
    ds_read_b128 v[208:211], v4 offset:2048
    s_waitcnt vmcnt(7)
    s_waitcnt lgkmcnt(6)
    v_mfma_f32_32x32x16_bf16 v[136:151], v[216:219], v[104:107], v[136:151]
    ds_read_b128 v[212:215], v4 offset:3072
    s_waitcnt lgkmcnt(6)
    v_mfma_f32_32x32x16_bf16 v[152:167], v[220:223], v[104:107], v[152:167]
    ds_read_b128 v[216:219], v4 offset:4096
    s_barrier
    s_waitcnt lgkmcnt(6)
    v_mfma_f32_32x32x16_bf16 v[168:183], v[224:227], v[104:107], v[168:183]
    ds_read_b128 v[220:223], v4 offset:5120
    s_waitcnt vmcnt(6)
    s_waitcnt lgkmcnt(6)
    v_mfma_f32_32x32x16_bf16 v[136:151], v[228:231], v[108:111], v[136:151]
    ds_read_b128 v[224:227], v4 offset:6144
    s_add_u32 m0, s28, 0
    s_add_u32 s27, s24, 159744
    buffer_load_dwordx4 v3, s[8:11], s27 offen lds
    s_waitcnt lgkmcnt(6)
    v_mfma_f32_32x32x16_bf16 v[152:167], v[200:203], v[108:111], v[152:167]
    ds_read_b128 v[228:231], v4 offset:7168
    s_add_u32 m0, s28, 4096
    s_add_u32 s27, s24, 163840
    buffer_load_dwordx4 v3, s[8:11], s27 offen lds
    s_waitcnt lgkmcnt(6)
    v_mfma_f32_32x32x16_bf16 v[168:183], v[204:207], v[108:111], v[168:183]
    ds_read_b128 v[200:203], v4 offset:8192
    s_add_u32 m0, s28, 8192
    s_add_u32 s27, s24, 167936
    buffer_load_dwordx4 v3, s[8:11], s27 offen lds
    s_waitcnt vmcnt(8)
    s_waitcnt lgkmcnt(6)
    v_mfma_f32_32x32x16_bf16 v[136:151], v[208:211], v[112:115], v[136:151]
    ds_read_b128 v[204:207], v4 offset:9216
    s_add_u32 m0, s28, 12288
    s_add_u32 s27, s24, 172032
    buffer_load_dwordx4 v3, s[8:11], s27 offen lds
    s_waitcnt lgkmcnt(6)
    v_mfma_f32_32x32x16_bf16 v[152:167], v[212:215], v[112:115], v[152:167]
    ds_read_b128 v[208:211], v4 offset:10240
    s_add_u32 m0, s28, 16384
    s_add_u32 s27, s24, 176128
    buffer_load_dwordx4 v3, s[8:11], s27 offen lds
    s_waitcnt lgkmcnt(6)
    v_mfma_f32_32x32x16_bf16 v[168:183], v[216:219], v[112:115], v[168:183]
    ds_read_b128 v[212:215], v4 offset:11264
    s_waitcnt vmcnt(9)
    s_waitcnt lgkmcnt(6)
    v_mfma_f32_32x32x16_bf16 v[136:151], v[220:223], v[116:119], v[136:151]
    ds_read_b128 v[216:219], v4 offset:12288
    s_add_u32 m0, s28, 20480
    s_add_u32 s27, s24, 180224
    buffer_load_dwordx4 v3, s[8:11], s27 offen lds
    s_waitcnt lgkmcnt(6)
    v_mfma_f32_32x32x16_bf16 v[152:167], v[224:227], v[116:119], v[152:167]
    ds_read_b128 v[220:223], v4 offset:13312
    s_waitcnt lgkmcnt(6)
    v_mfma_f32_32x32x16_bf16 v[168:183], v[228:231], v[116:119], v[168:183]
    ds_read_b128 v[224:227], v4 offset:14336
    s_add_u32 m0, s28, 24576
    s_add_u32 s27, s24, 184320
    buffer_load_dwordx4 v3, s[8:11], s27 offen lds
    s_waitcnt vmcnt(10)
    s_waitcnt lgkmcnt(6)
    v_mfma_f32_32x32x16_bf16 v[136:151], v[200:203], v[120:123], v[136:151]
    ds_read_b128 v[228:231], v4 offset:15360
    s_waitcnt lgkmcnt(6)
    v_mfma_f32_32x32x16_bf16 v[152:167], v[204:207], v[120:123], v[152:167]
    ds_read_b128 v[200:203], v4 offset:16384
    s_add_u32 m0, s28, 28672
    s_add_u32 s27, s24, 188416
    buffer_load_dwordx4 v3, s[8:11], s27 offen lds
    s_waitcnt lgkmcnt(6)
    v_mfma_f32_32x32x16_bf16 v[168:183], v[208:211], v[120:123], v[168:183]
    ds_read_b128 v[204:207], v4 offset:17408
    s_waitcnt vmcnt(10)
    s_waitcnt lgkmcnt(6)
    v_mfma_f32_32x32x16_bf16 v[136:151], v[212:215], v[124:127], v[136:151]
    ds_read_b128 v[208:211], v4 offset:18432
    s_add_u32 m0, s28, 32768
    s_add_u32 s27, s24, 192512
    buffer_load_dwordx4 v3, s[8:11], s27 offen lds
    s_waitcnt lgkmcnt(6)
    v_mfma_f32_32x32x16_bf16 v[152:167], v[216:219], v[124:127], v[152:167]
    ds_read_b128 v[212:215], v4 offset:19456
    s_waitcnt lgkmcnt(6)
    v_mfma_f32_32x32x16_bf16 v[168:183], v[220:223], v[124:127], v[168:183]
    ds_read_b128 v[216:219], v4 offset:20480
    s_add_u32 m0, s28, 36864
    s_add_u32 s27, s24, 196608
    buffer_load_dwordx4 v3, s[8:11], s27 offen lds
    s_waitcnt vmcnt(11)
    s_waitcnt lgkmcnt(6)
    v_mfma_f32_32x32x16_bf16 v[136:151], v[224:227], v[128:131], v[136:151]
    ds_read_b128 v[220:223], v4 offset:21504
    s_waitcnt lgkmcnt(6)
    v_mfma_f32_32x32x16_bf16 v[152:167], v[228:231], v[128:131], v[152:167]
    ds_read_b128 v[224:227], v4 offset:22528
    s_add_u32 m0, s28, 40960
    s_add_u32 s27, s24, 200704
    buffer_load_dwordx4 v3, s[8:11], s27 offen lds
    s_waitcnt lgkmcnt(6)
    v_mfma_f32_32x32x16_bf16 v[168:183], v[200:203], v[128:131], v[168:183]
    ds_read_b128 v[228:231], v4 offset:23552
    s_waitcnt vmcnt(11)
    s_waitcnt lgkmcnt(6)
    v_mfma_f32_32x32x16_bf16 v[136:151], v[204:207], v[132:135], v[136:151]
    ds_read_b128 v[200:203], v4 offset:24576
    s_add_u32 m0, s28, 45056
    s_add_u32 s27, s24, 204800
    buffer_load_dwordx4 v3, s[8:11], s27 offen lds
    s_waitcnt lgkmcnt(6)
    v_mfma_f32_32x32x16_bf16 v[152:167], v[208:211], v[132:135], v[152:167]
    ds_read_b128 v[204:207], v4 offset:25600
    s_waitcnt lgkmcnt(6)
    v_mfma_f32_32x32x16_bf16 v[168:183], v[212:215], v[132:135], v[168:183]
    ds_read_b128 v[208:211], v4 offset:26624
    s_waitcnt lgkmcnt(6)
    v_mfma_f32_32x32x16_bf16 v[184:199], v[216:219], v[24:27], 0
    ds_read_b128 v[212:215], v4 offset:27648
    s_waitcnt lgkmcnt(6)
    v_mfma_f32_32x32x16_bf16 v[184:199], v[220:223], v[28:31], v[184:199]
    ds_read_b128 v[216:219], v4 offset:28672
    s_waitcnt lgkmcnt(6)
    v_mfma_f32_32x32x16_bf16 v[184:199], v[224:227], v[32:35], v[184:199]
    ds_read_b128 v[220:223], v4 offset:29696
    s_waitcnt lgkmcnt(6)
    v_mfma_f32_32x32x16_bf16 v[184:199], v[228:231], v[36:39], v[184:199]
    ds_read_b128 v[224:227], v4 offset:30720
    s_waitcnt lgkmcnt(6)
    v_mfma_f32_32x32x16_bf16 v[184:199], v[200:203], v[40:43], v[184:199]
    ds_read_b128 v[228:231], v4 offset:31744
    s_waitcnt lgkmcnt(6)
    v_mfma_f32_32x32x16_bf16 v[184:199], v[204:207], v[44:47], v[184:199]
    ds_read_b128 v[200:203], v4 offset:32768
    s_waitcnt lgkmcnt(6)
    v_mfma_f32_32x32x16_bf16 v[184:199], v[208:211], v[48:51], v[184:199]
    ds_read_b128 v[204:207], v4 offset:33792
    s_waitcnt lgkmcnt(6)
    v_mfma_f32_32x32x16_bf16 v[136:151], v[212:215], v[248:251], v[136:151]
    ds_read_b128 v[208:211], v4 offset:34816
    s_waitcnt lgkmcnt(6)
    v_mfma_f32_32x32x16_bf16 v[152:167], v[216:219], v[248:251], v[152:167]
    ds_read_b128 v[212:215], v4 offset:35840
    s_waitcnt lgkmcnt(6)
    v_mfma_f32_32x32x16_bf16 v[168:183], v[220:223], v[248:251], v[168:183]
    ds_read_b128 v[216:219], v4 offset:36864
    s_waitcnt lgkmcnt(6)
    v_mfma_f32_32x32x16_bf16 v[184:199], v[224:227], v[52:55], v[184:199]
    ds_read_b128 v[220:223], v4 offset:37888
    s_nop 1
    v_max_f32 v136, 0, v136
    v_max_f32 v137, 0, v137
    v_max_f32 v138, 0, v138
    v_max_f32 v139, 0, v139
    s_waitcnt lgkmcnt(6)
    v_mfma_f32_32x32x16_bf16 v[184:199], v[228:231], v[56:59], v[184:199]
    ds_read_b128 v[224:227], v4 offset:38912
    v_mul_f32 v140, v10, v140
    v_mul_f32 v141, v10, v141
    v_mul_f32 v142, v10, v142
    v_mul_f32 v143, v10, v143
    s_waitcnt lgkmcnt(6)
    v_mfma_f32_32x32x16_bf16 v[184:199], v[200:203], v[60:63], v[184:199]
    ds_read_b128 v[228:231], v4 offset:39936
    v_mul_f32 v136, v136, v140
    v_mul_f32 v137, v137, v141
    v_mul_f32 v138, v138, v142
    v_mul_f32 v139, v139, v143
    s_waitcnt lgkmcnt(6)
    v_mfma_f32_32x32x16_bf16 v[184:199], v[204:207], v[64:67], v[184:199]
    ds_read_b128 v[200:203], v4 offset:40960
    v_cvt_pk_bf16_f32 v232, v136, v137
    v_cvt_pk_bf16_f32 v233, v138, v139
    v_max_f32 v144, 0, v144
    v_max_f32 v145, 0, v145
    s_waitcnt lgkmcnt(6)
    v_mfma_f32_32x32x16_bf16 v[184:199], v[208:211], v[68:71], v[184:199]
    ds_read_b128 v[204:207], v4 offset:41984
    v_max_f32 v146, 0, v146
    v_max_f32 v147, 0, v147
    v_mul_f32 v148, v10, v148
    v_mul_f32 v149, v10, v149
    s_waitcnt lgkmcnt(6)
    v_mfma_f32_32x32x16_bf16 v[184:199], v[212:215], v[72:75], v[184:199]
    ds_read_b128 v[208:211], v4 offset:43008
    v_mul_f32 v150, v10, v150
    v_mul_f32 v151, v10, v151
    v_mul_f32 v144, v144, v148
    v_mul_f32 v145, v145, v149
    s_waitcnt lgkmcnt(6)
    v_mfma_f32_32x32x16_bf16 v[184:199], v[216:219], v[76:79], v[184:199]
    ds_read_b128 v[212:215], v4 offset:44032
    v_mul_f32 v146, v146, v150
    v_mul_f32 v147, v147, v151
    v_cvt_pk_bf16_f32 v234, v144, v145
    v_cvt_pk_bf16_f32 v235, v146, v147
    s_waitcnt lgkmcnt(6)
    v_mfma_f32_32x32x16_bf16 v[184:199], v[220:223], v[80:83], v[184:199]
    ds_read_b128 v[216:219], v4 offset:45056
    s_add_u32 s26, s36, 16777216
    buffer_store_dwordx4 v[232:235], v3, s[8:11], s26 offen sc1
    v_max_f32 v152, 0, v152
    v_max_f32 v153, 0, v153
    v_max_f32 v154, 0, v154
    s_waitcnt lgkmcnt(6)
    v_mfma_f32_32x32x16_bf16 v[184:199], v[224:227], v[84:87], v[184:199]
    ds_read_b128 v[220:223], v4 offset:46080
    v_max_f32 v155, 0, v155
    v_mul_f32 v156, v10, v156
    v_mul_f32 v157, v10, v157
    v_mul_f32 v158, v10, v158
    s_waitcnt lgkmcnt(6)
    v_mfma_f32_32x32x16_bf16 v[184:199], v[228:231], v[88:91], v[184:199]
    ds_read_b128 v[224:227], v4 offset:47104
    v_mul_f32 v159, v10, v159
    v_mul_f32 v152, v152, v156
    v_mul_f32 v153, v153, v157
    v_mul_f32 v154, v154, v158
    s_waitcnt lgkmcnt(6)
    v_mfma_f32_32x32x16_bf16 v[184:199], v[200:203], v[92:95], v[184:199]
    ds_read_b128 v[228:231], v4 offset:48128
    v_mul_f32 v155, v155, v159
    v_cvt_pk_bf16_f32 v236, v152, v153
    v_cvt_pk_bf16_f32 v237, v154, v155
    v_max_f32 v160, 0, v160
    s_waitcnt lgkmcnt(6)
    v_mfma_f32_32x32x16_bf16 v[184:199], v[204:207], v[96:99], v[184:199]
    ds_read_b128 v[200:203], v4 offset:49152
    v_max_f32 v161, 0, v161
    v_max_f32 v162, 0, v162
    v_max_f32 v163, 0, v163
    v_mul_f32 v164, v10, v164
    s_waitcnt lgkmcnt(6)
    v_mfma_f32_32x32x16_bf16 v[184:199], v[208:211], v[100:103], v[184:199]
    ds_read_b128 v[204:207], v4 offset:50176
    v_mul_f32 v165, v10, v165
    v_mul_f32 v166, v10, v166
    v_mul_f32 v167, v10, v167
    v_mul_f32 v160, v160, v164
    s_waitcnt lgkmcnt(6)
    v_mfma_f32_32x32x16_bf16 v[184:199], v[212:215], v[104:107], v[184:199]
    ds_read_b128 v[208:211], v4 offset:51200
    v_mul_f32 v161, v161, v165
    v_mul_f32 v162, v162, v166
    v_mul_f32 v163, v163, v167
    v_cvt_pk_bf16_f32 v238, v160, v161
    s_waitcnt lgkmcnt(6)
    v_mfma_f32_32x32x16_bf16 v[184:199], v[216:219], v[108:111], v[184:199]
    ds_read_b128 v[212:215], v4 offset:52224
    v_cvt_pk_bf16_f32 v239, v162, v163
    s_add_u32 s26, s36, 16778240
    buffer_store_dwordx4 v[236:239], v3, s[8:11], s26 offen sc1
    v_max_f32 v168, 0, v168
    v_max_f32 v169, 0, v169
    s_waitcnt lgkmcnt(6)
    v_mfma_f32_32x32x16_bf16 v[184:199], v[220:223], v[112:115], v[184:199]
    ds_read_b128 v[216:219], v4 offset:53248
    v_max_f32 v170, 0, v170
    v_max_f32 v171, 0, v171
    v_mul_f32 v172, v10, v172
    v_mul_f32 v173, v10, v173
    s_waitcnt lgkmcnt(6)
    v_mfma_f32_32x32x16_bf16 v[184:199], v[224:227], v[116:119], v[184:199]
    ds_read_b128 v[220:223], v4 offset:54272
    v_mul_f32 v174, v10, v174
    v_mul_f32 v175, v10, v175
    v_mul_f32 v168, v168, v172
    v_mul_f32 v169, v169, v173
    s_waitcnt lgkmcnt(6)
    v_mfma_f32_32x32x16_bf16 v[184:199], v[228:231], v[120:123], v[184:199]
    ds_read_b128 v[224:227], v4 offset:55296
    v_mul_f32 v170, v170, v174
    v_mul_f32 v171, v171, v175
    v_cvt_pk_bf16_f32 v232, v168, v169
    v_cvt_pk_bf16_f32 v233, v170, v171
    s_waitcnt lgkmcnt(6)
    v_mfma_f32_32x32x16_bf16 v[184:199], v[200:203], v[124:127], v[184:199]
    ds_read_b128 v[228:231], v4 offset:56320
    v_max_f32 v176, 0, v176
    v_max_f32 v177, 0, v177
    v_max_f32 v178, 0, v178
    v_max_f32 v179, 0, v179
    s_waitcnt lgkmcnt(6)
    v_mfma_f32_32x32x16_bf16 v[184:199], v[204:207], v[128:131], v[184:199]
    ds_read_b128 v[200:203], v4 offset:57344
    v_mul_f32 v180, v10, v180
    v_mul_f32 v181, v10, v181
    v_mul_f32 v182, v10, v182
    v_mul_f32 v183, v10, v183
    s_waitcnt lgkmcnt(6)
    v_mfma_f32_32x32x16_bf16 v[184:199], v[208:211], v[132:135], v[184:199]
    ds_read_b128 v[204:207], v4 offset:58368
    v_mul_f32 v176, v176, v180
    v_mul_f32 v177, v177, v181
    v_mul_f32 v178, v178, v182
    v_mul_f32 v179, v179, v183
    s_waitcnt lgkmcnt(6)
    v_mfma_f32_32x32x16_bf16 v[184:199], v[212:215], v[248:251], v[184:199]
    ds_read_b128 v[208:211], v4 offset:59392
    v_cvt_pk_bf16_f32 v234, v176, v177
    v_cvt_pk_bf16_f32 v235, v178, v179
    s_add_u32 s26, s36, 16779264
    buffer_store_dwordx4 v[232:235], v3, s[8:11], s26 offen sc1
    s_waitcnt lgkmcnt(6)
    v_mfma_f32_32x32x16_bf16 v[136:151], v[216:219], v[24:27], 0
    ds_read_b128 v[212:215], v4 offset:60416
    s_waitcnt lgkmcnt(6)
    v_mfma_f32_32x32x16_bf16 v[152:167], v[220:223], v[24:27], 0
    ds_read_b128 v[216:219], v4 offset:61440
    s_waitcnt lgkmcnt(6)
    v_mfma_f32_32x32x16_bf16 v[168:183], v[224:227], v[24:27], 0
    ds_read_b128 v[220:223], v4 offset:62464
    v_max_f32 v184, 0, v184
    v_max_f32 v185, 0, v185
    v_max_f32 v186, 0, v186
    v_max_f32 v187, 0, v187
    s_waitcnt lgkmcnt(6)
    v_mfma_f32_32x32x16_bf16 v[136:151], v[228:231], v[28:31], v[136:151]
    ds_read_b128 v[224:227], v4 offset:63488
    v_mul_f32 v188, v10, v188
    v_mul_f32 v189, v10, v189
    v_mul_f32 v190, v10, v190
    v_mul_f32 v191, v10, v191
    s_waitcnt lgkmcnt(6)
    v_mfma_f32_32x32x16_bf16 v[152:167], v[200:203], v[28:31], v[152:167]
    ds_read_b128 v[228:231], v4 offset:64512
    v_mul_f32 v184, v184, v188
    v_mul_f32 v185, v185, v189
    v_mul_f32 v186, v186, v190
    v_mul_f32 v187, v187, v191
    s_add_u32 s29, s25, 28672
    buffer_load_dwordx4 v[24:27], v3, s[8:11], s29 offen
    s_waitcnt lgkmcnt(6)
    v_mfma_f32_32x32x16_bf16 v[168:183], v[204:207], v[28:31], v[168:183]
    ds_read_b128 v[200:203], v5 offset:0
    v_cvt_pk_bf16_f32 v236, v184, v185
    v_cvt_pk_bf16_f32 v237, v186, v187
    v_max_f32 v192, 0, v192
    v_max_f32 v193, 0, v193
    s_waitcnt lgkmcnt(6)
    v_mfma_f32_32x32x16_bf16 v[136:151], v[208:211], v[32:35], v[136:151]
    ds_read_b128 v[204:207], v5 offset:1024
    v_max_f32 v194, 0, v194
    v_max_f32 v195, 0, v195
    v_mul_f32 v196, v10, v196
    v_mul_f32 v197, v10, v197
    s_waitcnt lgkmcnt(6)
    v_mfma_f32_32x32x16_bf16 v[152:167], v[212:215], v[32:35], v[152:167]
    ds_read_b128 v[208:211], v5 offset:2048
    v_mul_f32 v198, v10, v198
    v_mul_f32 v199, v10, v199
    v_mul_f32 v192, v192, v196
    v_mul_f32 v193, v193, v197
    s_add_u32 s29, s25, 29696
    buffer_load_dwordx4 v[28:31], v3, s[8:11], s29 offen
    s_waitcnt lgkmcnt(6)
    v_mfma_f32_32x32x16_bf16 v[168:183], v[216:219], v[32:35], v[168:183]
    ds_read_b128 v[212:215], v5 offset:3072
    v_mul_f32 v194, v194, v198
    v_mul_f32 v195, v195, v199
    v_cvt_pk_bf16_f32 v238, v192, v193
    v_cvt_pk_bf16_f32 v239, v194, v195
    s_waitcnt lgkmcnt(6)
    v_mfma_f32_32x32x16_bf16 v[136:151], v[220:223], v[36:39], v[136:151]
    ds_read_b128 v[216:219], v5 offset:4096
    s_add_u32 s26, s36, 16780288
    buffer_store_dwordx4 v[236:239], v3, s[8:11], s26 offen sc1
    s_waitcnt lgkmcnt(6)
    v_mfma_f32_32x32x16_bf16 v[152:167], v[224:227], v[36:39], v[152:167]
    ds_read_b128 v[220:223], v5 offset:5120
    s_add_u32 s29, s25, 30720
    buffer_load_dwordx4 v[32:35], v3, s[8:11], s29 offen
    s_waitcnt lgkmcnt(6)
    v_mfma_f32_32x32x16_bf16 v[168:183], v[228:231], v[36:39], v[168:183]
    ds_read_b128 v[224:227], v5 offset:6144
    s_waitcnt lgkmcnt(6)
    v_mfma_f32_32x32x16_bf16 v[136:151], v[200:203], v[40:43], v[136:151]
    ds_read_b128 v[228:231], v5 offset:7168
    s_waitcnt lgkmcnt(6)
    v_mfma_f32_32x32x16_bf16 v[152:167], v[204:207], v[40:43], v[152:167]
    ds_read_b128 v[200:203], v5 offset:8192
    s_add_u32 s29, s25, 31744
    buffer_load_dwordx4 v[36:39], v3, s[8:11], s29 offen
    s_waitcnt lgkmcnt(6)
    v_mfma_f32_32x32x16_bf16 v[168:183], v[208:211], v[40:43], v[168:183]
    ds_read_b128 v[204:207], v5 offset:9216
    s_waitcnt lgkmcnt(6)
    v_mfma_f32_32x32x16_bf16 v[136:151], v[212:215], v[44:47], v[136:151]
    ds_read_b128 v[208:211], v5 offset:10240
    s_waitcnt lgkmcnt(6)
    v_mfma_f32_32x32x16_bf16 v[152:167], v[216:219], v[44:47], v[152:167]
    ds_read_b128 v[212:215], v5 offset:11264
    s_add_u32 s29, s25, 32768
    buffer_load_dwordx4 v[40:43], v3, s[8:11], s29 offen
    s_waitcnt lgkmcnt(6)
    v_mfma_f32_32x32x16_bf16 v[168:183], v[220:223], v[44:47], v[168:183]
    ds_read_b128 v[216:219], v5 offset:12288
    s_waitcnt lgkmcnt(6)
    v_mfma_f32_32x32x16_bf16 v[136:151], v[224:227], v[48:51], v[136:151]
    ds_read_b128 v[220:223], v5 offset:13312
    s_waitcnt lgkmcnt(6)
    v_mfma_f32_32x32x16_bf16 v[152:167], v[228:231], v[48:51], v[152:167]
    ds_read_b128 v[224:227], v5 offset:14336
    s_add_u32 s29, s25, 33792
    buffer_load_dwordx4 v[44:47], v3, s[8:11], s29 offen
    s_waitcnt lgkmcnt(6)
    v_mfma_f32_32x32x16_bf16 v[168:183], v[200:203], v[48:51], v[168:183]
    ds_read_b128 v[228:231], v5 offset:15360
    s_waitcnt lgkmcnt(6)
    v_mfma_f32_32x32x16_bf16 v[136:151], v[204:207], v[52:55], v[136:151]
    ds_read_b128 v[200:203], v5 offset:16384
    s_waitcnt lgkmcnt(6)
    v_mfma_f32_32x32x16_bf16 v[152:167], v[208:211], v[52:55], v[152:167]
    ds_read_b128 v[204:207], v5 offset:17408
    s_add_u32 s29, s25, 34816
    buffer_load_dwordx4 v[48:51], v3, s[8:11], s29 offen
    s_waitcnt lgkmcnt(6)
    v_mfma_f32_32x32x16_bf16 v[168:183], v[212:215], v[52:55], v[168:183]
    ds_read_b128 v[208:211], v5 offset:18432
    s_waitcnt lgkmcnt(6)
    v_mfma_f32_32x32x16_bf16 v[136:151], v[216:219], v[56:59], v[136:151]
    ds_read_b128 v[212:215], v5 offset:19456
    s_waitcnt lgkmcnt(6)
    v_mfma_f32_32x32x16_bf16 v[152:167], v[220:223], v[56:59], v[152:167]
    ds_read_b128 v[216:219], v5 offset:20480
    s_add_u32 s29, s25, 43008
    buffer_load_dwordx4 v[52:55], v3, s[8:11], s29 offen
    s_waitcnt lgkmcnt(6)
    v_mfma_f32_32x32x16_bf16 v[168:183], v[224:227], v[56:59], v[168:183]
    ds_read_b128 v[220:223], v5 offset:21504
    s_waitcnt lgkmcnt(6)
    v_mfma_f32_32x32x16_bf16 v[136:151], v[228:231], v[60:63], v[136:151]
    ds_read_b128 v[224:227], v5 offset:22528
    s_waitcnt lgkmcnt(6)
    v_mfma_f32_32x32x16_bf16 v[152:167], v[200:203], v[60:63], v[152:167]
    ds_read_b128 v[228:231], v5 offset:23552
    s_add_u32 s29, s25, 44032
    buffer_load_dwordx4 v[56:59], v3, s[8:11], s29 offen
    s_waitcnt lgkmcnt(6)
    v_mfma_f32_32x32x16_bf16 v[168:183], v[204:207], v[60:63], v[168:183]
    ds_read_b128 v[200:203], v5 offset:24576
    s_waitcnt lgkmcnt(6)
    v_mfma_f32_32x32x16_bf16 v[136:151], v[208:211], v[64:67], v[136:151]
    ds_read_b128 v[204:207], v5 offset:25600
    s_waitcnt lgkmcnt(6)
    v_mfma_f32_32x32x16_bf16 v[152:167], v[212:215], v[64:67], v[152:167]
    ds_read_b128 v[208:211], v5 offset:26624
    s_add_u32 s29, s25, 45056
    buffer_load_dwordx4 v[60:63], v3, s[8:11], s29 offen
    s_waitcnt lgkmcnt(6)
    v_mfma_f32_32x32x16_bf16 v[168:183], v[216:219], v[64:67], v[168:183]
    ds_read_b128 v[212:215], v5 offset:27648
    s_waitcnt vmcnt(14)
    s_barrier
    s_waitcnt lgkmcnt(6)
    v_mfma_f32_32x32x16_bf16 v[136:151], v[220:223], v[68:71], v[136:151]
    ds_read_b128 v[216:219], v3 offset:0
    s_waitcnt vmcnt(8)
    v_mov_b32 v14, 4
    v_mov_b32 v13, 0
    s_add_u32 s35, s34, 262144
    s_mov_b64 exec, 1
    buffer_store_dword v14, v13, s[8:11], s35 offen
    s_mov_b64 exec, -1
    s_waitcnt lgkmcnt(6)
    v_mfma_f32_32x32x16_bf16 v[152:167], v[224:227], v[68:71], v[152:167]
    ds_read_b128 v[220:223], v3 offset:1024
    s_add_u32 s29, s25, 46080
    buffer_load_dwordx4 v[64:67], v3, s[8:11], s29 offen
    s_waitcnt lgkmcnt(6)
    v_mfma_f32_32x32x16_bf16 v[168:183], v[228:231], v[68:71], v[168:183]
    ds_read_b128 v[224:227], v3 offset:2048
    s_waitcnt lgkmcnt(6)
    v_mfma_f32_32x32x16_bf16 v[136:151], v[200:203], v[72:75], v[136:151]
    ds_read_b128 v[228:231], v3 offset:3072
    s_waitcnt lgkmcnt(6)
    v_mfma_f32_32x32x16_bf16 v[152:167], v[204:207], v[72:75], v[152:167]
    ds_read_b128 v[200:203], v3 offset:4096
    s_add_u32 s29, s25, 47104
    buffer_load_dwordx4 v[68:71], v3, s[8:11], s29 offen
    s_waitcnt lgkmcnt(6)
    v_mfma_f32_32x32x16_bf16 v[168:183], v[208:211], v[72:75], v[168:183]
    ds_read_b128 v[204:207], v3 offset:5120
    s_waitcnt lgkmcnt(6)
    v_mfma_f32_32x32x16_bf16 v[136:151], v[212:215], v[76:79], v[136:151]
    ds_read_b128 v[208:211], v3 offset:6144
    s_waitcnt lgkmcnt(6)
    v_mfma_f32_32x32x16_bf16 v[152:167], v[216:219], v[76:79], v[152:167]
    ds_read_b128 v[212:215], v3 offset:7168
    s_add_u32 s29, s25, 48128
    buffer_load_dwordx4 v[72:75], v3, s[8:11], s29 offen
    s_waitcnt lgkmcnt(6)
    v_mfma_f32_32x32x16_bf16 v[168:183], v[220:223], v[76:79], v[168:183]
    ds_read_b128 v[216:219], v3 offset:8192
    s_waitcnt lgkmcnt(6)
    v_mfma_f32_32x32x16_bf16 v[136:151], v[224:227], v[80:83], v[136:151]
    ds_read_b128 v[220:223], v3 offset:9216
    s_waitcnt lgkmcnt(6)
    v_mfma_f32_32x32x16_bf16 v[152:167], v[228:231], v[80:83], v[152:167]
    ds_read_b128 v[224:227], v3 offset:10240
    s_add_u32 s29, s25, 49152
    buffer_load_dwordx4 v[76:79], v3, s[8:11], s29 offen
    s_add_u32 s33, s32, 262144
    v_and_b32 v245, 3, v2
    v_lshlrev_b32 v245, 8, v245
    buffer_load_dword v244, v245, s[8:11], s33 offen sc1
    s_waitcnt lgkmcnt(6)
    v_mfma_f32_32x32x16_bf16 v[168:183], v[200:203], v[80:83], v[168:183]
    ds_read_b128 v[228:231], v3 offset:11264
    s_waitcnt lgkmcnt(6)
    v_mfma_f32_32x32x16_bf16 v[136:151], v[204:207], v[84:87], v[136:151]
    ds_read_b128 v[200:203], v3 offset:12288
    s_waitcnt lgkmcnt(6)
    v_mfma_f32_32x32x16_bf16 v[152:167], v[208:211], v[84:87], v[152:167]
    ds_read_b128 v[204:207], v3 offset:13312
    s_waitcnt lgkmcnt(6)
    v_mfma_f32_32x32x16_bf16 v[168:183], v[212:215], v[84:87], v[168:183]
    ds_read_b128 v[208:211], v3 offset:14336
    s_waitcnt lgkmcnt(6)
    v_mfma_f32_32x32x16_bf16 v[136:151], v[216:219], v[88:91], v[136:151]
    ds_read_b128 v[212:215], v3 offset:15360
    s_waitcnt lgkmcnt(6)
    v_mfma_f32_32x32x16_bf16 v[152:167], v[220:223], v[88:91], v[152:167]
    ds_read_b128 v[216:219], v3 offset:16384
    s_waitcnt lgkmcnt(6)
    v_mfma_f32_32x32x16_bf16 v[168:183], v[224:227], v[88:91], v[168:183]
    ds_read_b128 v[220:223], v3 offset:17408
    s_waitcnt lgkmcnt(6)
    v_mfma_f32_32x32x16_bf16 v[136:151], v[228:231], v[92:95], v[136:151]
    ds_read_b128 v[224:227], v3 offset:18432
    s_waitcnt lgkmcnt(6)
    v_mfma_f32_32x32x16_bf16 v[152:167], v[200:203], v[92:95], v[152:167]
    ds_read_b128 v[228:231], v3 offset:19456
    s_waitcnt lgkmcnt(6)
    v_mfma_f32_32x32x16_bf16 v[168:183], v[204:207], v[92:95], v[168:183]
    ds_read_b128 v[200:203], v3 offset:20480
    s_waitcnt lgkmcnt(6)
    v_mfma_f32_32x32x16_bf16 v[136:151], v[208:211], v[96:99], v[136:151]
    ds_read_b128 v[204:207], v3 offset:21504
    s_waitcnt lgkmcnt(6)
    v_mfma_f32_32x32x16_bf16 v[152:167], v[212:215], v[96:99], v[152:167]
    ds_read_b128 v[208:211], v3 offset:22528
    s_waitcnt lgkmcnt(6)
    v_mfma_f32_32x32x16_bf16 v[168:183], v[216:219], v[96:99], v[168:183]
    ds_read_b128 v[212:215], v3 offset:23552
    s_waitcnt lgkmcnt(6)
    v_mfma_f32_32x32x16_bf16 v[136:151], v[220:223], v[100:103], v[136:151]
    ds_read_b128 v[216:219], v3 offset:24576
    s_waitcnt lgkmcnt(6)
    v_mfma_f32_32x32x16_bf16 v[152:167], v[224:227], v[100:103], v[152:167]
    ds_read_b128 v[220:223], v3 offset:25600
    s_waitcnt lgkmcnt(6)
    v_mfma_f32_32x32x16_bf16 v[168:183], v[228:231], v[100:103], v[168:183]
    ds_read_b128 v[224:227], v3 offset:26624
    s_waitcnt vmcnt(0)
    s_mov_b32 s61, 0
ffn_kernelf_fhl18:
    v_cmp_gt_u32 vcc, 4, v244
    s_add_u32 s61, s61, 1
    s_cmp_eq_u64 vcc, 0
    s_cbranch_scc1 ffn_kernelf_fhok17
    s_cmp_ge_u32 s61, 4000
    s_cbranch_scc1 ffn_kernelf_fhok17
    s_sleep 1
    buffer_load_dword v244, v245, s[8:11], s33 offen sc1
    s_waitcnt vmcnt(0)
    s_branch ffn_kernelf_fhl18
ffn_kernelf_fhok17:
    s_waitcnt lgkmcnt(6)
    v_mfma_f32_32x32x16_bf16 v[136:151], v[200:203], v[104:107], v[136:151]
    ds_read_b128 v[228:231], v3 offset:27648
    s_add_u32 s31, s30, 16777216
    buffer_load_dwordx4 v[80:83], v12, s[8:11], s31 offen offset:0 sc1
    s_add_u32 s31, s30, 16777216
    buffer_load_dwordx4 v[84:87], v12, s[8:11], s31 offen offset:256 sc1
    s_waitcnt lgkmcnt(6)
    v_mfma_f32_32x32x16_bf16 v[152:167], v[204:207], v[104:107], v[152:167]
    ds_read_b128 v[200:203], v3 offset:28672
    s_add_u32 s31, s30, 16791552
    buffer_load_dwordx4 v[88:91], v12, s[8:11], s31 offen offset:0 sc1
    s_waitcnt lgkmcnt(6)
    v_mfma_f32_32x32x16_bf16 v[168:183], v[208:211], v[104:107], v[168:183]
    ds_read_b128 v[204:207], v3 offset:29696
    s_add_u32 s31, s30, 16791552
    buffer_load_dwordx4 v[92:95], v12, s[8:11], s31 offen offset:256 sc1
    s_waitcnt lgkmcnt(6)
    v_mfma_f32_32x32x16_bf16 v[136:151], v[212:215], v[108:111], v[136:151]
    ds_read_b128 v[208:211], v3 offset:30720
    s_waitcnt lgkmcnt(6)
    v_mfma_f32_32x32x16_bf16 v[136:151], v[216:219], v[112:115], v[136:151]
    ds_read_b128 v[212:215], v3 offset:31744
    s_add_u32 s31, s30, 16778240
    buffer_load_dwordx4 v[96:99], v12, s[8:11], s31 offen offset:0 sc1
    s_waitcnt lgkmcnt(6)
    v_mfma_f32_32x32x16_bf16 v[136:151], v[220:223], v[116:119], v[136:151]
    ds_read_b128 v[216:219], v3 offset:32768
    s_waitcnt lgkmcnt(6)
    v_mfma_f32_32x32x16_bf16 v[136:151], v[224:227], v[120:123], v[136:151]
    ds_read_b128 v[220:223], v3 offset:33792
    s_add_u32 s31, s30, 16778240
    buffer_load_dwordx4 v[100:103], v12, s[8:11], s31 offen offset:256 sc1
    s_waitcnt lgkmcnt(6)
    v_mfma_f32_32x32x16_bf16 v[136:151], v[228:231], v[124:127], v[136:151]
    ds_read_b128 v[224:227], v3 offset:34816
    s_waitcnt lgkmcnt(6)
    v_mfma_f32_32x32x16_bf16 v[136:151], v[200:203], v[128:131], v[136:151]
    ds_read_b128 v[228:231], v3 offset:35840
    s_add_u32 s31, s30, 16792576
    buffer_load_dwordx4 v[104:107], v12, s[8:11], s31 offen offset:0 sc1
    s_waitcnt lgkmcnt(6)
    v_mfma_f32_32x32x16_bf16 v[136:151], v[204:207], v[132:135], v[136:151]
    ds_read_b128 v[200:203], v3 offset:36864
    s_waitcnt lgkmcnt(6)
    v_mfma_f32_32x32x16_bf16 v[136:151], v[208:211], v[248:251], v[136:151]
    ds_read_b128 v[204:207], v3 offset:37888
    s_waitcnt lgkmcnt(6)
    v_mfma_f32_32x32x16_bf16 v[152:167], v[212:215], v[108:111], v[152:167]
    ds_read_b128 v[208:211], v3 offset:38912
    s_waitcnt lgkmcnt(6)
    v_mfma_f32_32x32x16_bf16 v[152:167], v[216:219], v[112:115], v[152:167]
    ds_read_b128 v[212:215], v3 offset:39936
    s_nop 4
    v_max_f32 v136, 0, v136
    v_max_f32 v137, 0, v137
    v_max_f32 v138, 0, v138
    v_max_f32 v139, 0, v139
    s_waitcnt lgkmcnt(6)
    v_mfma_f32_32x32x16_bf16 v[152:167], v[220:223], v[116:119], v[152:167]
    ds_read_b128 v[216:219], v3 offset:40960
    v_mul_f32 v140, v10, v140
    v_mul_f32 v141, v10, v141
    v_mul_f32 v142, v10, v142
    v_mul_f32 v143, v10, v143
    s_waitcnt lgkmcnt(6)
    v_mfma_f32_32x32x16_bf16 v[152:167], v[224:227], v[120:123], v[152:167]
    ds_read_b128 v[220:223], v3 offset:41984
    v_mul_f32 v136, v136, v140
    v_mul_f32 v137, v137, v141
    v_mul_f32 v138, v138, v142
    v_mul_f32 v139, v139, v143
    s_waitcnt lgkmcnt(6)
    v_mfma_f32_32x32x16_bf16 v[152:167], v[228:231], v[124:127], v[152:167]
    ds_read_b128 v[224:227], v3 offset:43008
    v_cvt_pk_bf16_f32 v232, v136, v137
    v_cvt_pk_bf16_f32 v233, v138, v139
    v_max_f32 v144, 0, v144
    v_max_f32 v145, 0, v145
    s_waitcnt lgkmcnt(6)
    v_mfma_f32_32x32x16_bf16 v[152:167], v[200:203], v[128:131], v[152:167]
    ds_read_b128 v[228:231], v3 offset:44032
    v_max_f32 v146, 0, v146
    v_max_f32 v147, 0, v147
    v_mul_f32 v148, v10, v148
    v_mul_f32 v149, v10, v149
    s_waitcnt lgkmcnt(6)
    v_mfma_f32_32x32x16_bf16 v[152:167], v[204:207], v[132:135], v[152:167]
    ds_read_b128 v[200:203], v3 offset:45056
    v_mul_f32 v150, v10, v150
    v_mul_f32 v151, v10, v151
    v_mul_f32 v144, v144, v148
    v_mul_f32 v145, v145, v149
    s_waitcnt lgkmcnt(6)
    v_mfma_f32_32x32x16_bf16 v[152:167], v[208:211], v[248:251], v[152:167]
    ds_read_b128 v[204:207], v3 offset:46080
    v_mul_f32 v146, v146, v150
    v_mul_f32 v147, v147, v151
    v_cvt_pk_bf16_f32 v234, v144, v145
    v_cvt_pk_bf16_f32 v235, v146, v147
    s_waitcnt lgkmcnt(6)
    v_mfma_f32_32x32x16_bf16 v[168:183], v[212:215], v[108:111], v[168:183]
    ds_read_b128 v[208:211], v3 offset:47104
    s_add_u32 s26, s36, 16781312
    buffer_store_dwordx4 v[232:235], v3, s[8:11], s26 offen sc1
    s_waitcnt lgkmcnt(6)
    v_mfma_f32_32x32x16_bf16 v[168:183], v[216:219], v[112:115], v[168:183]
    v_max_f32 v152, 0, v152
    v_max_f32 v153, 0, v153
    v_max_f32 v154, 0, v154
    v_max_f32 v155, 0, v155
    s_add_u32 s31, s30, 16792576
    buffer_load_dwordx4 v[108:111], v12, s[8:11], s31 offen offset:256 sc1
    s_waitcnt lgkmcnt(5)
    v_mfma_f32_32x32x16_bf16 v[168:183], v[220:223], v[116:119], v[168:183]
    v_mul_f32 v156, v10, v156
    v_mul_f32 v157, v10, v157
    v_mul_f32 v158, v10, v158
    v_mul_f32 v159, v10, v159
    s_waitcnt lgkmcnt(4)
    v_mfma_f32_32x32x16_bf16 v[168:183], v[224:227], v[120:123], v[168:183]
    v_mul_f32 v152, v152, v156
    v_mul_f32 v153, v153, v157
    v_mul_f32 v154, v154, v158
    v_mul_f32 v155, v155, v159
    s_add_u32 s31, s30, 16779264
    buffer_load_dwordx4 v[112:115], v12, s[8:11], s31 offen offset:0 sc1
    s_waitcnt lgkmcnt(3)
    v_mfma_f32_32x32x16_bf16 v[168:183], v[228:231], v[124:127], v[168:183]
    v_cvt_pk_bf16_f32 v236, v152, v153
    v_cvt_pk_bf16_f32 v237, v154, v155
    v_max_f32 v160, 0, v160
    v_max_f32 v161, 0, v161
    s_add_u32 s31, s30, 16779264
    buffer_load_dwordx4 v[116:119], v12, s[8:11], s31 offen offset:256 sc1
    s_waitcnt lgkmcnt(2)
    v_mfma_f32_32x32x16_bf16 v[168:183], v[200:203], v[128:131], v[168:183]
    v_max_f32 v162, 0, v162
    v_max_f32 v163, 0, v163
    v_mul_f32 v164, v10, v164
    v_mul_f32 v165, v10, v165
    s_add_u32 s31, s30, 16793600
    buffer_load_dwordx4 v[120:123], v12, s[8:11], s31 offen offset:0 sc1
    s_waitcnt lgkmcnt(1)
    v_mfma_f32_32x32x16_bf16 v[168:183], v[204:207], v[132:135], v[168:183]
    v_mul_f32 v166, v10, v166
    v_mul_f32 v167, v10, v167
    v_mul_f32 v160, v160, v164
    v_mul_f32 v161, v161, v165
    s_add_u32 s31, s30, 16793600
    buffer_load_dwordx4 v[124:127], v12, s[8:11], s31 offen offset:256 sc1
    s_waitcnt lgkmcnt(0)
    v_mfma_f32_32x32x16_bf16 v[168:183], v[208:211], v[248:251], v[168:183]
    v_mul_f32 v162, v162, v166
    v_mul_f32 v163, v163, v167
    v_cvt_pk_bf16_f32 v238, v160, v161
    v_cvt_pk_bf16_f32 v239, v162, v163
    s_add_u32 s29, s25, 57344
    buffer_load_dwordx4 v[128:131], v3, s[8:11], s29 offen
    s_add_u32 s26, s36, 16782336
    buffer_store_dwordx4 v[236:239], v3, s[8:11], s26 offen sc1
    s_nop 3
    v_max_f32 v168, 0, v168
    v_max_f32 v169, 0, v169
    v_max_f32 v170, 0, v170
    v_max_f32 v171, 0, v171
    v_mul_f32 v172, v10, v172
    v_mul_f32 v173, v10, v173
    v_mul_f32 v174, v10, v174
    v_mul_f32 v175, v10, v175
    v_mul_f32 v168, v168, v172
    v_mul_f32 v169, v169, v173
    v_mul_f32 v170, v170, v174
    v_mul_f32 v171, v171, v175
    v_cvt_pk_bf16_f32 v232, v168, v169
    v_cvt_pk_bf16_f32 v233, v170, v171
    v_max_f32 v176, 0, v176
    v_max_f32 v177, 0, v177
    v_max_f32 v178, 0, v178
    v_max_f32 v179, 0, v179
    v_mul_f32 v180, v10, v180
    v_mul_f32 v181, v10, v181
    v_mul_f32 v182, v10, v182
    v_mul_f32 v183, v10, v183
    v_mul_f32 v176, v176, v180
    v_mul_f32 v177, v177, v181
    v_mul_f32 v178, v178, v182
    v_mul_f32 v179, v179, v183
    v_cvt_pk_bf16_f32 v234, v176, v177
    v_cvt_pk_bf16_f32 v235, v178, v179
    s_add_u32 s26, s36, 16783360
    buffer_store_dwordx4 v[232:235], v3, s[8:11], s26 offen sc1
    s_waitcnt vmcnt(15)
    v_mfma_f32_16x16x32_bf16 v[200:203], a[0:3], v[80:83], 0
    s_waitcnt vmcnt(14)
    v_mfma_f32_16x16x32_bf16 v[204:207], a[0:3], v[84:87], 0
    v_mfma_f32_16x16x32_bf16 v[208:211], a[4:7], v[80:83], 0
    v_mfma_f32_16x16x32_bf16 v[212:215], a[4:7], v[84:87], 0
    s_add_u32 s29, s25, 58368
    buffer_load_dwordx4 v[132:135], v3, s[8:11], s29 offen
    v_mfma_f32_16x16x32_bf16 v[216:219], a[8:11], v[80:83], 0
    v_mfma_f32_16x16x32_bf16 v[220:223], a[8:11], v[84:87], 0
    v_mfma_f32_16x16x32_bf16 v[224:227], a[12:15], v[80:83], 0
    v_mfma_f32_16x16x32_bf16 v[228:231], a[12:15], v[84:87], 0
    s_add_u32 s29, s25, 59392
    buffer_load_dwordx4 v[136:139], v3, s[8:11], s29 offen
    v_mfma_f32_16x16x32_bf16 v[184:187], a[16:19], v[80:83], 0
    v_mfma_f32_16x16x32_bf16 v[188:191], a[16:19], v[84:87], 0
    v_mfma_f32_16x16x32_bf16 v[192:195], a[20:23], v[80:83], 0
    v_mfma_f32_16x16x32_bf16 v[196:199], a[20:23], v[84:87], 0
    s_add_u32 s29, s25, 60416
    buffer_load_dwordx4 v[140:143], v3, s[8:11], s29 offen
    v_mfma_f32_16x16x32_bf16 v[248:251], a[24:27], v[80:83], 0
    v_mfma_f32_16x16x32_bf16 v[252:255], a[24:27], v[84:87], 0
    s_waitcnt vmcnt(16)
    v_mfma_f32_16x16x32_bf16 v[200:203], a[28:31], v[88:91], v[200:203]
    s_waitcnt vmcnt(15)
    v_mfma_f32_16x16x32_bf16 v[204:207], a[28:31], v[92:95], v[204:207]
    s_add_u32 s29, s25, 61440
    buffer_load_dwordx4 v[144:147], v3, s[8:11], s29 offen
    v_mfma_f32_16x16x32_bf16 v[208:211], a[32:35], v[88:91], v[208:211]
    v_mfma_f32_16x16x32_bf16 v[212:215], a[32:35], v[92:95], v[212:215]
    v_mfma_f32_16x16x32_bf16 v[216:219], a[36:39], v[88:91], v[216:219]
    v_mfma_f32_16x16x32_bf16 v[220:223], a[36:39], v[92:95], v[220:223]
    s_add_u32 s29, s25, 62464
    buffer_load_dwordx4 v[148:151], v3, s[8:11], s29 offen
    v_mfma_f32_16x16x32_bf16 v[224:227], a[40:43], v[88:91], v[224:227]
    v_mfma_f32_16x16x32_bf16 v[228:231], a[40:43], v[92:95], v[228:231]
    v_mfma_f32_16x16x32_bf16 v[184:187], a[44:47], v[88:91], v[184:187]
    v_mfma_f32_16x16x32_bf16 v[188:191], a[44:47], v[92:95], v[188:191]
    s_add_u32 s29, s25, 63488
    buffer_load_dwordx4 v[152:155], v3, s[8:11], s29 offen
    v_mfma_f32_16x16x32_bf16 v[192:195], a[48:51], v[88:91], v[192:195]
    v_mfma_f32_16x16x32_bf16 v[196:199], a[48:51], v[92:95], v[196:199]
    s_add_u32 s31, s30, 16780288
    buffer_load_dwordx4 v[156:159], v12, s[8:11], s31 offen offset:0 sc1
    v_mfma_f32_16x16x32_bf16 v[248:251], a[52:55], v[88:91], v[248:251]
    s_add_u32 s31, s30, 16780288
    buffer_load_dwordx4 v[160:163], v12, s[8:11], s31 offen offset:256 sc1
    v_mfma_f32_16x16x32_bf16 v[252:255], a[52:55], v[92:95], v[252:255]
    s_waitcnt vmcnt(8)
    v_mov_b32 v14, 7
    v_mov_b32 v13, 0
    s_add_u32 s35, s34, 262144
    s_mov_b64 exec, 1
    buffer_store_dword v14, v13, s[8:11], s35 offen
    s_mov_b64 exec, -1
    v_mfma_f32_16x16x32_bf16 v[200:203], a[56:59], v[96:99], v[200:203]
    v_mfma_f32_16x16x32_bf16 v[204:207], a[56:59], v[100:103], v[204:207]
    v_mfma_f32_16x16x32_bf16 v[208:211], a[60:63], v[96:99], v[208:211]
    s_add_u32 s31, s30, 16794624
    buffer_load_dwordx4 v[164:167], v12, s[8:11], s31 offen offset:0 sc1
    v_mfma_f32_16x16x32_bf16 v[212:215], a[60:63], v[100:103], v[212:215]
    v_mfma_f32_16x16x32_bf16 v[216:219], a[64:67], v[96:99], v[216:219]
    v_mfma_f32_16x16x32_bf16 v[220:223], a[64:67], v[100:103], v[220:223]
    v_mfma_f32_16x16x32_bf16 v[224:227], a[68:71], v[96:99], v[224:227]
    s_add_u32 s31, s30, 16794624
    buffer_load_dwordx4 v[168:171], v12, s[8:11], s31 offen offset:256 sc1
    v_mfma_f32_16x16x32_bf16 v[228:231], a[68:71], v[100:103], v[228:231]
    s_add_u32 s33, s32, 262144
    v_and_b32 v245, 3, v2
    v_lshlrev_b32 v245, 8, v245
    buffer_load_dword v244, v245, s[8:11], s33 offen sc1
    v_mfma_f32_16x16x32_bf16 v[184:187], a[72:75], v[96:99], v[184:187]
    v_mfma_f32_16x16x32_bf16 v[188:191], a[72:75], v[100:103], v[188:191]
    v_mfma_f32_16x16x32_bf16 v[192:195], a[76:79], v[96:99], v[192:195]
    s_add_u32 s29, s25, 71680
    buffer_load_dwordx4 v[172:175], v3, s[8:11], s29 offen
    v_mfma_f32_16x16x32_bf16 v[196:199], a[76:79], v[100:103], v[196:199]
    v_mfma_f32_16x16x32_bf16 v[248:251], a[80:83], v[96:99], v[248:251]
    v_mfma_f32_16x16x32_bf16 v[252:255], a[80:83], v[100:103], v[252:255]
    v_mfma_f32_16x16x32_bf16 v[200:203], a[84:87], v[104:107], v[200:203]
    s_add_u32 s29, s25, 72704
    buffer_load_dwordx4 v[176:179], v3, s[8:11], s29 offen
    v_mfma_f32_16x16x32_bf16 v[204:207], a[84:87], v[108:111], v[204:207]
    v_mfma_f32_16x16x32_bf16 v[208:211], a[88:91], v[104:107], v[208:211]
    v_mfma_f32_16x16x32_bf16 v[212:215], a[88:91], v[108:111], v[212:215]
    v_mfma_f32_16x16x32_bf16 v[216:219], a[92:95], v[104:107], v[216:219]
    s_add_u32 s29, s25, 73728
    buffer_load_dwordx4 v[180:183], v3, s[8:11], s29 offen
    v_mfma_f32_16x16x32_bf16 v[220:223], a[92:95], v[108:111], v[220:223]
    v_mfma_f32_16x16x32_bf16 v[224:227], a[96:99], v[104:107], v[224:227]
    v_mfma_f32_16x16x32_bf16 v[228:231], a[96:99], v[108:111], v[228:231]
    v_mfma_f32_16x16x32_bf16 v[184:187], a[100:103], v[104:107], v[184:187]
    s_add_u32 s29, s25, 74752
    buffer_load_dwordx4 v[80:83], v3, s[8:11], s29 offen
    v_mfma_f32_16x16x32_bf16 v[188:191], a[100:103], v[108:111], v[188:191]
    v_mfma_f32_16x16x32_bf16 v[192:195], a[104:107], v[104:107], v[192:195]
    v_mfma_f32_16x16x32_bf16 v[196:199], a[104:107], v[108:111], v[196:199]
    v_mfma_f32_16x16x32_bf16 v[248:251], a[108:111], v[104:107], v[248:251]
    s_add_u32 s29, s25, 75776
    buffer_load_dwordx4 v[84:87], v3, s[8:11], s29 offen
    v_mfma_f32_16x16x32_bf16 v[252:255], a[108:111], v[108:111], v[252:255]
    s_waitcnt vmcnt(5)
    s_mov_b32 s61, 0
ffn_kernelf_fhl20:
    v_cmp_gt_u32 vcc, 7, v244
    s_add_u32 s61, s61, 1
    s_cmp_eq_u64 vcc, 0
    s_cbranch_scc1 ffn_kernelf_fhok19
    s_cmp_ge_u32 s61, 4000
    s_cbranch_scc1 ffn_kernelf_fhok19
    s_sleep 1
    buffer_load_dword v244, v245, s[8:11], s33 offen sc1
    s_waitcnt vmcnt(0)
    s_branch ffn_kernelf_fhl20
ffn_kernelf_fhok19:
    v_mfma_f32_16x16x32_bf16 v[200:203], v[24:27], v[112:115], v[200:203]
    s_add_u32 s31, s30, 16781312
    buffer_load_dwordx4 v[96:99], v12, s[8:11], s31 offen offset:0 sc1
    s_add_u32 s31, s30, 16781312
    buffer_load_dwordx4 v[100:103], v12, s[8:11], s31 offen offset:256 sc1
    v_mfma_f32_16x16x32_bf16 v[204:207], v[24:27], v[116:119], v[204:207]
    v_mfma_f32_16x16x32_bf16 v[208:211], v[28:31], v[112:115], v[208:211]
    v_mfma_f32_16x16x32_bf16 v[212:215], v[28:31], v[116:119], v[212:215]
    v_mfma_f32_16x16x32_bf16 v[216:219], v[32:35], v[112:115], v[216:219]
    s_add_u32 s29, s25, 76800
    buffer_load_dwordx4 v[88:91], v3, s[8:11], s29 offen
    v_mfma_f32_16x16x32_bf16 v[220:223], v[32:35], v[116:119], v[220:223]
    v_mfma_f32_16x16x32_bf16 v[224:227], v[36:39], v[112:115], v[224:227]
    v_mfma_f32_16x16x32_bf16 v[228:231], v[36:39], v[116:119], v[228:231]
    v_mfma_f32_16x16x32_bf16 v[184:187], v[40:43], v[112:115], v[184:187]
    s_add_u32 s29, s25, 77824
    buffer_load_dwordx4 v[92:95], v3, s[8:11], s29 offen
    v_mfma_f32_16x16x32_bf16 v[188:191], v[40:43], v[116:119], v[188:191]
    v_mfma_f32_16x16x32_bf16 v[192:195], v[44:47], v[112:115], v[192:195]
    v_mfma_f32_16x16x32_bf16 v[196:199], v[44:47], v[116:119], v[196:199]
    s_add_u32 s31, s30, 16795648
    buffer_load_dwordx4 v[104:107], v12, s[8:11], s31 offen offset:0 sc1
    v_mfma_f32_16x16x32_bf16 v[248:251], v[48:51], v[112:115], v[248:251]
    s_add_u32 s31, s30, 16795648
    buffer_load_dwordx4 v[108:111], v12, s[8:11], s31 offen offset:256 sc1
    v_mfma_f32_16x16x32_bf16 v[252:255], v[48:51], v[116:119], v[252:255]
    v_mfma_f32_16x16x32_bf16 v[200:203], a[112:115], v[120:123], v[200:203]
    v_mfma_f32_16x16x32_bf16 v[204:207], a[112:115], v[124:127], v[204:207]
    v_mfma_f32_16x16x32_bf16 v[208:211], a[116:119], v[120:123], v[208:211]
    s_add_u32 s31, s30, 16782336
    buffer_load_dwordx4 v[24:27], v12, s[8:11], s31 offen offset:0 sc1
    v_mfma_f32_16x16x32_bf16 v[212:215], a[116:119], v[124:127], v[212:215]
    v_mfma_f32_16x16x32_bf16 v[216:219], a[120:123], v[120:123], v[216:219]
    v_mfma_f32_16x16x32_bf16 v[220:223], a[120:123], v[124:127], v[220:223]
    v_mfma_f32_16x16x32_bf16 v[224:227], a[124:127], v[120:123], v[224:227]
    s_add_u32 s31, s30, 16782336
    buffer_load_dwordx4 v[28:31], v12, s[8:11], s31 offen offset:256 sc1
    v_mfma_f32_16x16x32_bf16 v[228:231], a[124:127], v[124:127], v[228:231]
    v_mfma_f32_16x16x32_bf16 v[184:187], a[128:131], v[120:123], v[184:187]
    v_mfma_f32_16x16x32_bf16 v[188:191], a[128:131], v[124:127], v[188:191]
    v_mfma_f32_16x16x32_bf16 v[192:195], a[132:135], v[120:123], v[192:195]
    s_add_u32 s29, s25, 93184
    buffer_load_dwordx4 v[32:35], v3, s[8:11], s29 offen
    v_mfma_f32_16x16x32_bf16 v[196:199], a[132:135], v[124:127], v[196:199]
    v_mfma_f32_16x16x32_bf16 v[248:251], a[136:139], v[120:123], v[248:251]
    v_mfma_f32_16x16x32_bf16 v[252:255], a[136:139], v[124:127], v[252:255]
    v_mfma_f32_16x16x32_bf16 v[200:203], v[52:55], v[156:159], v[200:203]
    s_add_u32 s29, s25, 94208
    buffer_load_dwordx4 v[36:39], v3, s[8:11], s29 offen
    v_mfma_f32_16x16x32_bf16 v[204:207], v[52:55], v[160:163], v[204:207]
    v_mfma_f32_16x16x32_bf16 v[208:211], v[56:59], v[156:159], v[208:211]
    v_mfma_f32_16x16x32_bf16 v[212:215], v[56:59], v[160:163], v[212:215]
    v_mfma_f32_16x16x32_bf16 v[216:219], v[60:63], v[156:159], v[216:219]
    s_add_u32 s29, s25, 95232
    buffer_load_dwordx4 v[40:43], v3, s[8:11], s29 offen
    v_mfma_f32_16x16x32_bf16 v[220:223], v[60:63], v[160:163], v[220:223]
    v_mfma_f32_16x16x32_bf16 v[224:227], v[64:67], v[156:159], v[224:227]
    v_mfma_f32_16x16x32_bf16 v[228:231], v[64:67], v[160:163], v[228:231]
    v_mfma_f32_16x16x32_bf16 v[184:187], v[68:71], v[156:159], v[184:187]
    s_add_u32 s29, s25, 96256
    buffer_load_dwordx4 v[44:47], v3, s[8:11], s29 offen
    v_mfma_f32_16x16x32_bf16 v[188:191], v[68:71], v[160:163], v[188:191]
    v_mfma_f32_16x16x32_bf16 v[192:195], v[72:75], v[156:159], v[192:195]
    v_mfma_f32_16x16x32_bf16 v[196:199], v[72:75], v[160:163], v[196:199]
    s_add_u32 s31, s30, 16796672
    buffer_load_dwordx4 v[120:123], v12, s[8:11], s31 offen offset:0 sc1
    v_mfma_f32_16x16x32_bf16 v[248:251], v[76:79], v[156:159], v[248:251]
    s_add_u32 s31, s30, 16796672
    buffer_load_dwordx4 v[124:127], v12, s[8:11], s31 offen offset:256 sc1
    v_mfma_f32_16x16x32_bf16 v[252:255], v[76:79], v[160:163], v[252:255]
    s_add_u32 s31, s30, 16783360
    buffer_load_dwordx4 v[52:55], v12, s[8:11], s31 offen offset:0 sc1
    v_mfma_f32_16x16x32_bf16 v[200:203], a[140:143], v[164:167], v[200:203]
    s_add_u32 s31, s30, 16783360
    buffer_load_dwordx4 v[56:59], v12, s[8:11], s31 offen offset:256 sc1
    v_mfma_f32_16x16x32_bf16 v[204:207], a[140:143], v[168:171], v[204:207]
    s_add_u32 s31, s30, 16797696
    buffer_load_dwordx4 v[60:63], v12, s[8:11], s31 offen offset:0 sc1
    v_mfma_f32_16x16x32_bf16 v[208:211], a[144:147], v[164:167], v[208:211]
    s_add_u32 s31, s30, 16797696
    buffer_load_dwordx4 v[64:67], v12, s[8:11], s31 offen offset:256 sc1
    v_mfma_f32_16x16x32_bf16 v[212:215], a[144:147], v[168:171], v[212:215]
    v_mfma_f32_16x16x32_bf16 v[216:219], a[148:151], v[164:167], v[216:219]
    v_mfma_f32_16x16x32_bf16 v[220:223], a[148:151], v[168:171], v[220:223]
    v_mfma_f32_16x16x32_bf16 v[224:227], a[152:155], v[164:167], v[224:227]
    s_add_u32 s29, s25, 97280
    buffer_load_dwordx4 v[48:51], v3, s[8:11], s29 offen
    v_mfma_f32_16x16x32_bf16 v[228:231], a[152:155], v[168:171], v[228:231]
    v_mfma_f32_16x16x32_bf16 v[184:187], a[156:159], v[164:167], v[184:187]
    v_mfma_f32_16x16x32_bf16 v[188:191], a[156:159], v[168:171], v[188:191]
    v_mfma_f32_16x16x32_bf16 v[192:195], a[160:163], v[164:167], v[192:195]
    s_add_u32 s29, s25, 98304
    buffer_load_dwordx4 v[112:115], v3, s[8:11], s29 offen
    v_mfma_f32_16x16x32_bf16 v[196:199], a[160:163], v[168:171], v[196:199]
    v_mfma_f32_16x16x32_bf16 v[248:251], a[164:167], v[164:167], v[248:251]
    v_mfma_f32_16x16x32_bf16 v[252:255], a[164:167], v[168:171], v[252:255]
    s_barrier
    s_waitcnt vmcnt(19)
    v_mfma_f32_16x16x32_bf16 v[200:203], v[128:131], v[96:99], v[200:203]
    s_add_u32 s29, s25, 99328
    buffer_load_dwordx4 v[116:119], v3, s[8:11], s29 offen
    s_waitcnt vmcnt(19)
    v_mfma_f32_16x16x32_bf16 v[204:207], v[128:131], v[100:103], v[204:207]
    v_mfma_f32_16x16x32_bf16 v[208:211], v[132:135], v[96:99], v[208:211]
    v_mfma_f32_16x16x32_bf16 v[212:215], v[132:135], v[100:103], v[212:215]
    v_mfma_f32_16x16x32_bf16 v[216:219], v[136:139], v[96:99], v[216:219]
    v_mfma_f32_16x16x32_bf16 v[220:223], v[136:139], v[100:103], v[220:223]
    v_mfma_f32_16x16x32_bf16 v[224:227], v[140:143], v[96:99], v[224:227]
    v_mfma_f32_16x16x32_bf16 v[228:231], v[140:143], v[100:103], v[228:231]
    v_mfma_f32_16x16x32_bf16 v[184:187], v[144:147], v[96:99], v[184:187]
    v_mfma_f32_16x16x32_bf16 v[188:191], v[144:147], v[100:103], v[188:191]
    v_mfma_f32_16x16x32_bf16 v[192:195], v[148:151], v[96:99], v[192:195]
    v_mfma_f32_16x16x32_bf16 v[196:199], v[148:151], v[100:103], v[196:199]
    v_mfma_f32_16x16x32_bf16 v[248:251], v[152:155], v[96:99], v[248:251]
    v_mfma_f32_16x16x32_bf16 v[252:255], v[152:155], v[100:103], v[252:255]
    s_waitcnt vmcnt(16)
    v_mfma_f32_16x16x32_bf16 v[200:203], a[168:171], v[104:107], v[200:203]
    s_waitcnt vmcnt(15)
    v_mfma_f32_16x16x32_bf16 v[204:207], a[168:171], v[108:111], v[204:207]
    v_mfma_f32_16x16x32_bf16 v[208:211], a[172:175], v[104:107], v[208:211]
    v_mfma_f32_16x16x32_bf16 v[212:215], a[172:175], v[108:111], v[212:215]
    v_mfma_f32_16x16x32_bf16 v[216:219], a[176:179], v[104:107], v[216:219]
    v_mfma_f32_16x16x32_bf16 v[220:223], a[176:179], v[108:111], v[220:223]
    v_mfma_f32_16x16x32_bf16 v[224:227], a[180:183], v[104:107], v[224:227]
    v_mfma_f32_16x16x32_bf16 v[228:231], a[180:183], v[108:111], v[228:231]
    v_mfma_f32_16x16x32_bf16 v[184:187], a[184:187], v[104:107], v[184:187]
    v_mfma_f32_16x16x32_bf16 v[188:191], a[184:187], v[108:111], v[188:191]
    v_mfma_f32_16x16x32_bf16 v[192:195], a[188:191], v[104:107], v[192:195]
    v_mfma_f32_16x16x32_bf16 v[196:199], a[188:191], v[108:111], v[196:199]
    v_mfma_f32_16x16x32_bf16 v[248:251], a[192:195], v[104:107], v[248:251]
    v_mfma_f32_16x16x32_bf16 v[252:255], a[192:195], v[108:111], v[252:255]
    s_waitcnt vmcnt(14)
    v_mfma_f32_16x16x32_bf16 v[200:203], v[172:175], v[24:27], v[200:203]
    s_waitcnt vmcnt(13)
    v_mfma_f32_16x16x32_bf16 v[204:207], v[172:175], v[28:31], v[204:207]
    v_mfma_f32_16x16x32_bf16 v[208:211], v[176:179], v[24:27], v[208:211]
    v_mfma_f32_16x16x32_bf16 v[212:215], v[176:179], v[28:31], v[212:215]
    v_mfma_f32_16x16x32_bf16 v[216:219], v[180:183], v[24:27], v[216:219]
    v_mfma_f32_16x16x32_bf16 v[220:223], v[180:183], v[28:31], v[220:223]
    v_mfma_f32_16x16x32_bf16 v[224:227], v[80:83], v[24:27], v[224:227]
    v_mfma_f32_16x16x32_bf16 v[228:231], v[80:83], v[28:31], v[228:231]
    v_mfma_f32_16x16x32_bf16 v[184:187], v[84:87], v[24:27], v[184:187]
    v_mfma_f32_16x16x32_bf16 v[188:191], v[84:87], v[28:31], v[188:191]
    v_mfma_f32_16x16x32_bf16 v[192:195], v[88:91], v[24:27], v[192:195]
    v_mfma_f32_16x16x32_bf16 v[196:199], v[88:91], v[28:31], v[196:199]
    v_mfma_f32_16x16x32_bf16 v[248:251], v[92:95], v[24:27], v[248:251]
    v_mfma_f32_16x16x32_bf16 v[252:255], v[92:95], v[28:31], v[252:255]
    s_waitcnt vmcnt(8)
    v_mfma_f32_16x16x32_bf16 v[200:203], a[196:199], v[120:123], v[200:203]
    s_mul_i32 s26, s3, 14336
    v_add_u32 v6, s26, v3
    s_waitcnt vmcnt(7)
    v_mfma_f32_16x16x32_bf16 v[204:207], a[196:199], v[124:127], v[204:207]
    s_waitcnt vmcnt(6)
    v_mfma_f32_16x16x32_bf16 v[200:203], a[224:227], v[52:55], v[200:203]
    s_waitcnt vmcnt(5)
    v_mfma_f32_16x16x32_bf16 v[204:207], a[224:227], v[56:59], v[204:207]
    s_waitcnt vmcnt(4)
    v_mfma_f32_16x16x32_bf16 v[200:203], v[32:35], v[60:63], v[200:203]
    s_waitcnt vmcnt(3)
    v_mfma_f32_16x16x32_bf16 v[204:207], v[32:35], v[64:67], v[204:207]
    v_mfma_f32_16x16x32_bf16 v[208:211], a[200:203], v[120:123], v[208:211]
    v_mfma_f32_16x16x32_bf16 v[212:215], a[200:203], v[124:127], v[212:215]
    v_mfma_f32_16x16x32_bf16 v[208:211], a[228:231], v[52:55], v[208:211]
    s_nop 2
    ds_write_b128 v6, v[200:203] offset:0
    v_mfma_f32_16x16x32_bf16 v[212:215], a[228:231], v[56:59], v[212:215]
    ds_write_b128 v6, v[204:207] offset:1024
    v_mfma_f32_16x16x32_bf16 v[208:211], v[36:39], v[60:63], v[208:211]
    v_mfma_f32_16x16x32_bf16 v[212:215], v[36:39], v[64:67], v[212:215]
    v_mfma_f32_16x16x32_bf16 v[216:219], a[204:207], v[120:123], v[216:219]
    v_mfma_f32_16x16x32_bf16 v[220:223], a[204:207], v[124:127], v[220:223]
    v_mfma_f32_16x16x32_bf16 v[216:219], a[232:235], v[52:55], v[216:219]
    s_nop 3
    ds_write_b128 v6, v[208:211] offset:2048
    v_mfma_f32_16x16x32_bf16 v[220:223], a[232:235], v[56:59], v[220:223]
    ds_write_b128 v6, v[212:215] offset:3072
    v_mfma_f32_16x16x32_bf16 v[216:219], v[40:43], v[60:63], v[216:219]
    v_mfma_f32_16x16x32_bf16 v[220:223], v[40:43], v[64:67], v[220:223]
    v_mfma_f32_16x16x32_bf16 v[224:227], a[208:211], v[120:123], v[224:227]
    v_mfma_f32_16x16x32_bf16 v[228:231], a[208:211], v[124:127], v[228:231]
    v_mfma_f32_16x16x32_bf16 v[224:227], a[236:239], v[52:55], v[224:227]
    s_nop 3
    ds_write_b128 v6, v[216:219] offset:4096
    v_mfma_f32_16x16x32_bf16 v[228:231], a[236:239], v[56:59], v[228:231]
    ds_write_b128 v6, v[220:223] offset:5120
    v_mfma_f32_16x16x32_bf16 v[224:227], v[44:47], v[60:63], v[224:227]
    v_mfma_f32_16x16x32_bf16 v[228:231], v[44:47], v[64:67], v[228:231]
    v_mfma_f32_16x16x32_bf16 v[184:187], a[212:215], v[120:123], v[184:187]
    v_mfma_f32_16x16x32_bf16 v[188:191], a[212:215], v[124:127], v[188:191]
    v_mfma_f32_16x16x32_bf16 v[184:187], a[240:243], v[52:55], v[184:187]
    s_nop 3
    ds_write_b128 v6, v[224:227] offset:6144
    v_mfma_f32_16x16x32_bf16 v[188:191], a[240:243], v[56:59], v[188:191]
    ds_write_b128 v6, v[228:231] offset:7168
    s_waitcnt vmcnt(2)
    v_mfma_f32_16x16x32_bf16 v[184:187], v[48:51], v[60:63], v[184:187]
    v_mfma_f32_16x16x32_bf16 v[188:191], v[48:51], v[64:67], v[188:191]
    v_mfma_f32_16x16x32_bf16 v[192:195], a[216:219], v[120:123], v[192:195]
    v_mfma_f32_16x16x32_bf16 v[196:199], a[216:219], v[124:127], v[196:199]
    v_mfma_f32_16x16x32_bf16 v[192:195], a[244:247], v[52:55], v[192:195]
    s_nop 3
    ds_write_b128 v6, v[184:187] offset:8192
    v_mfma_f32_16x16x32_bf16 v[196:199], a[244:247], v[56:59], v[196:199]
    ds_write_b128 v6, v[188:191] offset:9216
    s_waitcnt vmcnt(1)
    v_mfma_f32_16x16x32_bf16 v[192:195], v[112:115], v[60:63], v[192:195]
    v_mfma_f32_16x16x32_bf16 v[196:199], v[112:115], v[64:67], v[196:199]
    v_mfma_f32_16x16x32_bf16 v[248:251], a[220:223], v[120:123], v[248:251]
    v_mfma_f32_16x16x32_bf16 v[252:255], a[220:223], v[124:127], v[252:255]
    v_mfma_f32_16x16x32_bf16 v[248:251], a[248:251], v[52:55], v[248:251]
    s_nop 3
    ds_write_b128 v6, v[192:195] offset:10240
    v_mfma_f32_16x16x32_bf16 v[252:255], a[248:251], v[56:59], v[252:255]
    ds_write_b128 v6, v[196:199] offset:11264
    s_waitcnt vmcnt(0)
    v_mfma_f32_16x16x32_bf16 v[248:251], v[116:119], v[60:63], v[248:251]
    v_mfma_f32_16x16x32_bf16 v[252:255], v[116:119], v[64:67], v[252:255]
    v_mov_b32 v13, v6
    v_lshlrev_b32 v6, 4, v0
    v_add_u32 v7, 4096, v6
    v_cmp_gt_u32 vcc, 192, v0
    v_mov_b32 v8, 2147483648
    s_nop 0
    v_cndmask_b32 v7, v8, v7, vcc
    v_and_b32 v9, 15, v2
    v_bfe_u32 v14, v2, 4, 1
    v_lshl_add_u32 v14, v1, 1, v14
    v_lshlrev_b32 v14, 10, v14
    v_lshrrev_b32 v15, 5, v2
    v_lshl_add_u32 v14, v15, 9, v14
    v_lshl_add_u32 v14, v9, 4, v14
    ds_write_b128 v13, v[248:251] offset:12288
    ds_write_b128 v13, v[252:255] offset:13312
    s_waitcnt lgkmcnt(0)
    s_barrier
    ds_read_b128 v[24:27], v14 offset:0
    ds_read_b128 v[28:31], v14 offset:256
    ds_read_b128 v[32:35], v14 offset:14336
    ds_read_b128 v[36:39], v14 offset:14592
    ds_read_b128 v[40:43], v14 offset:28672
    ds_read_b128 v[44:47], v14 offset:28928
    ds_read_b128 v[48:51], v14 offset:43008
    ds_read_b128 v[52:55], v14 offset:43264
    ds_read_b128 v[56:59], v14 offset:8192
    ds_read_b128 v[60:63], v14 offset:8448
    ds_read_b128 v[64:67], v14 offset:22528
    ds_read_b128 v[68:71], v14 offset:22784
    ds_read_b128 v[72:75], v14 offset:36864
    ds_read_b128 v[76:79], v14 offset:37120
    ds_read_b128 v[80:83], v14 offset:51200
    ds_read_b128 v[84:87], v14 offset:51456
    s_waitcnt lgkmcnt(8)
    v_pk_add_f32 v[24:25], v[24:25], v[32:33]
    v_pk_add_f32 v[40:41], v[40:41], v[48:49]
    v_pk_add_f32 v[26:27], v[26:27], v[34:35]
    v_pk_add_f32 v[42:43], v[42:43], v[50:51]
    v_pk_add_f32 v[28:29], v[28:29], v[36:37]
    v_pk_add_f32 v[44:45], v[44:45], v[52:53]
    v_pk_add_f32 v[30:31], v[30:31], v[38:39]
    v_pk_add_f32 v[46:47], v[46:47], v[54:55]
    v_pk_add_f32 v[24:25], v[24:25], v[40:41]
    v_pk_add_f32 v[26:27], v[26:27], v[42:43]
    v_pk_add_f32 v[28:29], v[28:29], v[44:45]
    v_pk_add_f32 v[30:31], v[30:31], v[46:47]
    v_cvt_pk_bf16_f32 v32, v24, v25
    v_cvt_pk_bf16_f32 v33, v26, v27
    v_cvt_pk_bf16_f32 v34, v28, v29
    v_cvt_pk_bf16_f32 v35, v30, v31
    v_lshlrev_b32 v24, 16, v32
    v_and_b32 v25, 0xffff0000, v32
    v_lshlrev_b32 v40, 16, v16
    v_and_b32 v41, 0xffff0000, v16
    v_lshlrev_b32 v26, 16, v33
    v_and_b32 v27, 0xffff0000, v33
    v_lshlrev_b32 v42, 16, v17
    v_and_b32 v43, 0xffff0000, v17
    v_lshlrev_b32 v28, 16, v34
    v_and_b32 v29, 0xffff0000, v34
    v_lshlrev_b32 v44, 16, v18
    v_and_b32 v45, 0xffff0000, v18
    v_lshlrev_b32 v30, 16, v35
    v_and_b32 v31, 0xffff0000, v35
    v_lshlrev_b32 v46, 16, v19
    v_and_b32 v47, 0xffff0000, v19
    v_pk_add_f32 v[24:25], v[24:25], v[40:41]
    v_pk_add_f32 v[26:27], v[26:27], v[42:43]
    v_pk_add_f32 v[28:29], v[28:29], v[44:45]
    v_pk_add_f32 v[30:31], v[30:31], v[46:47]
    v_cvt_pk_bf16_f32 v16, v24, v25
    v_cvt_pk_bf16_f32 v17, v26, v27
    v_cvt_pk_bf16_f32 v18, v28, v29
    v_cvt_pk_bf16_f32 v19, v30, v31
    s_waitcnt lgkmcnt(0)
    v_pk_add_f32 v[56:57], v[56:57], v[64:65]
    v_pk_add_f32 v[72:73], v[72:73], v[80:81]
    v_pk_add_f32 v[58:59], v[58:59], v[66:67]
    v_pk_add_f32 v[74:75], v[74:75], v[82:83]
    v_pk_add_f32 v[60:61], v[60:61], v[68:69]
    v_pk_add_f32 v[76:77], v[76:77], v[84:85]
    v_pk_add_f32 v[62:63], v[62:63], v[70:71]
    v_pk_add_f32 v[78:79], v[78:79], v[86:87]
    v_pk_add_f32 v[56:57], v[56:57], v[72:73]
    v_pk_add_f32 v[58:59], v[58:59], v[74:75]
    v_pk_add_f32 v[60:61], v[60:61], v[76:77]
    v_pk_add_f32 v[62:63], v[62:63], v[78:79]
    v_cvt_pk_bf16_f32 v64, v56, v57
    v_cvt_pk_bf16_f32 v65, v58, v59
    v_cvt_pk_bf16_f32 v66, v60, v61
    v_cvt_pk_bf16_f32 v67, v62, v63
    v_lshlrev_b32 v56, 16, v64
    v_and_b32 v57, 0xffff0000, v64
    v_lshlrev_b32 v72, 16, v20
    v_and_b32 v73, 0xffff0000, v20
    v_lshlrev_b32 v58, 16, v65
    v_and_b32 v59, 0xffff0000, v65
    v_lshlrev_b32 v74, 16, v21
    v_and_b32 v75, 0xffff0000, v21
    v_lshlrev_b32 v60, 16, v66
    v_and_b32 v61, 0xffff0000, v66
    v_lshlrev_b32 v76, 16, v22
    v_and_b32 v77, 0xffff0000, v22
    v_lshlrev_b32 v62, 16, v67
    v_and_b32 v63, 0xffff0000, v67
    v_lshlrev_b32 v78, 16, v23
    v_and_b32 v79, 0xffff0000, v23
    v_pk_add_f32 v[56:57], v[56:57], v[72:73]
    v_pk_add_f32 v[58:59], v[58:59], v[74:75]
    v_pk_add_f32 v[60:61], v[60:61], v[76:77]
    v_pk_add_f32 v[62:63], v[62:63], v[78:79]
    v_cvt_pk_bf16_f32 v20, v56, v57
    v_cvt_pk_bf16_f32 v21, v58, v59
    v_cvt_pk_bf16_f32 v22, v60, v61
    v_cvt_pk_bf16_f32 v23, v62, v63
    v_and_b32 v9, 31, v2
    v_mul_u32_u24 v9, 896, v9
    v_lshrrev_b32 v10, 5, v2
    v_lshl_add_u32 v9, v10, 4, v9
    v_lshl_add_u32 v9, v1, 5, v9
    v_add_u32 v10, 128, v9
    v_cmp_gt_u32 vcc, 192, v0
    s_nop 1
    v_cndmask_b32 v10, v8, v10, vcc
    s_mul_i32 s26, s21, 28672
    s_mul_i32 s27, s22, 224
    s_add_u32 s26, s26, s27
    buffer_store_dwordx4 v[16:19], v9, s[12:15], s26 offen
    buffer_store_dwordx4 v[20:23], v10, s[12:15], s26 offen
    s_endpgm
ffn_slow_T:
    s_nop 7
    s_nop 7
    buffer_load_dword v85, v84, s[8:11], s51 offen sc1
    v_mov_b32 v42, v40
    v_mov_b32 v43, v40
    v_mov_b32 v40, v41
    v_lshlrev_b32 v68, 16, v32
    v_and_b32 v69, 0xffff0000, v32
    v_pk_add_f32 v[52:53], v[68:69], v[42:43] neg_lo:[0,1] neg_hi:[0,1]
    v_cvt_pk_bf16_f32 v15, v52, v53
    v_lshlrev_b32 v52, 16, v15
    v_and_b32 v53, 0xffff0000, v15
    v_pk_mul_f32 v[52:53], v[52:53], v[40:41]
    v_cvt_pk_bf16_f32 v15, v52, v53
    v_lshlrev_b32 v52, 16, v15
    v_and_b32 v53, 0xffff0000, v15
    v_lshlrev_b32 v70, 16, v33
    v_and_b32 v71, 0xffff0000, v33
    v_pk_add_f32 v[54:55], v[70:71], v[42:43] neg_lo:[0,1] neg_hi:[0,1]
    v_cvt_pk_bf16_f32 v15, v54, v55
    v_lshlrev_b32 v54, 16, v15
    v_and_b32 v55, 0xffff0000, v15
    v_pk_mul_f32 v[54:55], v[54:55], v[40:41]
    v_cvt_pk_bf16_f32 v15, v54, v55
    v_lshlrev_b32 v54, 16, v15
    v_and_b32 v55, 0xffff0000, v15
    v_lshlrev_b32 v72, 16, v34
    v_and_b32 v73, 0xffff0000, v34
    v_pk_add_f32 v[56:57], v[72:73], v[42:43] neg_lo:[0,1] neg_hi:[0,1]
    v_cvt_pk_bf16_f32 v15, v56, v57
    v_lshlrev_b32 v56, 16, v15
    v_and_b32 v57, 0xffff0000, v15
    v_pk_mul_f32 v[56:57], v[56:57], v[40:41]
    v_cvt_pk_bf16_f32 v15, v56, v57
    v_lshlrev_b32 v56, 16, v15
    v_and_b32 v57, 0xffff0000, v15
    v_lshlrev_b32 v74, 16, v35
    v_and_b32 v75, 0xffff0000, v35
    v_pk_add_f32 v[58:59], v[74:75], v[42:43] neg_lo:[0,1] neg_hi:[0,1]
    v_cvt_pk_bf16_f32 v15, v58, v59
    v_lshlrev_b32 v58, 16, v15
    v_and_b32 v59, 0xffff0000, v15
    v_pk_mul_f32 v[58:59], v[58:59], v[40:41]
    v_cvt_pk_bf16_f32 v15, v58, v59
    v_lshlrev_b32 v58, 16, v15
    v_and_b32 v59, 0xffff0000, v15
    v_lshlrev_b32 v76, 16, v36
    v_and_b32 v77, 0xffff0000, v36
    v_pk_add_f32 v[60:61], v[76:77], v[42:43] neg_lo:[0,1] neg_hi:[0,1]
    v_cvt_pk_bf16_f32 v15, v60, v61
    v_lshlrev_b32 v60, 16, v15
    v_and_b32 v61, 0xffff0000, v15
    v_pk_mul_f32 v[60:61], v[60:61], v[40:41]
    v_cvt_pk_bf16_f32 v15, v60, v61
    v_lshlrev_b32 v60, 16, v15
    v_and_b32 v61, 0xffff0000, v15
    v_lshlrev_b32 v78, 16, v37
    v_and_b32 v79, 0xffff0000, v37
    v_pk_add_f32 v[62:63], v[78:79], v[42:43] neg_lo:[0,1] neg_hi:[0,1]
    v_cvt_pk_bf16_f32 v15, v62, v63
    v_lshlrev_b32 v62, 16, v15
    v_and_b32 v63, 0xffff0000, v15
    v_pk_mul_f32 v[62:63], v[62:63], v[40:41]
    v_cvt_pk_bf16_f32 v15, v62, v63
    v_lshlrev_b32 v62, 16, v15
    v_and_b32 v63, 0xffff0000, v15
    v_lshlrev_b32 v80, 16, v38
    v_and_b32 v81, 0xffff0000, v38
    v_pk_add_f32 v[64:65], v[80:81], v[42:43] neg_lo:[0,1] neg_hi:[0,1]
    v_cvt_pk_bf16_f32 v15, v64, v65
    v_lshlrev_b32 v64, 16, v15
    v_and_b32 v65, 0xffff0000, v15
    v_pk_mul_f32 v[64:65], v[64:65], v[40:41]
    v_cvt_pk_bf16_f32 v15, v64, v65
    v_lshlrev_b32 v64, 16, v15
    v_and_b32 v65, 0xffff0000, v15
    v_lshlrev_b32 v82, 16, v39
    v_and_b32 v83, 0xffff0000, v39
    v_pk_add_f32 v[66:67], v[82:83], v[42:43] neg_lo:[0,1] neg_hi:[0,1]
    v_cvt_pk_bf16_f32 v15, v66, v67
    v_lshlrev_b32 v66, 16, v15
    v_and_b32 v67, 0xffff0000, v15
    v_pk_mul_f32 v[66:67], v[66:67], v[40:41]
    v_cvt_pk_bf16_f32 v15, v66, v67
    v_lshlrev_b32 v66, 16, v15
    v_and_b32 v67, 0xffff0000, v15
    s_waitcnt vmcnt(0)
    s_mov_b32 s61, 0
ffn_kernels_cfl2:
    v_cmp_eq_u32 vcc, 0, v85
    s_add_u32 s61, s61, 1
    s_cmp_eq_u64 vcc, 0
    s_cbranch_scc1 ffn_kernels_cfok1
    s_cmp_ge_u32 s61, 4000
    s_cbranch_scc1 ffn_kernels_cfok1
    s_sleep 2
    buffer_load_dword v85, v84, s[8:11], s51 offen sc1
    s_waitcnt vmcnt(0)
    s_branch ffn_kernels_cfl2
ffn_kernels_cfok1:
    buffer_load_dwordx4 v[24:27], v9, s[8:11], s50 offen sc1
    buffer_load_dwordx4 v[28:31], v9, s[8:11], s49 offen sc1
    s_add_u32 s26, s37, 8388608
    s_add_u32 s27, s37, 6291456
    s_waitcnt vmcnt(1)
    ds_write_b128 v13, v[24:27]
    s_waitcnt lgkmcnt(0)
    ds_read_b64_tr_b16 v[44:45], v14
    ds_read_b64_tr_b16 v[46:47], v14 offset:256
    s_waitcnt lgkmcnt(0)
    v_lshlrev_b32 v84, 16, v44
    v_and_b32 v85, 0xffff0000, v44
    v_pk_fma_f32 v[84:85], v[84:85], v[52:53], v[68:69]
    v_cvt_pk_bf16_f32 v16, v84, v85
    v_lshlrev_b32 v86, 16, v45
    v_and_b32 v87, 0xffff0000, v45
    v_pk_fma_f32 v[86:87], v[86:87], v[54:55], v[70:71]
    v_cvt_pk_bf16_f32 v17, v86, v87
    v_lshlrev_b32 v84, 16, v46
    v_and_b32 v85, 0xffff0000, v46
    v_pk_fma_f32 v[84:85], v[84:85], v[56:57], v[72:73]
    v_cvt_pk_bf16_f32 v18, v84, v85
    v_lshlrev_b32 v86, 16, v47
    v_and_b32 v87, 0xffff0000, v47
    v_pk_fma_f32 v[86:87], v[86:87], v[58:59], v[74:75]
    v_cvt_pk_bf16_f32 v19, v86, v87
    buffer_store_dwordx4 v[16:19], v6, s[8:11], s26 offen sc1
    s_waitcnt vmcnt(1)
    ds_write_b128 v13, v[28:31]
    s_waitcnt lgkmcnt(0)
    ds_read_b64_tr_b16 v[48:49], v14
    ds_read_b64_tr_b16 v[50:51], v14 offset:256
    s_waitcnt lgkmcnt(0)
    v_lshlrev_b32 v84, 16, v48
    v_and_b32 v85, 0xffff0000, v48
    v_pk_fma_f32 v[84:85], v[84:85], v[60:61], v[76:77]
    v_cvt_pk_bf16_f32 v20, v84, v85
    v_lshlrev_b32 v86, 16, v49
    v_and_b32 v87, 0xffff0000, v49
    v_pk_fma_f32 v[86:87], v[86:87], v[62:63], v[78:79]
    v_cvt_pk_bf16_f32 v21, v86, v87
    v_lshlrev_b32 v84, 16, v50
    v_and_b32 v85, 0xffff0000, v50
    v_pk_fma_f32 v[84:85], v[84:85], v[64:65], v[80:81]
    v_cvt_pk_bf16_f32 v22, v84, v85
    v_lshlrev_b32 v86, 16, v51
    v_and_b32 v87, 0xffff0000, v51
    v_pk_fma_f32 v[86:87], v[86:87], v[66:67], v[82:83]
    v_cvt_pk_bf16_f32 v23, v86, v87
    buffer_store_dwordx4 v[20:23], v7, s[8:11], s26 offen sc1
    v_mov_b32 v8, 0
    v_mov_b32 v9, 0
    s_mov_b32 s26, 0x3f803f80
    v_dot2_f32_bf16 v8, v16, s26, v8
    v_dot2_f32_bf16 v9, v16, v16, v9
    v_dot2_f32_bf16 v8, v17, s26, v8
    v_dot2_f32_bf16 v9, v17, v17, v9
    v_dot2_f32_bf16 v8, v18, s26, v8
    v_dot2_f32_bf16 v9, v18, v18, v9
    v_dot2_f32_bf16 v8, v19, s26, v8
    v_dot2_f32_bf16 v9, v19, v19, v9
    v_dot2_f32_bf16 v8, v20, s26, v8
    v_dot2_f32_bf16 v9, v20, v20, v9
    v_dot2_f32_bf16 v8, v21, s26, v8
    v_dot2_f32_bf16 v9, v21, v21, v9
    v_dot2_f32_bf16 v8, v22, s26, v8
    v_dot2_f32_bf16 v9, v22, v22, v9
    v_dot2_f32_bf16 v8, v23, s26, v8
    v_dot2_f32_bf16 v9, v23, v23, v9
    s_nop 1
    v_mov_b32 v15, v8
    s_nop 1
    v_permlane32_swap_b32 v8, v15
    v_add_f32 v8, v8, v15
    v_mov_b32 v15, v9
    s_nop 1
    v_permlane32_swap_b32 v9, v15
    v_add_f32 v9, v9, v15
    v_or_b32 v9, 1, v9
    s_add_u32 s26, s38, 32243712
    s_waitcnt vmcnt(0)
    s_mov_b32 exec_hi, 0
    buffer_store_dwordx2 v[8:9], v11, s[8:11], s26 offen sc1
    s_mov_b64 exec, -1
    buffer_store_dwordx4 v[44:47], v6, s[8:11], s27 offen
    buffer_store_dwordx4 v[48:51], v7, s[8:11], s27 offen
    v_mov_b32 v6, v10
    s_lshl_b32 s43, s20, 12
    s_add_u32 s43, s43, 32243712
    buffer_load_dwordx2 v[232:233], v6, s[8:11], s43 offen offset:0 sc1
    buffer_load_dwordx2 v[234:235], v6, s[8:11], s43 offen offset:256 sc1
    buffer_load_dwordx2 v[236:237], v6, s[8:11], s43 offen offset:512 sc1
    buffer_load_dwordx2 v[238:239], v6, s[8:11], s43 offen offset:768 sc1
    buffer_load_dwordx2 v[240:241], v6, s[8:11], s43 offen offset:1024 sc1
    buffer_load_dwordx2 v[242:243], v6, s[8:11], s43 offen offset:1280 sc1
    buffer_load_dwordx2 v[244:245], v6, s[8:11], s43 offen offset:1536 sc1
    buffer_load_dwordx2 v[246:247], v6, s[8:11], s43 offen offset:1792 sc1
    s_waitcnt vmcnt(0)
    s_mov_b32 s61, 0
ffn_kernels_t1l4:
    v_and_b32 v15, v233, v235
    v_and_b32 v15, v15, v237
    v_and_b32 v15, v15, v239
    v_and_b32 v15, v15, v241
    v_and_b32 v15, v15, v243
    v_and_b32 v15, v15, v245
    v_and_b32 v15, v15, v247
    v_and_b32 v15, 1, v15
    v_cmp_eq_u32 vcc, 0, v15
    s_add_u32 s61, s61, 1
    s_cmp_eq_u64 vcc, 0
    s_cbranch_scc1 ffn_kernels_t1ok3
    s_cmp_ge_u32 s61, 4000
    s_cbranch_scc1 ffn_kernels_t1ok3
    s_sleep 1
    buffer_load_dwordx2 v[232:233], v6, s[8:11], s43 offen offset:0 sc1
    buffer_load_dwordx2 v[234:235], v6, s[8:11], s43 offen offset:256 sc1
    buffer_load_dwordx2 v[236:237], v6, s[8:11], s43 offen offset:512 sc1
    buffer_load_dwordx2 v[238:239], v6, s[8:11], s43 offen offset:768 sc1
    buffer_load_dwordx2 v[240:241], v6, s[8:11], s43 offen offset:1024 sc1
    buffer_load_dwordx2 v[242:243], v6, s[8:11], s43 offen offset:1280 sc1
    buffer_load_dwordx2 v[244:245], v6, s[8:11], s43 offen offset:1536 sc1
    buffer_load_dwordx2 v[246:247], v6, s[8:11], s43 offen offset:1792 sc1
    s_waitcnt vmcnt(0)
    s_branch ffn_kernels_t1l4
ffn_kernels_t1ok3:
    s_add_u32 s26, s23, 0
    buffer_load_dwordx4 v[24:27], v3, s[8:11], s26 offen sc1
    s_add_u32 s26, s23, 1024
    buffer_load_dwordx4 v[28:31], v3, s[8:11], s26 offen sc1
    s_add_u32 s26, s23, 2048
    buffer_load_dwordx4 v[32:35], v3, s[8:11], s26 offen sc1
    s_add_u32 s26, s23, 3072
    buffer_load_dwordx4 v[36:39], v3, s[8:11], s26 offen sc1
    s_add_u32 s26, s23, 4096
    buffer_load_dwordx4 v[40:43], v3, s[8:11], s26 offen sc1
    s_add_u32 s26, s23, 5120
    buffer_load_dwordx4 v[44:47], v3, s[8:11], s26 offen sc1
    s_add_u32 s26, s23, 6144
    buffer_load_dwordx4 v[48:51], v3, s[8:11], s26 offen sc1
    s_add_u32 s26, s23, 7168
    buffer_load_dwordx4 v[52:55], v3, s[8:11], s26 offen sc1
    s_add_u32 s26, s23, 8192
    buffer_load_dwordx4 v[56:59], v3, s[8:11], s26 offen sc1
    s_barrier
    ds_read_b128 v[200:203], v3 offset:0
    ds_read_b128 v[204:207], v3 offset:1024
    ds_read_b128 v[208:211], v3 offset:2048
    ds_read_b128 v[212:215], v3 offset:3072
    ds_read_b128 v[216:219], v3 offset:4096
    ds_read_b128 v[220:223], v3 offset:5120
    ds_read_b128 v[224:227], v3 offset:6144
    s_waitcnt vmcnt(8)
    s_waitcnt lgkmcnt(6)
    v_mfma_f32_32x32x16_bf16 v[136:151], v[200:203], v[24:27], 0
    ds_read_b128 v[228:231], v3 offset:7168
    s_barrier
    s_waitcnt lgkmcnt(6)
    v_mfma_f32_32x32x16_bf16 v[152:167], v[204:207], v[24:27], 0
    ds_read_b128 v[200:203], v3 offset:8192
    s_add_u32 s26, s23, 9216
    buffer_load_dwordx4 v[60:63], v3, s[8:11], s26 offen sc1
    s_waitcnt lgkmcnt(6)
    v_mfma_f32_32x32x16_bf16 v[168:183], v[208:211], v[24:27], 0
    ds_read_b128 v[204:207], v3 offset:9216
    s_waitcnt vmcnt(8)
    s_waitcnt lgkmcnt(6)
    v_mfma_f32_32x32x16_bf16 v[136:151], v[212:215], v[28:31], v[136:151]
    ds_read_b128 v[208:211], v3 offset:10240
    s_add_u32 m0, s28, 36864
    s_add_u32 s27, s24, 36864
    buffer_load_dwordx4 v3, s[8:11], s27 offen lds
    s_waitcnt lgkmcnt(6)
    v_mfma_f32_32x32x16_bf16 v[152:167], v[216:219], v[28:31], v[152:167]
    ds_read_b128 v[212:215], v3 offset:11264
    s_add_u32 m0, s28, 40960
    s_add_u32 s27, s24, 40960
    buffer_load_dwordx4 v3, s[8:11], s27 offen lds
    s_add_u32 m0, s28, 45056
    s_add_u32 s27, s24, 45056
    buffer_load_dwordx4 v3, s[8:11], s27 offen lds
    s_add_u32 m0, s28, 49152
    s_add_u32 s27, s24, 49152
    buffer_load_dwordx4 v3, s[8:11], s27 offen lds
    s_add_u32 m0, s28, 53248
    s_add_u32 s27, s24, 53248
    buffer_load_dwordx4 v3, s[8:11], s27 offen lds
    s_waitcnt lgkmcnt(6)
    v_mfma_f32_32x32x16_bf16 v[168:183], v[220:223], v[28:31], v[168:183]
    ds_read_b128 v[216:219], v3 offset:12288
    s_add_u32 s26, s23, 10240
    buffer_load_dwordx4 v[64:67], v3, s[8:11], s26 offen sc1
    s_waitcnt vmcnt(13)
    s_waitcnt lgkmcnt(6)
    v_mfma_f32_32x32x16_bf16 v[136:151], v[224:227], v[32:35], v[136:151]
    ds_read_b128 v[220:223], v3 offset:13312
    s_waitcnt lgkmcnt(6)
    v_mfma_f32_32x32x16_bf16 v[152:167], v[228:231], v[32:35], v[152:167]
    ds_read_b128 v[224:227], v3 offset:14336
    s_add_u32 s26, s23, 11264
    buffer_load_dwordx4 v[68:71], v3, s[8:11], s26 offen sc1
    s_waitcnt lgkmcnt(6)
    v_mfma_f32_32x32x16_bf16 v[168:183], v[200:203], v[32:35], v[168:183]
    ds_read_b128 v[228:231], v3 offset:15360
    s_waitcnt vmcnt(13)
    s_waitcnt lgkmcnt(6)
    v_mfma_f32_32x32x16_bf16 v[136:151], v[204:207], v[36:39], v[136:151]
    ds_read_b128 v[200:203], v3 offset:16384
    s_add_u32 s26, s23, 12288
    buffer_load_dwordx4 v[72:75], v3, s[8:11], s26 offen sc1
    s_waitcnt lgkmcnt(6)
    v_mfma_f32_32x32x16_bf16 v[152:167], v[208:211], v[36:39], v[152:167]
    ds_read_b128 v[204:207], v3 offset:17408
    s_waitcnt lgkmcnt(6)
    v_mfma_f32_32x32x16_bf16 v[168:183], v[212:215], v[36:39], v[168:183]
    ds_read_b128 v[208:211], v3 offset:18432
    s_add_u32 s26, s23, 13312
    buffer_load_dwordx4 v[76:79], v3, s[8:11], s26 offen sc1
    s_waitcnt vmcnt(14)
    s_waitcnt lgkmcnt(6)
    v_mfma_f32_32x32x16_bf16 v[136:151], v[216:219], v[40:43], v[136:151]
    ds_read_b128 v[212:215], v3 offset:19456
    s_barrier
    s_waitcnt lgkmcnt(6)
    v_mfma_f32_32x32x16_bf16 v[152:167], v[220:223], v[40:43], v[152:167]
    ds_read_b128 v[216:219], v3 offset:20480
    s_add_u32 s26, s23, 14336
    buffer_load_dwordx4 v[80:83], v3, s[8:11], s26 offen sc1
    s_waitcnt lgkmcnt(6)
    v_mfma_f32_32x32x16_bf16 v[168:183], v[224:227], v[40:43], v[168:183]
    ds_read_b128 v[220:223], v3 offset:21504
    s_waitcnt vmcnt(14)
    s_waitcnt lgkmcnt(6)
    v_mfma_f32_32x32x16_bf16 v[136:151], v[228:231], v[44:47], v[136:151]
    ds_read_b128 v[224:227], v3 offset:22528
    s_add_u32 s26, s23, 15360
    buffer_load_dwordx4 v[84:87], v3, s[8:11], s26 offen sc1
    s_waitcnt lgkmcnt(6)
    v_mfma_f32_32x32x16_bf16 v[152:167], v[200:203], v[44:47], v[152:167]
    ds_read_b128 v[228:231], v3 offset:23552
    s_waitcnt lgkmcnt(6)
    v_mfma_f32_32x32x16_bf16 v[168:183], v[204:207], v[44:47], v[168:183]
    ds_read_b128 v[200:203], v3 offset:24576
    s_add_u32 s26, s23, 16384
    buffer_load_dwordx4 v[88:91], v3, s[8:11], s26 offen sc1
    s_waitcnt vmcnt(15)
    s_waitcnt lgkmcnt(6)
    v_mfma_f32_32x32x16_bf16 v[136:151], v[208:211], v[48:51], v[136:151]
    ds_read_b128 v[204:207], v3 offset:25600
    s_waitcnt lgkmcnt(6)
    v_mfma_f32_32x32x16_bf16 v[152:167], v[212:215], v[48:51], v[152:167]
    ds_read_b128 v[208:211], v3 offset:26624
    s_add_u32 s26, s23, 17408
    buffer_load_dwordx4 v[92:95], v3, s[8:11], s26 offen sc1
    s_waitcnt lgkmcnt(6)
    v_mfma_f32_32x32x16_bf16 v[168:183], v[216:219], v[48:51], v[168:183]
    ds_read_b128 v[212:215], v3 offset:27648
    s_waitcnt vmcnt(15)
    s_waitcnt lgkmcnt(6)
    v_mfma_f32_32x32x16_bf16 v[136:151], v[220:223], v[52:55], v[136:151]
    ds_read_b128 v[216:219], v3 offset:28672
    s_add_u32 s26, s23, 18432
    buffer_load_dwordx4 v[96:99], v3, s[8:11], s26 offen sc1
    s_waitcnt lgkmcnt(6)
    v_mfma_f32_32x32x16_bf16 v[152:167], v[224:227], v[52:55], v[152:167]
    ds_read_b128 v[220:223], v3 offset:29696
    s_waitcnt lgkmcnt(6)
    v_mfma_f32_32x32x16_bf16 v[168:183], v[228:231], v[52:55], v[168:183]
    ds_read_b128 v[224:227], v3 offset:30720
    s_add_u32 s26, s23, 19456
    buffer_load_dwordx4 v[100:103], v3, s[8:11], s26 offen sc1
    s_waitcnt vmcnt(16)
    s_waitcnt lgkmcnt(6)
    v_mfma_f32_32x32x16_bf16 v[136:151], v[200:203], v[56:59], v[136:151]
    ds_read_b128 v[228:231], v3 offset:31744
    s_waitcnt lgkmcnt(6)
    v_mfma_f32_32x32x16_bf16 v[152:167], v[204:207], v[56:59], v[152:167]
    ds_read_b128 v[200:203], v3 offset:32768
    s_add_u32 s26, s23, 20480
    buffer_load_dwordx4 v[104:107], v3, s[8:11], s26 offen sc1
    s_waitcnt lgkmcnt(6)
    v_mfma_f32_32x32x16_bf16 v[168:183], v[208:211], v[56:59], v[168:183]
    ds_read_b128 v[204:207], v3 offset:33792
    s_waitcnt vmcnt(16)
    s_waitcnt lgkmcnt(6)
    v_mfma_f32_32x32x16_bf16 v[136:151], v[212:215], v[60:63], v[136:151]
    ds_read_b128 v[208:211], v3 offset:34816
    s_add_u32 s26, s23, 21504
    buffer_load_dwordx4 v[108:111], v3, s[8:11], s26 offen sc1
    s_waitcnt lgkmcnt(6)
    v_mfma_f32_32x32x16_bf16 v[152:167], v[216:219], v[60:63], v[152:167]
    ds_read_b128 v[212:215], v3 offset:35840
    s_waitcnt vmcnt(12)
    s_barrier
    s_waitcnt lgkmcnt(6)
    v_mfma_f32_32x32x16_bf16 v[168:183], v[220:223], v[60:63], v[168:183]
    ds_read_b128 v[216:219], v3 offset:36864
    s_add_u32 s26, s23, 22528
    buffer_load_dwordx4 v[112:115], v3, s[8:11], s26 offen sc1
    s_waitcnt vmcnt(12)
    s_waitcnt lgkmcnt(6)
    v_mfma_f32_32x32x16_bf16 v[136:151], v[224:227], v[64:67], v[136:151]
    ds_read_b128 v[220:223], v3 offset:37888
    s_waitcnt lgkmcnt(6)
    v_mfma_f32_32x32x16_bf16 v[152:167], v[228:231], v[64:67], v[152:167]
    ds_read_b128 v[224:227], v3 offset:38912
    s_add_u32 s26, s23, 23552
    buffer_load_dwordx4 v[116:119], v3, s[8:11], s26 offen sc1
    s_waitcnt lgkmcnt(6)
    v_mfma_f32_32x32x16_bf16 v[168:183], v[200:203], v[64:67], v[168:183]
    ds_read_b128 v[228:231], v3 offset:39936
    s_waitcnt vmcnt(12)
    s_waitcnt lgkmcnt(6)
    v_mfma_f32_32x32x16_bf16 v[136:151], v[204:207], v[68:71], v[136:151]
    ds_read_b128 v[200:203], v3 offset:40960
    s_add_u32 s26, s23, 24576
    buffer_load_dwordx4 v[120:123], v3, s[8:11], s26 offen sc1
    s_waitcnt lgkmcnt(6)
    v_mfma_f32_32x32x16_bf16 v[152:167], v[208:211], v[68:71], v[152:167]
    ds_read_b128 v[204:207], v3 offset:41984
    s_waitcnt lgkmcnt(6)
    v_mfma_f32_32x32x16_bf16 v[168:183], v[212:215], v[68:71], v[168:183]
    ds_read_b128 v[208:211], v3 offset:43008
    s_add_u32 s26, s23, 25600
    buffer_load_dwordx4 v[124:127], v3, s[8:11], s26 offen sc1
    s_waitcnt vmcnt(13)
    s_waitcnt lgkmcnt(6)
    v_mfma_f32_32x32x16_bf16 v[136:151], v[216:219], v[72:75], v[136:151]
    ds_read_b128 v[212:215], v3 offset:44032
    s_waitcnt lgkmcnt(6)
    v_mfma_f32_32x32x16_bf16 v[152:167], v[220:223], v[72:75], v[152:167]
    ds_read_b128 v[216:219], v3 offset:45056
    s_add_u32 s26, s23, 26624
    buffer_load_dwordx4 v[128:131], v3, s[8:11], s26 offen sc1
    s_waitcnt lgkmcnt(6)
    v_mfma_f32_32x32x16_bf16 v[168:183], v[224:227], v[72:75], v[168:183]
    ds_read_b128 v[220:223], v3 offset:46080
    s_waitcnt vmcnt(13)
    s_waitcnt lgkmcnt(6)
    v_mfma_f32_32x32x16_bf16 v[136:151], v[228:231], v[76:79], v[136:151]
    ds_read_b128 v[224:227], v3 offset:47104
    s_add_u32 s26, s23, 27648
    buffer_load_dwordx4 v[132:135], v3, s[8:11], s26 offen sc1
    s_waitcnt lgkmcnt(6)
    v_mfma_f32_32x32x16_bf16 v[152:167], v[200:203], v[76:79], v[152:167]
    ds_read_b128 v[228:231], v3 offset:48128
    v_add_f32 v6, v232, v234
    v_add_f32 v7, v233, v235
    v_add_f32 v6, v6, v236
    v_add_f32 v7, v7, v237
    s_waitcnt lgkmcnt(6)
    v_mfma_f32_32x32x16_bf16 v[168:183], v[204:207], v[76:79], v[168:183]
    ds_read_b128 v[200:203], v3 offset:49152
    v_add_f32 v6, v6, v238
    v_add_f32 v7, v7, v239
    v_add_f32 v6, v6, v240
    v_add_f32 v7, v7, v241
    s_add_u32 s29, s25, 37888
    buffer_load_dwordx4 a[120:123], v3, s[8:11], s29 offen
    s_waitcnt vmcnt(14)
    s_waitcnt lgkmcnt(6)
    v_mfma_f32_32x32x16_bf16 v[136:151], v[208:211], v[80:83], v[136:151]
    ds_read_b128 v[204:207], v3 offset:50176
    v_add_f32 v6, v6, v242
    v_add_f32 v7, v7, v243
    v_add_f32 v6, v6, v244
    v_add_f32 v7, v7, v245
    s_waitcnt lgkmcnt(6)
    v_mfma_f32_32x32x16_bf16 v[152:167], v[212:215], v[80:83], v[152:167]
    ds_read_b128 v[208:211], v3 offset:51200
    v_add_f32 v6, v6, v246
    v_add_f32 v7, v7, v247
    v_mov_b32 v8, v6
    s_nop 1
    v_permlane32_swap_b32 v6, v8
    s_add_u32 s29, s25, 38912
    buffer_load_dwordx4 a[124:127], v3, s[8:11], s29 offen
    s_waitcnt lgkmcnt(6)
    v_mfma_f32_32x32x16_bf16 v[168:183], v[216:219], v[80:83], v[168:183]
    ds_read_b128 v[212:215], v3 offset:52224
    v_add_f32 v6, v6, v8
    v_mov_b32 v9, v7
    s_nop 1
    v_permlane32_swap_b32 v7, v9
    v_add_f32 v7, v7, v9
    s_waitcnt vmcnt(14)
    s_waitcnt lgkmcnt(6)
    v_mfma_f32_32x32x16_bf16 v[136:151], v[220:223], v[84:87], v[136:151]
    ds_read_b128 v[216:219], v3 offset:53248
    v_mul_f32 v6, 0x3b124925, v6
    v_mul_f32 v7, 0x3b124925, v7
    v_fma_f32 v7, -v6, v6, v7
    v_max_f32 v7, 0, v7
    s_add_u32 s29, s25, 39936
    buffer_load_dwordx4 a[128:131], v3, s[8:11], s29 offen
    s_waitcnt lgkmcnt(6)
    v_mfma_f32_32x32x16_bf16 v[152:167], v[224:227], v[84:87], v[152:167]
    ds_read_b128 v[220:223], v3 offset:54272
    v_cvt_pk_bf16_f32 v11, v6, v6
    v_lshlrev_b32 v11, 16, v11
    v_cvt_pk_bf16_f32 v7, v7, v7
    v_lshlrev_b32 v7, 16, v7
    s_waitcnt lgkmcnt(6)
    v_mfma_f32_32x32x16_bf16 v[168:183], v[228:231], v[84:87], v[168:183]
    ds_read_b128 v[224:227], v3 offset:55296
    v_add_f32 v7, 0x3727c5ac, v7
    v_cvt_pk_bf16_f32 v7, v7, v7
    v_lshlrev_b32 v7, 16, v7
    v_sqrt_f32 v7, v7
    s_add_u32 s29, s25, 40960
    buffer_load_dwordx4 a[132:135], v3, s[8:11], s29 offen
    s_waitcnt vmcnt(15)
    s_waitcnt lgkmcnt(6)
    v_mfma_f32_32x32x16_bf16 v[136:151], v[200:203], v[88:91], v[136:151]
    ds_read_b128 v[228:231], v3 offset:56320
    v_cvt_pk_bf16_f32 v7, v7, v7
    v_lshlrev_b32 v7, 16, v7
    v_rcp_f32 v10, v7
    v_cvt_pk_bf16_f32 v248, -v11, -v11
    s_barrier
    s_waitcnt lgkmcnt(6)
    v_mfma_f32_32x32x16_bf16 v[152:167], v[204:207], v[88:91], v[152:167]
    ds_read_b128 v[200:203], v3 offset:57344
    v_mov_b32 v249, v248
    v_mov_b32 v250, v248
    v_mov_b32 v251, v248
    v_mul_f32 v10, v10, v10
    s_add_u32 s29, s25, 41984
    buffer_load_dwordx4 a[136:139], v3, s[8:11], s29 offen
    s_waitcnt lgkmcnt(6)
    v_mfma_f32_32x32x16_bf16 v[168:183], v[208:211], v[88:91], v[168:183]
    ds_read_b128 v[204:207], v3 offset:58368
    s_waitcnt vmcnt(15)
    s_waitcnt lgkmcnt(6)
    v_mfma_f32_32x32x16_bf16 v[136:151], v[212:215], v[92:95], v[136:151]
    ds_read_b128 v[208:211], v3 offset:59392
    s_add_u32 s29, s25, 50176
    buffer_load_dwordx4 a[140:143], v3, s[8:11], s29 offen
    s_waitcnt lgkmcnt(6)
    v_mfma_f32_32x32x16_bf16 v[152:167], v[216:219], v[92:95], v[152:167]
    ds_read_b128 v[212:215], v3 offset:60416
    s_waitcnt lgkmcnt(6)
    v_mfma_f32_32x32x16_bf16 v[168:183], v[220:223], v[92:95], v[168:183]
    ds_read_b128 v[216:219], v3 offset:61440
    s_add_u32 s29, s25, 51200
    buffer_load_dwordx4 a[144:147], v3, s[8:11], s29 offen
    s_waitcnt vmcnt(16)
    s_waitcnt lgkmcnt(6)
    v_mfma_f32_32x32x16_bf16 v[136:151], v[224:227], v[96:99], v[136:151]
    ds_read_b128 v[220:223], v3 offset:62464
    s_waitcnt lgkmcnt(6)
    v_mfma_f32_32x32x16_bf16 v[152:167], v[228:231], v[96:99], v[152:167]
    ds_read_b128 v[224:227], v3 offset:63488
    s_add_u32 s29, s25, 52224
    buffer_load_dwordx4 a[148:151], v3, s[8:11], s29 offen
    s_waitcnt lgkmcnt(6)
    v_mfma_f32_32x32x16_bf16 v[168:183], v[200:203], v[96:99], v[168:183]
    ds_read_b128 v[228:231], v3 offset:64512
    s_waitcnt vmcnt(16)
    s_waitcnt lgkmcnt(6)
    v_mfma_f32_32x32x16_bf16 v[136:151], v[204:207], v[100:103], v[136:151]
    ds_read_b128 v[200:203], v4 offset:0
    s_add_u32 s29, s25, 53248
    buffer_load_dwordx4 a[152:155], v3, s[8:11], s29 offen
    s_waitcnt lgkmcnt(6)
    v_mfma_f32_32x32x16_bf16 v[152:167], v[208:211], v[100:103], v[152:167]
    ds_read_b128 v[204:207], v4 offset:1024
    s_waitcnt lgkmcnt(6)
    v_mfma_f32_32x32x16_bf16 v[168:183], v[212:215], v[100:103], v[168:183]
    ds_read_b128 v[208:211], v4 offset:2048
    s_add_u32 s29, s25, 54272
    buffer_load_dwordx4 a[156:159], v3, s[8:11], s29 offen
    s_waitcnt vmcnt(17)
    s_waitcnt lgkmcnt(6)
    v_mfma_f32_32x32x16_bf16 v[136:151], v[216:219], v[104:107], v[136:151]
    ds_read_b128 v[212:215], v4 offset:3072
    s_waitcnt lgkmcnt(6)
    v_mfma_f32_32x32x16_bf16 v[152:167], v[220:223], v[104:107], v[152:167]
    ds_read_b128 v[216:219], v4 offset:4096
    s_add_u32 s29, s25, 55296
    buffer_load_dwordx4 a[160:163], v3, s[8:11], s29 offen
    s_barrier
    s_waitcnt lgkmcnt(6)
    v_mfma_f32_32x32x16_bf16 v[168:183], v[224:227], v[104:107], v[168:183]
    ds_read_b128 v[220:223], v4 offset:5120
    s_waitcnt vmcnt(17)
    s_waitcnt lgkmcnt(6)
    v_mfma_f32_32x32x16_bf16 v[136:151], v[228:231], v[108:111], v[136:151]
    ds_read_b128 v[224:227], v4 offset:6144
    s_add_u32 m0, s28, 0
    s_add_u32 s27, s24, 159744
    buffer_load_dwordx4 v3, s[8:11], s27 offen lds
    s_waitcnt lgkmcnt(6)
    v_mfma_f32_32x32x16_bf16 v[152:167], v[200:203], v[108:111], v[152:167]
    ds_read_b128 v[228:231], v4 offset:7168
    s_waitcnt lgkmcnt(6)
    v_mfma_f32_32x32x16_bf16 v[168:183], v[204:207], v[108:111], v[168:183]
    ds_read_b128 v[200:203], v4 offset:8192
    s_add_u32 m0, s28, 4096
    s_add_u32 s27, s24, 163840
    buffer_load_dwordx4 v3, s[8:11], s27 offen lds
    s_waitcnt vmcnt(18)
    s_waitcnt lgkmcnt(6)
    v_mfma_f32_32x32x16_bf16 v[136:151], v[208:211], v[112:115], v[136:151]
    ds_read_b128 v[204:207], v4 offset:9216
    s_waitcnt lgkmcnt(6)
    v_mfma_f32_32x32x16_bf16 v[152:167], v[212:215], v[112:115], v[152:167]
    ds_read_b128 v[208:211], v4 offset:10240
    s_add_u32 m0, s28, 8192
    s_add_u32 s27, s24, 167936
    buffer_load_dwordx4 v3, s[8:11], s27 offen lds
    s_waitcnt lgkmcnt(6)
    v_mfma_f32_32x32x16_bf16 v[168:183], v[216:219], v[112:115], v[168:183]
    ds_read_b128 v[212:215], v4 offset:11264
    s_waitcnt vmcnt(18)
    s_waitcnt lgkmcnt(6)
    v_mfma_f32_32x32x16_bf16 v[136:151], v[220:223], v[116:119], v[136:151]
    ds_read_b128 v[216:219], v4 offset:12288
    s_add_u32 m0, s28, 12288
    s_add_u32 s27, s24, 172032
    buffer_load_dwordx4 v3, s[8:11], s27 offen lds
    s_waitcnt lgkmcnt(6)
    v_mfma_f32_32x32x16_bf16 v[152:167], v[224:227], v[116:119], v[152:167]
    ds_read_b128 v[220:223], v4 offset:13312
    s_waitcnt lgkmcnt(6)
    v_mfma_f32_32x32x16_bf16 v[168:183], v[228:231], v[116:119], v[168:183]
    ds_read_b128 v[224:227], v4 offset:14336
    s_add_u32 m0, s28, 16384
    s_add_u32 s27, s24, 176128
    buffer_load_dwordx4 v3, s[8:11], s27 offen lds
    s_waitcnt vmcnt(19)
    s_waitcnt lgkmcnt(6)
    v_mfma_f32_32x32x16_bf16 v[136:151], v[200:203], v[120:123], v[136:151]
    ds_read_b128 v[228:231], v4 offset:15360
    s_waitcnt lgkmcnt(6)
    v_mfma_f32_32x32x16_bf16 v[152:167], v[204:207], v[120:123], v[152:167]
    ds_read_b128 v[200:203], v4 offset:16384
    s_add_u32 m0, s28, 20480
    s_add_u32 s27, s24, 180224
    buffer_load_dwordx4 v3, s[8:11], s27 offen lds
    s_waitcnt lgkmcnt(6)
    v_mfma_f32_32x32x16_bf16 v[168:183], v[208:211], v[120:123], v[168:183]
    ds_read_b128 v[204:207], v4 offset:17408
    s_waitcnt vmcnt(19)
    s_waitcnt lgkmcnt(6)
    v_mfma_f32_32x32x16_bf16 v[136:151], v[212:215], v[124:127], v[136:151]
    ds_read_b128 v[208:211], v4 offset:18432
    s_add_u32 m0, s28, 24576
    s_add_u32 s27, s24, 184320
    buffer_load_dwordx4 v3, s[8:11], s27 offen lds
    s_waitcnt lgkmcnt(6)
    v_mfma_f32_32x32x16_bf16 v[152:167], v[216:219], v[124:127], v[152:167]
    ds_read_b128 v[212:215], v4 offset:19456
    s_barrier
    s_waitcnt lgkmcnt(6)
    v_mfma_f32_32x32x16_bf16 v[168:183], v[220:223], v[124:127], v[168:183]
    ds_read_b128 v[216:219], v4 offset:20480
    s_add_u32 m0, s28, 28672
    s_add_u32 s27, s24, 188416
    buffer_load_dwordx4 v3, s[8:11], s27 offen lds
    s_waitcnt vmcnt(20)
    s_waitcnt lgkmcnt(6)
    v_mfma_f32_32x32x16_bf16 v[136:151], v[224:227], v[128:131], v[136:151]
    ds_read_b128 v[220:223], v4 offset:21504
    s_waitcnt lgkmcnt(6)
    v_mfma_f32_32x32x16_bf16 v[152:167], v[228:231], v[128:131], v[152:167]
    ds_read_b128 v[224:227], v4 offset:22528
    s_add_u32 m0, s28, 32768
    s_add_u32 s27, s24, 192512
    buffer_load_dwordx4 v3, s[8:11], s27 offen lds
    s_waitcnt lgkmcnt(6)
    v_mfma_f32_32x32x16_bf16 v[168:183], v[200:203], v[128:131], v[168:183]
    ds_read_b128 v[228:231], v4 offset:23552
    s_waitcnt vmcnt(20)
    s_waitcnt lgkmcnt(6)
    v_mfma_f32_32x32x16_bf16 v[136:151], v[204:207], v[132:135], v[136:151]
    ds_read_b128 v[200:203], v4 offset:24576
    s_add_u32 m0, s28, 36864
    s_add_u32 s27, s24, 196608
    buffer_load_dwordx4 v3, s[8:11], s27 offen lds
    s_waitcnt lgkmcnt(6)
    v_mfma_f32_32x32x16_bf16 v[152:167], v[208:211], v[132:135], v[152:167]
    ds_read_b128 v[204:207], v4 offset:25600
    s_waitcnt lgkmcnt(6)
    v_mfma_f32_32x32x16_bf16 v[168:183], v[212:215], v[132:135], v[168:183]
    ds_read_b128 v[208:211], v4 offset:26624
    s_add_u32 m0, s28, 40960
    s_add_u32 s27, s24, 200704
    buffer_load_dwordx4 v3, s[8:11], s27 offen lds
    s_waitcnt lgkmcnt(6)
    v_mfma_f32_32x32x16_bf16 v[184:199], v[216:219], v[24:27], 0
    ds_read_b128 v[212:215], v4 offset:27648
    s_waitcnt lgkmcnt(6)
    v_mfma_f32_32x32x16_bf16 v[184:199], v[220:223], v[28:31], v[184:199]
    ds_read_b128 v[216:219], v4 offset:28672
    s_add_u32 m0, s28, 45056
    s_add_u32 s27, s24, 204800
    buffer_load_dwordx4 v3, s[8:11], s27 offen lds
    s_waitcnt lgkmcnt(6)
    v_mfma_f32_32x32x16_bf16 v[184:199], v[224:227], v[32:35], v[184:199]
    ds_read_b128 v[220:223], v4 offset:29696
    s_waitcnt lgkmcnt(6)
    v_mfma_f32_32x32x16_bf16 v[184:199], v[228:231], v[36:39], v[184:199]
    ds_read_b128 v[224:227], v4 offset:30720
    s_add_u32 s29, s25, 56320
    buffer_load_dwordx4 a[164:167], v3, s[8:11], s29 offen
    s_waitcnt lgkmcnt(6)
    v_mfma_f32_32x32x16_bf16 v[184:199], v[200:203], v[40:43], v[184:199]
    ds_read_b128 v[228:231], v4 offset:31744
    s_waitcnt lgkmcnt(6)
    v_mfma_f32_32x32x16_bf16 v[184:199], v[204:207], v[44:47], v[184:199]
    ds_read_b128 v[200:203], v4 offset:32768
    s_add_u32 s29, s25, 64512
    buffer_load_dwordx4 a[168:171], v3, s[8:11], s29 offen
    s_waitcnt lgkmcnt(6)
    v_mfma_f32_32x32x16_bf16 v[184:199], v[208:211], v[48:51], v[184:199]
    ds_read_b128 v[204:207], v4 offset:33792
    s_waitcnt lgkmcnt(6)
    v_mfma_f32_32x32x16_bf16 v[136:151], v[212:215], v[248:251], v[136:151]
    ds_read_b128 v[208:211], v4 offset:34816
    s_add_u32 s29, s25, 65536
    buffer_load_dwordx4 a[172:175], v3, s[8:11], s29 offen
    s_waitcnt lgkmcnt(6)
    v_mfma_f32_32x32x16_bf16 v[152:167], v[216:219], v[248:251], v[152:167]
    ds_read_b128 v[212:215], v4 offset:35840
    s_waitcnt lgkmcnt(6)
    v_mfma_f32_32x32x16_bf16 v[168:183], v[220:223], v[248:251], v[168:183]
    ds_read_b128 v[216:219], v4 offset:36864
    s_add_u32 s29, s25, 66560
    buffer_load_dwordx4 a[176:179], v3, s[8:11], s29 offen
    s_waitcnt lgkmcnt(6)
    v_mfma_f32_32x32x16_bf16 v[184:199], v[224:227], v[52:55], v[184:199]
    ds_read_b128 v[220:223], v4 offset:37888
    v_max_f32 v136, 0, v136
    v_max_f32 v137, 0, v137
    v_max_f32 v138, 0, v138
    v_max_f32 v139, 0, v139
    s_waitcnt lgkmcnt(6)
    v_mfma_f32_32x32x16_bf16 v[184:199], v[228:231], v[56:59], v[184:199]
    ds_read_b128 v[224:227], v4 offset:38912
    v_mul_f32 v140, v10, v140
    v_mul_f32 v141, v10, v141
    v_mul_f32 v142, v10, v142
    v_mul_f32 v143, v10, v143
    s_add_u32 s29, s25, 67584
    buffer_load_dwordx4 a[180:183], v3, s[8:11], s29 offen
    s_waitcnt lgkmcnt(6)
    v_mfma_f32_32x32x16_bf16 v[184:199], v[200:203], v[60:63], v[184:199]
    ds_read_b128 v[228:231], v4 offset:39936
    v_mul_f32 v136, v136, v140
    v_mul_f32 v137, v137, v141
    v_mul_f32 v138, v138, v142
    v_mul_f32 v139, v139, v143
    s_waitcnt lgkmcnt(6)
    v_mfma_f32_32x32x16_bf16 v[184:199], v[204:207], v[64:67], v[184:199]
    ds_read_b128 v[200:203], v4 offset:40960
    v_cvt_pk_bf16_f32 v232, v136, v137
    v_cvt_pk_bf16_f32 v233, v138, v139
    v_max_f32 v144, 0, v144
    v_max_f32 v145, 0, v145
    s_add_u32 s29, s25, 68608
    buffer_load_dwordx4 a[184:187], v3, s[8:11], s29 offen
    s_waitcnt lgkmcnt(6)
    v_mfma_f32_32x32x16_bf16 v[184:199], v[208:211], v[68:71], v[184:199]
    ds_read_b128 v[204:207], v4 offset:41984
    v_max_f32 v146, 0, v146
    v_max_f32 v147, 0, v147
    v_mul_f32 v148, v10, v148
    v_mul_f32 v149, v10, v149
    s_waitcnt lgkmcnt(6)
    v_mfma_f32_32x32x16_bf16 v[184:199], v[212:215], v[72:75], v[184:199]
    ds_read_b128 v[208:211], v4 offset:43008
    v_mul_f32 v150, v10, v150
    v_mul_f32 v151, v10, v151
    v_mul_f32 v144, v144, v148
    v_mul_f32 v145, v145, v149
    s_add_u32 s29, s25, 69632
    buffer_load_dwordx4 a[188:191], v3, s[8:11], s29 offen
    s_waitcnt lgkmcnt(6)
    v_mfma_f32_32x32x16_bf16 v[184:199], v[216:219], v[76:79], v[184:199]
    ds_read_b128 v[212:215], v4 offset:44032
    v_mul_f32 v146, v146, v150
    v_mul_f32 v147, v147, v151
    v_cvt_pk_bf16_f32 v234, v144, v145
    v_cvt_pk_bf16_f32 v235, v146, v147
    s_waitcnt lgkmcnt(6)
    v_mfma_f32_32x32x16_bf16 v[184:199], v[220:223], v[80:83], v[184:199]
    ds_read_b128 v[216:219], v4 offset:45056
    s_add_u32 s26, s36, 0
    buffer_store_dwordx4 v[232:235], v3, s[8:11], s26 offen sc1
    v_max_f32 v152, 0, v152
    v_max_f32 v153, 0, v153
    v_max_f32 v154, 0, v154
    s_add_u32 s29, s25, 70656
    buffer_load_dwordx4 a[192:195], v3, s[8:11], s29 offen
    s_waitcnt lgkmcnt(6)
    v_mfma_f32_32x32x16_bf16 v[184:199], v[224:227], v[84:87], v[184:199]
    ds_read_b128 v[220:223], v4 offset:46080
    v_max_f32 v155, 0, v155
    v_mul_f32 v156, v10, v156
    v_mul_f32 v157, v10, v157
    v_mul_f32 v158, v10, v158
    s_waitcnt lgkmcnt(6)
    v_mfma_f32_32x32x16_bf16 v[184:199], v[228:231], v[88:91], v[184:199]
    ds_read_b128 v[224:227], v4 offset:47104
    v_mul_f32 v159, v10, v159
    v_mul_f32 v152, v152, v156
    v_mul_f32 v153, v153, v157
    v_mul_f32 v154, v154, v158
    s_add_u32 s29, s25, 78848
    buffer_load_dwordx4 a[196:199], v3, s[8:11], s29 offen
    s_waitcnt lgkmcnt(6)
    v_mfma_f32_32x32x16_bf16 v[184:199], v[200:203], v[92:95], v[184:199]
    ds_read_b128 v[228:231], v4 offset:48128
    v_mul_f32 v155, v155, v159
    v_cvt_pk_bf16_f32 v236, v152, v153
    v_cvt_pk_bf16_f32 v237, v154, v155
    v_max_f32 v160, 0, v160
    s_waitcnt lgkmcnt(6)
    v_mfma_f32_32x32x16_bf16 v[184:199], v[204:207], v[96:99], v[184:199]
    ds_read_b128 v[200:203], v4 offset:49152
    v_max_f32 v161, 0, v161
    v_max_f32 v162, 0, v162
    v_max_f32 v163, 0, v163
    v_mul_f32 v164, v10, v164
    s_add_u32 s29, s25, 79872
    buffer_load_dwordx4 a[200:203], v3, s[8:11], s29 offen
    s_waitcnt lgkmcnt(6)
    v_mfma_f32_32x32x16_bf16 v[184:199], v[208:211], v[100:103], v[184:199]
    ds_read_b128 v[204:207], v4 offset:50176
    v_mul_f32 v165, v10, v165
    v_mul_f32 v166, v10, v166
    v_mul_f32 v167, v10, v167
    v_mul_f32 v160, v160, v164
    s_waitcnt lgkmcnt(6)
    v_mfma_f32_32x32x16_bf16 v[184:199], v[212:215], v[104:107], v[184:199]
    ds_read_b128 v[208:211], v4 offset:51200
    v_mul_f32 v161, v161, v165
    v_mul_f32 v162, v162, v166
    v_mul_f32 v163, v163, v167
    v_cvt_pk_bf16_f32 v238, v160, v161
    s_add_u32 s29, s25, 80896
    buffer_load_dwordx4 a[204:207], v3, s[8:11], s29 offen
    s_waitcnt lgkmcnt(6)
    v_mfma_f32_32x32x16_bf16 v[184:199], v[216:219], v[108:111], v[184:199]
    ds_read_b128 v[212:215], v4 offset:52224
    v_cvt_pk_bf16_f32 v239, v162, v163
    s_add_u32 s26, s36, 1024
    buffer_store_dwordx4 v[236:239], v3, s[8:11], s26 offen sc1
    v_max_f32 v168, 0, v168
    v_max_f32 v169, 0, v169
    s_waitcnt lgkmcnt(6)
    v_mfma_f32_32x32x16_bf16 v[184:199], v[220:223], v[112:115], v[184:199]
    ds_read_b128 v[216:219], v4 offset:53248
    v_max_f32 v170, 0, v170
    v_max_f32 v171, 0, v171
    v_mul_f32 v172, v10, v172
    v_mul_f32 v173, v10, v173
    s_add_u32 s29, s25, 81920
    buffer_load_dwordx4 a[208:211], v3, s[8:11], s29 offen
    s_waitcnt lgkmcnt(6)
    v_mfma_f32_32x32x16_bf16 v[184:199], v[224:227], v[116:119], v[184:199]
    ds_read_b128 v[220:223], v4 offset:54272
    v_mul_f32 v174, v10, v174
    v_mul_f32 v175, v10, v175
    v_mul_f32 v168, v168, v172
    v_mul_f32 v169, v169, v173
    s_waitcnt lgkmcnt(6)
    v_mfma_f32_32x32x16_bf16 v[184:199], v[228:231], v[120:123], v[184:199]
    ds_read_b128 v[224:227], v4 offset:55296
    v_mul_f32 v170, v170, v174
    v_mul_f32 v171, v171, v175
    v_cvt_pk_bf16_f32 v232, v168, v169
    v_cvt_pk_bf16_f32 v233, v170, v171
    s_add_u32 s29, s25, 82944
    buffer_load_dwordx4 a[212:215], v3, s[8:11], s29 offen
    s_waitcnt lgkmcnt(6)
    v_mfma_f32_32x32x16_bf16 v[184:199], v[200:203], v[124:127], v[184:199]
    ds_read_b128 v[228:231], v4 offset:56320
    v_max_f32 v176, 0, v176
    v_max_f32 v177, 0, v177
    v_max_f32 v178, 0, v178
    v_max_f32 v179, 0, v179
    s_barrier
    s_waitcnt lgkmcnt(6)
    v_mfma_f32_32x32x16_bf16 v[184:199], v[204:207], v[128:131], v[184:199]
    ds_read_b128 v[200:203], v4 offset:57344
    v_mul_f32 v180, v10, v180
    v_mul_f32 v181, v10, v181
    v_mul_f32 v182, v10, v182
    v_mul_f32 v183, v10, v183
    s_add_u32 s29, s25, 83968
    buffer_load_dwordx4 a[216:219], v3, s[8:11], s29 offen
    s_waitcnt lgkmcnt(6)
    v_mfma_f32_32x32x16_bf16 v[184:199], v[208:211], v[132:135], v[184:199]
    ds_read_b128 v[204:207], v4 offset:58368
    v_mul_f32 v176, v176, v180
    v_mul_f32 v177, v177, v181
    v_mul_f32 v178, v178, v182
    v_mul_f32 v179, v179, v183
    s_waitcnt lgkmcnt(6)
    v_mfma_f32_32x32x16_bf16 v[184:199], v[212:215], v[248:251], v[184:199]
    ds_read_b128 v[208:211], v4 offset:59392
    v_cvt_pk_bf16_f32 v234, v176, v177
    v_cvt_pk_bf16_f32 v235, v178, v179
    s_add_u32 s26, s36, 2048
    buffer_store_dwordx4 v[232:235], v3, s[8:11], s26 offen sc1
    s_add_u32 s29, s25, 84992
    buffer_load_dwordx4 a[220:223], v3, s[8:11], s29 offen
    s_waitcnt lgkmcnt(6)
    v_mfma_f32_32x32x16_bf16 v[136:151], v[216:219], v[24:27], 0
    ds_read_b128 v[212:215], v4 offset:60416
    s_waitcnt lgkmcnt(6)
    v_mfma_f32_32x32x16_bf16 v[152:167], v[220:223], v[24:27], 0
    ds_read_b128 v[216:219], v4 offset:61440
    s_add_u32 s29, s25, 86016
    buffer_load_dwordx4 a[224:227], v3, s[8:11], s29 offen
    s_waitcnt lgkmcnt(6)
    v_mfma_f32_32x32x16_bf16 v[168:183], v[224:227], v[24:27], 0
    ds_read_b128 v[220:223], v4 offset:62464
    v_max_f32 v184, 0, v184
    v_max_f32 v185, 0, v185
    v_max_f32 v186, 0, v186
    v_max_f32 v187, 0, v187
    s_waitcnt lgkmcnt(6)
    v_mfma_f32_32x32x16_bf16 v[136:151], v[228:231], v[28:31], v[136:151]
    ds_read_b128 v[224:227], v4 offset:63488
    v_mul_f32 v188, v10, v188
    v_mul_f32 v189, v10, v189
    v_mul_f32 v190, v10, v190
    v_mul_f32 v191, v10, v191
    s_add_u32 s29, s25, 87040
    buffer_load_dwordx4 a[228:231], v3, s[8:11], s29 offen
    s_waitcnt lgkmcnt(6)
    v_mfma_f32_32x32x16_bf16 v[152:167], v[200:203], v[28:31], v[152:167]
    ds_read_b128 v[228:231], v4 offset:64512
    v_mul_f32 v184, v184, v188
    v_mul_f32 v185, v185, v189
    v_mul_f32 v186, v186, v190
    v_mul_f32 v187, v187, v191
    s_waitcnt lgkmcnt(6)
    v_mfma_f32_32x32x16_bf16 v[168:183], v[204:207], v[28:31], v[168:183]
    ds_read_b128 v[200:203], v5 offset:0
    v_cvt_pk_bf16_f32 v236, v184, v185
    v_cvt_pk_bf16_f32 v237, v186, v187
    v_max_f32 v192, 0, v192
    v_max_f32 v193, 0, v193
    s_add_u32 s29, s25, 28672
    buffer_load_dwordx4 v[24:27], v3, s[8:11], s29 offen
    s_waitcnt lgkmcnt(6)
    v_mfma_f32_32x32x16_bf16 v[136:151], v[208:211], v[32:35], v[136:151]
    ds_read_b128 v[204:207], v5 offset:1024
    v_max_f32 v194, 0, v194
    v_max_f32 v195, 0, v195
    v_mul_f32 v196, v10, v196
    v_mul_f32 v197, v10, v197
    s_waitcnt lgkmcnt(6)
    v_mfma_f32_32x32x16_bf16 v[152:167], v[212:215], v[32:35], v[152:167]
    ds_read_b128 v[208:211], v5 offset:2048
    v_mul_f32 v198, v10, v198
    v_mul_f32 v199, v10, v199
    v_mul_f32 v192, v192, v196
    v_mul_f32 v193, v193, v197
    s_add_u32 s29, s25, 29696
    buffer_load_dwordx4 v[28:31], v3, s[8:11], s29 offen
    s_waitcnt lgkmcnt(6)
    v_mfma_f32_32x32x16_bf16 v[168:183], v[216:219], v[32:35], v[168:183]
    ds_read_b128 v[212:215], v5 offset:3072
    v_mul_f32 v194, v194, v198
    v_mul_f32 v195, v195, v199
    v_cvt_pk_bf16_f32 v238, v192, v193
    v_cvt_pk_bf16_f32 v239, v194, v195
    s_waitcnt lgkmcnt(6)
    v_mfma_f32_32x32x16_bf16 v[136:151], v[220:223], v[36:39], v[136:151]
    ds_read_b128 v[216:219], v5 offset:4096
    s_add_u32 s26, s36, 3072
    buffer_store_dwordx4 v[236:239], v3, s[8:11], s26 offen sc1
    s_add_u32 s29, s25, 88064
    buffer_load_dwordx4 a[232:235], v3, s[8:11], s29 offen
    s_waitcnt lgkmcnt(6)
    v_mfma_f32_32x32x16_bf16 v[152:167], v[224:227], v[36:39], v[152:167]
    ds_read_b128 v[220:223], v5 offset:5120
    s_waitcnt lgkmcnt(6)
    v_mfma_f32_32x32x16_bf16 v[168:183], v[228:231], v[36:39], v[168:183]
    ds_read_b128 v[224:227], v5 offset:6144
    s_add_u32 s29, s25, 30720
    buffer_load_dwordx4 v[32:35], v3, s[8:11], s29 offen
    s_waitcnt lgkmcnt(6)
    v_mfma_f32_32x32x16_bf16 v[136:151], v[200:203], v[40:43], v[136:151]
    ds_read_b128 v[228:231], v5 offset:7168
    s_waitcnt lgkmcnt(6)
    v_mfma_f32_32x32x16_bf16 v[152:167], v[204:207], v[40:43], v[152:167]
    ds_read_b128 v[200:203], v5 offset:8192
    s_add_u32 s29, s25, 31744
    buffer_load_dwordx4 v[36:39], v3, s[8:11], s29 offen
    s_waitcnt lgkmcnt(6)
    v_mfma_f32_32x32x16_bf16 v[168:183], v[208:211], v[40:43], v[168:183]
    ds_read_b128 v[204:207], v5 offset:9216
    s_waitcnt lgkmcnt(6)
    v_mfma_f32_32x32x16_bf16 v[136:151], v[212:215], v[44:47], v[136:151]
    ds_read_b128 v[208:211], v5 offset:10240
    s_add_u32 s29, s25, 89088
    buffer_load_dwordx4 a[236:239], v3, s[8:11], s29 offen
    s_waitcnt lgkmcnt(6)
    v_mfma_f32_32x32x16_bf16 v[152:167], v[216:219], v[44:47], v[152:167]
    ds_read_b128 v[212:215], v5 offset:11264
    s_waitcnt lgkmcnt(6)
    v_mfma_f32_32x32x16_bf16 v[168:183], v[220:223], v[44:47], v[168:183]
    ds_read_b128 v[216:219], v5 offset:12288
    s_add_u32 s29, s25, 32768
    buffer_load_dwordx4 v[40:43], v3, s[8:11], s29 offen
    s_waitcnt lgkmcnt(6)
    v_mfma_f32_32x32x16_bf16 v[136:151], v[224:227], v[48:51], v[136:151]
    ds_read_b128 v[220:223], v5 offset:13312
    s_waitcnt lgkmcnt(6)
    v_mfma_f32_32x32x16_bf16 v[152:167], v[228:231], v[48:51], v[152:167]
    ds_read_b128 v[224:227], v5 offset:14336
    s_add_u32 s29, s25, 33792
    buffer_load_dwordx4 v[44:47], v3, s[8:11], s29 offen
    s_waitcnt lgkmcnt(6)
    v_mfma_f32_32x32x16_bf16 v[168:183], v[200:203], v[48:51], v[168:183]
    ds_read_b128 v[228:231], v5 offset:15360
    s_waitcnt lgkmcnt(6)
    v_mfma_f32_32x32x16_bf16 v[136:151], v[204:207], v[52:55], v[136:151]
    ds_read_b128 v[200:203], v5 offset:16384
    s_add_u32 s29, s25, 90112
    buffer_load_dwordx4 a[240:243], v3, s[8:11], s29 offen
    s_waitcnt lgkmcnt(6)
    v_mfma_f32_32x32x16_bf16 v[152:167], v[208:211], v[52:55], v[152:167]
    ds_read_b128 v[204:207], v5 offset:17408
    s_waitcnt lgkmcnt(6)
    v_mfma_f32_32x32x16_bf16 v[168:183], v[212:215], v[52:55], v[168:183]
    ds_read_b128 v[208:211], v5 offset:18432
    s_add_u32 s29, s25, 34816
    buffer_load_dwordx4 v[48:51], v3, s[8:11], s29 offen
    s_waitcnt lgkmcnt(6)
    v_mfma_f32_32x32x16_bf16 v[136:151], v[216:219], v[56:59], v[136:151]
    ds_read_b128 v[212:215], v5 offset:19456
    s_waitcnt lgkmcnt(6)
    v_mfma_f32_32x32x16_bf16 v[152:167], v[220:223], v[56:59], v[152:167]
    ds_read_b128 v[216:219], v5 offset:20480
    s_add_u32 s29, s25, 43008
    buffer_load_dwordx4 v[52:55], v3, s[8:11], s29 offen
    s_waitcnt lgkmcnt(6)
    v_mfma_f32_32x32x16_bf16 v[168:183], v[224:227], v[56:59], v[168:183]
    ds_read_b128 v[220:223], v5 offset:21504
    s_waitcnt lgkmcnt(6)
    v_mfma_f32_32x32x16_bf16 v[136:151], v[228:231], v[60:63], v[136:151]
    ds_read_b128 v[224:227], v5 offset:22528
    s_add_u32 s29, s25, 91136
    buffer_load_dwordx4 a[244:247], v3, s[8:11], s29 offen
    s_waitcnt lgkmcnt(6)
    v_mfma_f32_32x32x16_bf16 v[152:167], v[200:203], v[60:63], v[152:167]
    ds_read_b128 v[228:231], v5 offset:23552
    s_waitcnt lgkmcnt(6)
    v_mfma_f32_32x32x16_bf16 v[168:183], v[204:207], v[60:63], v[168:183]
    ds_read_b128 v[200:203], v5 offset:24576
    s_add_u32 s29, s25, 44032
    buffer_load_dwordx4 v[56:59], v3, s[8:11], s29 offen
    s_waitcnt lgkmcnt(6)
    v_mfma_f32_32x32x16_bf16 v[136:151], v[208:211], v[64:67], v[136:151]
    ds_read_b128 v[204:207], v5 offset:25600
    s_waitcnt lgkmcnt(6)
    v_mfma_f32_32x32x16_bf16 v[152:167], v[212:215], v[64:67], v[152:167]
    ds_read_b128 v[208:211], v5 offset:26624
    s_add_u32 s29, s25, 45056
    buffer_load_dwordx4 v[60:63], v3, s[8:11], s29 offen
    s_waitcnt lgkmcnt(6)
    v_mfma_f32_32x32x16_bf16 v[168:183], v[216:219], v[64:67], v[168:183]
    ds_read_b128 v[212:215], v5 offset:27648
    s_waitcnt vmcnt(35)
    s_barrier
    s_waitcnt lgkmcnt(6)
    v_mfma_f32_32x32x16_bf16 v[136:151], v[220:223], v[68:71], v[136:151]
    ds_read_b128 v[216:219], v3 offset:0
    s_add_u32 s29, s25, 92160
    buffer_load_dwordx4 a[248:251], v3, s[8:11], s29 offen
    s_waitcnt vmcnt(13)
    v_mov_b32 v14, 4
    v_mov_b32 v13, 0
    s_add_u32 s35, s34, 0
    s_mov_b64 exec, 1
    buffer_store_dword v14, v13, s[8:11], s35 offen sc1
    s_mov_b64 exec, -1
    s_waitcnt lgkmcnt(6)
    v_mfma_f32_32x32x16_bf16 v[152:167], v[224:227], v[68:71], v[152:167]
    ds_read_b128 v[220:223], v3 offset:1024
    s_waitcnt lgkmcnt(6)
    v_mfma_f32_32x32x16_bf16 v[168:183], v[228:231], v[68:71], v[168:183]
    ds_read_b128 v[224:227], v3 offset:2048
    s_add_u32 s29, s25, 46080
    buffer_load_dwordx4 v[64:67], v3, s[8:11], s29 offen
    s_waitcnt lgkmcnt(6)
    v_mfma_f32_32x32x16_bf16 v[136:151], v[200:203], v[72:75], v[136:151]
    ds_read_b128 v[228:231], v3 offset:3072
    s_waitcnt lgkmcnt(6)
    v_mfma_f32_32x32x16_bf16 v[152:167], v[204:207], v[72:75], v[152:167]
    ds_read_b128 v[200:203], v3 offset:4096
    s_add_u32 s29, s25, 47104
    buffer_load_dwordx4 v[68:71], v3, s[8:11], s29 offen
    s_waitcnt lgkmcnt(6)
    v_mfma_f32_32x32x16_bf16 v[168:183], v[208:211], v[72:75], v[168:183]
    ds_read_b128 v[204:207], v3 offset:5120
    s_waitcnt lgkmcnt(6)
    v_mfma_f32_32x32x16_bf16 v[136:151], v[212:215], v[76:79], v[136:151]
    ds_read_b128 v[208:211], v3 offset:6144
    s_waitcnt lgkmcnt(6)
    v_mfma_f32_32x32x16_bf16 v[152:167], v[216:219], v[76:79], v[152:167]
    ds_read_b128 v[212:215], v3 offset:7168
    s_add_u32 s29, s25, 48128
    buffer_load_dwordx4 v[72:75], v3, s[8:11], s29 offen
    s_waitcnt lgkmcnt(6)
    v_mfma_f32_32x32x16_bf16 v[168:183], v[220:223], v[76:79], v[168:183]
    ds_read_b128 v[216:219], v3 offset:8192
    s_waitcnt lgkmcnt(6)
    v_mfma_f32_32x32x16_bf16 v[136:151], v[224:227], v[80:83], v[136:151]
    ds_read_b128 v[220:223], v3 offset:9216
    s_waitcnt lgkmcnt(6)
    v_mfma_f32_32x32x16_bf16 v[152:167], v[228:231], v[80:83], v[152:167]
    ds_read_b128 v[224:227], v3 offset:10240
    s_add_u32 s29, s25, 49152
    buffer_load_dwordx4 v[76:79], v3, s[8:11], s29 offen
    s_add_u32 s33, s32, 0
    v_and_b32 v245, 3, v2
    v_lshlrev_b32 v245, 8, v245
    buffer_load_dword v244, v245, s[8:11], s33 offen sc1
    s_waitcnt lgkmcnt(6)
    v_mfma_f32_32x32x16_bf16 v[168:183], v[200:203], v[80:83], v[168:183]
    ds_read_b128 v[228:231], v3 offset:11264
    s_waitcnt lgkmcnt(6)
    v_mfma_f32_32x32x16_bf16 v[136:151], v[204:207], v[84:87], v[136:151]
    ds_read_b128 v[200:203], v3 offset:12288
    s_waitcnt lgkmcnt(6)
    v_mfma_f32_32x32x16_bf16 v[152:167], v[208:211], v[84:87], v[152:167]
    ds_read_b128 v[204:207], v3 offset:13312
    s_waitcnt lgkmcnt(6)
    v_mfma_f32_32x32x16_bf16 v[168:183], v[212:215], v[84:87], v[168:183]
    ds_read_b128 v[208:211], v3 offset:14336
    s_waitcnt lgkmcnt(6)
    v_mfma_f32_32x32x16_bf16 v[136:151], v[216:219], v[88:91], v[136:151]
    ds_read_b128 v[212:215], v3 offset:15360
    s_waitcnt lgkmcnt(6)
    v_mfma_f32_32x32x16_bf16 v[152:167], v[220:223], v[88:91], v[152:167]
    ds_read_b128 v[216:219], v3 offset:16384
    s_waitcnt lgkmcnt(6)
    v_mfma_f32_32x32x16_bf16 v[168:183], v[224:227], v[88:91], v[168:183]
    ds_read_b128 v[220:223], v3 offset:17408
    s_waitcnt lgkmcnt(6)
    v_mfma_f32_32x32x16_bf16 v[136:151], v[228:231], v[92:95], v[136:151]
    ds_read_b128 v[224:227], v3 offset:18432
    s_waitcnt lgkmcnt(6)
    v_mfma_f32_32x32x16_bf16 v[152:167], v[200:203], v[92:95], v[152:167]
    ds_read_b128 v[228:231], v3 offset:19456
    s_waitcnt lgkmcnt(6)
    v_mfma_f32_32x32x16_bf16 v[168:183], v[204:207], v[92:95], v[168:183]
    ds_read_b128 v[200:203], v3 offset:20480
    s_waitcnt lgkmcnt(6)
    v_mfma_f32_32x32x16_bf16 v[136:151], v[208:211], v[96:99], v[136:151]
    ds_read_b128 v[204:207], v3 offset:21504
    s_waitcnt lgkmcnt(6)
    v_mfma_f32_32x32x16_bf16 v[152:167], v[212:215], v[96:99], v[152:167]
    ds_read_b128 v[208:211], v3 offset:22528
    s_waitcnt lgkmcnt(6)
    v_mfma_f32_32x32x16_bf16 v[168:183], v[216:219], v[96:99], v[168:183]
    ds_read_b128 v[212:215], v3 offset:23552
    s_waitcnt lgkmcnt(6)
    v_mfma_f32_32x32x16_bf16 v[136:151], v[220:223], v[100:103], v[136:151]
    ds_read_b128 v[216:219], v3 offset:24576
    s_waitcnt lgkmcnt(6)
    v_mfma_f32_32x32x16_bf16 v[152:167], v[224:227], v[100:103], v[152:167]
    ds_read_b128 v[220:223], v3 offset:25600
    s_waitcnt lgkmcnt(6)
    v_mfma_f32_32x32x16_bf16 v[168:183], v[228:231], v[100:103], v[168:183]
    ds_read_b128 v[224:227], v3 offset:26624
    s_waitcnt vmcnt(0)
    s_mov_b32 s61, 0
ffn_kernels_fhl6:
    v_cmp_gt_u32 vcc, 4, v244
    s_add_u32 s61, s61, 1
    s_cmp_eq_u64 vcc, 0
    s_cbranch_scc1 ffn_kernels_fhok5
    s_cmp_ge_u32 s61, 4000
    s_cbranch_scc1 ffn_kernels_fhok5
    s_sleep 1
    buffer_load_dword v244, v245, s[8:11], s33 offen sc1
    s_waitcnt vmcnt(0)
    s_branch ffn_kernels_fhl6
ffn_kernels_fhok5:
    s_waitcnt lgkmcnt(6)
    v_mfma_f32_32x32x16_bf16 v[136:151], v[200:203], v[104:107], v[136:151]
    ds_read_b128 v[228:231], v3 offset:27648
    s_waitcnt lgkmcnt(6)
    v_mfma_f32_32x32x16_bf16 v[152:167], v[204:207], v[104:107], v[152:167]
    ds_read_b128 v[200:203], v3 offset:28672
    s_add_u32 s31, s30, 0
    buffer_load_dwordx4 v[80:83], v12, s[8:11], s31 offen offset:0 sc1
    s_waitcnt lgkmcnt(6)
    v_mfma_f32_32x32x16_bf16 v[168:183], v[208:211], v[104:107], v[168:183]
    ds_read_b128 v[204:207], v3 offset:29696
    s_add_u32 s31, s30, 0
    buffer_load_dwordx4 v[84:87], v12, s[8:11], s31 offen offset:256 sc1
    s_waitcnt lgkmcnt(6)
    v_mfma_f32_32x32x16_bf16 v[136:151], v[212:215], v[108:111], v[136:151]
    ds_read_b128 v[208:211], v3 offset:30720
    s_add_u32 s31, s30, 14336
    buffer_load_dwordx4 v[88:91], v12, s[8:11], s31 offen offset:0 sc1
    s_waitcnt lgkmcnt(6)
    v_mfma_f32_32x32x16_bf16 v[136:151], v[216:219], v[112:115], v[136:151]
    ds_read_b128 v[212:215], v3 offset:31744
    s_add_u32 s31, s30, 14336
    buffer_load_dwordx4 v[92:95], v12, s[8:11], s31 offen offset:256 sc1
    s_waitcnt lgkmcnt(6)
    v_mfma_f32_32x32x16_bf16 v[136:151], v[220:223], v[116:119], v[136:151]
    ds_read_b128 v[216:219], v3 offset:32768
    s_add_u32 s31, s30, 1024
    buffer_load_dwordx4 v[96:99], v12, s[8:11], s31 offen offset:0 sc1
    s_waitcnt lgkmcnt(6)
    v_mfma_f32_32x32x16_bf16 v[136:151], v[224:227], v[120:123], v[136:151]
    ds_read_b128 v[220:223], v3 offset:33792
    s_waitcnt lgkmcnt(6)
    v_mfma_f32_32x32x16_bf16 v[136:151], v[228:231], v[124:127], v[136:151]
    ds_read_b128 v[224:227], v3 offset:34816
    s_add_u32 s31, s30, 1024
    buffer_load_dwordx4 v[100:103], v12, s[8:11], s31 offen offset:256 sc1
    s_waitcnt lgkmcnt(6)
    v_mfma_f32_32x32x16_bf16 v[136:151], v[200:203], v[128:131], v[136:151]
    ds_read_b128 v[228:231], v3 offset:35840
    s_waitcnt lgkmcnt(6)
    v_mfma_f32_32x32x16_bf16 v[136:151], v[204:207], v[132:135], v[136:151]
    ds_read_b128 v[200:203], v3 offset:36864
    s_add_u32 s31, s30, 15360
    buffer_load_dwordx4 v[104:107], v12, s[8:11], s31 offen offset:0 sc1
    s_waitcnt lgkmcnt(6)
    v_mfma_f32_32x32x16_bf16 v[136:151], v[208:211], v[248:251], v[136:151]
    ds_read_b128 v[204:207], v3 offset:37888
    s_waitcnt lgkmcnt(6)
    v_mfma_f32_32x32x16_bf16 v[152:167], v[212:215], v[108:111], v[152:167]
    ds_read_b128 v[208:211], v3 offset:38912
    s_waitcnt lgkmcnt(6)
    v_mfma_f32_32x32x16_bf16 v[152:167], v[216:219], v[112:115], v[152:167]
    ds_read_b128 v[212:215], v3 offset:39936
    s_nop 4
    v_max_f32 v136, 0, v136
    v_max_f32 v137, 0, v137
    v_max_f32 v138, 0, v138
    v_max_f32 v139, 0, v139
    s_waitcnt lgkmcnt(6)
    v_mfma_f32_32x32x16_bf16 v[152:167], v[220:223], v[116:119], v[152:167]
    ds_read_b128 v[216:219], v3 offset:40960
    v_mul_f32 v140, v10, v140
    v_mul_f32 v141, v10, v141
    v_mul_f32 v142, v10, v142
    v_mul_f32 v143, v10, v143
    s_waitcnt lgkmcnt(6)
    v_mfma_f32_32x32x16_bf16 v[152:167], v[224:227], v[120:123], v[152:167]
    ds_read_b128 v[220:223], v3 offset:41984
    v_mul_f32 v136, v136, v140
    v_mul_f32 v137, v137, v141
    v_mul_f32 v138, v138, v142
    v_mul_f32 v139, v139, v143
    s_waitcnt lgkmcnt(6)
    v_mfma_f32_32x32x16_bf16 v[152:167], v[228:231], v[124:127], v[152:167]
    ds_read_b128 v[224:227], v3 offset:43008
    v_cvt_pk_bf16_f32 v232, v136, v137
    v_cvt_pk_bf16_f32 v233, v138, v139
    v_max_f32 v144, 0, v144
    v_max_f32 v145, 0, v145
    s_waitcnt lgkmcnt(6)
    v_mfma_f32_32x32x16_bf16 v[152:167], v[200:203], v[128:131], v[152:167]
    ds_read_b128 v[228:231], v3 offset:44032
    v_max_f32 v146, 0, v146
    v_max_f32 v147, 0, v147
    v_mul_f32 v148, v10, v148
    v_mul_f32 v149, v10, v149
    s_waitcnt lgkmcnt(6)
    v_mfma_f32_32x32x16_bf16 v[152:167], v[204:207], v[132:135], v[152:167]
    ds_read_b128 v[200:203], v3 offset:45056
    v_mul_f32 v150, v10, v150
    v_mul_f32 v151, v10, v151
    v_mul_f32 v144, v144, v148
    v_mul_f32 v145, v145, v149
    s_waitcnt lgkmcnt(6)
    v_mfma_f32_32x32x16_bf16 v[152:167], v[208:211], v[248:251], v[152:167]
    ds_read_b128 v[204:207], v3 offset:46080
    v_mul_f32 v146, v146, v150
    v_mul_f32 v147, v147, v151
    v_cvt_pk_bf16_f32 v234, v144, v145
    v_cvt_pk_bf16_f32 v235, v146, v147
    s_waitcnt lgkmcnt(6)
    v_mfma_f32_32x32x16_bf16 v[168:183], v[212:215], v[108:111], v[168:183]
    ds_read_b128 v[208:211], v3 offset:47104
    s_add_u32 s26, s36, 4096
    buffer_store_dwordx4 v[232:235], v3, s[8:11], s26 offen sc1
    s_waitcnt lgkmcnt(6)
    v_mfma_f32_32x32x16_bf16 v[168:183], v[216:219], v[112:115], v[168:183]
    v_max_f32 v152, 0, v152
    v_max_f32 v153, 0, v153
    v_max_f32 v154, 0, v154
    v_max_f32 v155, 0, v155
    s_waitcnt lgkmcnt(5)
    v_mfma_f32_32x32x16_bf16 v[168:183], v[220:223], v[116:119], v[168:183]
    v_mul_f32 v156, v10, v156
    v_mul_f32 v157, v10, v157
    v_mul_f32 v158, v10, v158
    v_mul_f32 v159, v10, v159
    s_add_u32 s31, s30, 15360
    buffer_load_dwordx4 v[108:111], v12, s[8:11], s31 offen offset:256 sc1
    s_waitcnt lgkmcnt(4)
    v_mfma_f32_32x32x16_bf16 v[168:183], v[224:227], v[120:123], v[168:183]
    v_mul_f32 v152, v152, v156
    v_mul_f32 v153, v153, v157
    v_mul_f32 v154, v154, v158
    v_mul_f32 v155, v155, v159
    s_add_u32 s31, s30, 2048
    buffer_load_dwordx4 v[112:115], v12, s[8:11], s31 offen offset:0 sc1
    s_waitcnt lgkmcnt(3)
    v_mfma_f32_32x32x16_bf16 v[168:183], v[228:231], v[124:127], v[168:183]
    v_cvt_pk_bf16_f32 v236, v152, v153
    v_cvt_pk_bf16_f32 v237, v154, v155
    v_max_f32 v160, 0, v160
    v_max_f32 v161, 0, v161
    s_add_u32 s31, s30, 2048
    buffer_load_dwordx4 v[116:119], v12, s[8:11], s31 offen offset:256 sc1
    s_waitcnt lgkmcnt(2)
    v_mfma_f32_32x32x16_bf16 v[168:183], v[200:203], v[128:131], v[168:183]
    v_max_f32 v162, 0, v162
    v_max_f32 v163, 0, v163
    v_mul_f32 v164, v10, v164
    v_mul_f32 v165, v10, v165
    s_add_u32 s31, s30, 16384
    buffer_load_dwordx4 v[120:123], v12, s[8:11], s31 offen offset:0 sc1
    s_waitcnt lgkmcnt(1)
    v_mfma_f32_32x32x16_bf16 v[168:183], v[204:207], v[132:135], v[168:183]
    v_mul_f32 v166, v10, v166
    v_mul_f32 v167, v10, v167
    v_mul_f32 v160, v160, v164
    v_mul_f32 v161, v161, v165
    s_add_u32 s31, s30, 16384
    buffer_load_dwordx4 v[124:127], v12, s[8:11], s31 offen offset:256 sc1
    s_waitcnt lgkmcnt(0)
    v_mfma_f32_32x32x16_bf16 v[168:183], v[208:211], v[248:251], v[168:183]
    v_mul_f32 v162, v162, v166
    v_mul_f32 v163, v163, v167
    v_cvt_pk_bf16_f32 v238, v160, v161
    v_cvt_pk_bf16_f32 v239, v162, v163
    s_add_u32 s26, s36, 5120
    buffer_store_dwordx4 v[236:239], v3, s[8:11], s26 offen sc1
    s_nop 5
    v_max_f32 v168, 0, v168
    v_max_f32 v169, 0, v169
    v_max_f32 v170, 0, v170
    v_max_f32 v171, 0, v171
    v_mul_f32 v172, v10, v172
    v_mul_f32 v173, v10, v173
    v_mul_f32 v174, v10, v174
    v_mul_f32 v175, v10, v175
    v_mul_f32 v168, v168, v172
    v_mul_f32 v169, v169, v173
    v_mul_f32 v170, v170, v174
    v_mul_f32 v171, v171, v175
    v_cvt_pk_bf16_f32 v232, v168, v169
    v_cvt_pk_bf16_f32 v233, v170, v171
    v_max_f32 v176, 0, v176
    v_max_f32 v177, 0, v177
    v_max_f32 v178, 0, v178
    v_max_f32 v179, 0, v179
    v_mul_f32 v180, v10, v180
    v_mul_f32 v181, v10, v181
    v_mul_f32 v182, v10, v182
    v_mul_f32 v183, v10, v183
    v_mul_f32 v176, v176, v180
    v_mul_f32 v177, v177, v181
    v_mul_f32 v178, v178, v182
    v_mul_f32 v179, v179, v183
    v_cvt_pk_bf16_f32 v234, v176, v177
    v_cvt_pk_bf16_f32 v235, v178, v179
    s_add_u32 s26, s36, 6144
    buffer_store_dwordx4 v[232:235], v3, s[8:11], s26 offen sc1
    s_waitcnt vmcnt(14)
    v_mfma_f32_16x16x32_bf16 v[200:203], a[0:3], v[80:83], 0
    s_waitcnt vmcnt(13)
    v_mfma_f32_16x16x32_bf16 v[204:207], a[0:3], v[84:87], 0
    s_add_u32 s29, s25, 57344
    buffer_load_dwordx4 v[128:131], v3, s[8:11], s29 offen
    v_mfma_f32_16x16x32_bf16 v[208:211], a[4:7], v[80:83], 0
    v_mfma_f32_16x16x32_bf16 v[212:215], a[4:7], v[84:87], 0
    v_mfma_f32_16x16x32_bf16 v[216:219], a[8:11], v[80:83], 0
    v_mfma_f32_16x16x32_bf16 v[220:223], a[8:11], v[84:87], 0
    s_add_u32 s29, s25, 58368
    buffer_load_dwordx4 v[132:135], v3, s[8:11], s29 offen
    v_mfma_f32_16x16x32_bf16 v[224:227], a[12:15], v[80:83], 0
    v_mfma_f32_16x16x32_bf16 v[228:231], a[12:15], v[84:87], 0
    v_mfma_f32_16x16x32_bf16 v[184:187], a[16:19], v[80:83], 0
    v_mfma_f32_16x16x32_bf16 v[188:191], a[16:19], v[84:87], 0
    s_add_u32 s29, s25, 59392
    buffer_load_dwordx4 v[136:139], v3, s[8:11], s29 offen
    v_mfma_f32_16x16x32_bf16 v[192:195], a[20:23], v[80:83], 0
    v_mfma_f32_16x16x32_bf16 v[196:199], a[20:23], v[84:87], 0
    v_mfma_f32_16x16x32_bf16 v[248:251], a[24:27], v[80:83], 0
    v_mfma_f32_16x16x32_bf16 v[252:255], a[24:27], v[84:87], 0
    s_add_u32 s29, s25, 60416
    buffer_load_dwordx4 v[140:143], v3, s[8:11], s29 offen
    s_waitcnt vmcnt(16)
    v_mfma_f32_16x16x32_bf16 v[200:203], a[28:31], v[88:91], v[200:203]
    s_waitcnt vmcnt(15)
    v_mfma_f32_16x16x32_bf16 v[204:207], a[28:31], v[92:95], v[204:207]
    v_mfma_f32_16x16x32_bf16 v[208:211], a[32:35], v[88:91], v[208:211]
    v_mfma_f32_16x16x32_bf16 v[212:215], a[32:35], v[92:95], v[212:215]
    s_add_u32 s29, s25, 61440
    buffer_load_dwordx4 v[144:147], v3, s[8:11], s29 offen
    v_mfma_f32_16x16x32_bf16 v[216:219], a[36:39], v[88:91], v[216:219]
    v_mfma_f32_16x16x32_bf16 v[220:223], a[36:39], v[92:95], v[220:223]
    v_mfma_f32_16x16x32_bf16 v[224:227], a[40:43], v[88:91], v[224:227]
    v_mfma_f32_16x16x32_bf16 v[228:231], a[40:43], v[92:95], v[228:231]
    s_add_u32 s29, s25, 62464
    buffer_load_dwordx4 v[148:151], v3, s[8:11], s29 offen
    v_mfma_f32_16x16x32_bf16 v[184:187], a[44:47], v[88:91], v[184:187]
    v_mfma_f32_16x16x32_bf16 v[188:191], a[44:47], v[92:95], v[188:191]
    v_mfma_f32_16x16x32_bf16 v[192:195], a[48:51], v[88:91], v[192:195]
    v_mfma_f32_16x16x32_bf16 v[196:199], a[48:51], v[92:95], v[196:199]
    s_add_u32 s29, s25, 63488
    buffer_load_dwordx4 v[152:155], v3, s[8:11], s29 offen
    v_mfma_f32_16x16x32_bf16 v[248:251], a[52:55], v[88:91], v[248:251]
    v_mfma_f32_16x16x32_bf16 v[252:255], a[52:55], v[92:95], v[252:255]
    s_waitcnt vmcnt(7)
    v_mov_b32 v14, 7
    v_mov_b32 v13, 0
    s_add_u32 s35, s34, 0
    s_mov_b64 exec, 1
    buffer_store_dword v14, v13, s[8:11], s35 offen sc1
    s_mov_b64 exec, -1
    v_mfma_f32_16x16x32_bf16 v[200:203], a[56:59], v[96:99], v[200:203]
    v_mfma_f32_16x16x32_bf16 v[204:207], a[56:59], v[100:103], v[204:207]
    s_add_u32 s31, s30, 3072
    buffer_load_dwordx4 v[156:159], v12, s[8:11], s31 offen offset:0 sc1
    v_mfma_f32_16x16x32_bf16 v[208:211], a[60:63], v[96:99], v[208:211]
    v_mfma_f32_16x16x32_bf16 v[212:215], a[60:63], v[100:103], v[212:215]
    v_mfma_f32_16x16x32_bf16 v[216:219], a[64:67], v[96:99], v[216:219]
    v_mfma_f32_16x16x32_bf16 v[220:223], a[64:67], v[100:103], v[220:223]
    s_add_u32 s31, s30, 3072
    buffer_load_dwordx4 v[160:163], v12, s[8:11], s31 offen offset:256 sc1
    v_mfma_f32_16x16x32_bf16 v[224:227], a[68:71], v[96:99], v[224:227]
    v_mfma_f32_16x16x32_bf16 v[228:231], a[68:71], v[100:103], v[228:231]
    s_add_u32 s33, s32, 0
    v_and_b32 v245, 3, v2
    v_lshlrev_b32 v245, 8, v245
    buffer_load_dword v244, v245, s[8:11], s33 offen sc1
    v_mfma_f32_16x16x32_bf16 v[184:187], a[72:75], v[96:99], v[184:187]
    v_mfma_f32_16x16x32_bf16 v[188:191], a[72:75], v[100:103], v[188:191]
    s_add_u32 s31, s30, 17408
    buffer_load_dwordx4 v[164:167], v12, s[8:11], s31 offen offset:0 sc1
    v_mfma_f32_16x16x32_bf16 v[192:195], a[76:79], v[96:99], v[192:195]
    v_mfma_f32_16x16x32_bf16 v[196:199], a[76:79], v[100:103], v[196:199]
    v_mfma_f32_16x16x32_bf16 v[248:251], a[80:83], v[96:99], v[248:251]
    v_mfma_f32_16x16x32_bf16 v[252:255], a[80:83], v[100:103], v[252:255]
    s_add_u32 s31, s30, 17408
    buffer_load_dwordx4 v[168:171], v12, s[8:11], s31 offen offset:256 sc1
    v_mfma_f32_16x16x32_bf16 v[200:203], a[84:87], v[104:107], v[200:203]
    v_mfma_f32_16x16x32_bf16 v[204:207], a[84:87], v[108:111], v[204:207]
    v_mfma_f32_16x16x32_bf16 v[208:211], a[88:91], v[104:107], v[208:211]
    v_mfma_f32_16x16x32_bf16 v[212:215], a[88:91], v[108:111], v[212:215]
    s_add_u32 s29, s25, 71680
    buffer_load_dwordx4 v[172:175], v3, s[8:11], s29 offen
    v_mfma_f32_16x16x32_bf16 v[216:219], a[92:95], v[104:107], v[216:219]
    v_mfma_f32_16x16x32_bf16 v[220:223], a[92:95], v[108:111], v[220:223]
    v_mfma_f32_16x16x32_bf16 v[224:227], a[96:99], v[104:107], v[224:227]
    v_mfma_f32_16x16x32_bf16 v[228:231], a[96:99], v[108:111], v[228:231]
    s_add_u32 s29, s25, 72704
    buffer_load_dwordx4 v[176:179], v3, s[8:11], s29 offen
    v_mfma_f32_16x16x32_bf16 v[184:187], a[100:103], v[104:107], v[184:187]
    v_mfma_f32_16x16x32_bf16 v[188:191], a[100:103], v[108:111], v[188:191]
    v_mfma_f32_16x16x32_bf16 v[192:195], a[104:107], v[104:107], v[192:195]
    v_mfma_f32_16x16x32_bf16 v[196:199], a[104:107], v[108:111], v[196:199]
    s_add_u32 s29, s25, 73728
    buffer_load_dwordx4 v[180:183], v3, s[8:11], s29 offen
    v_mfma_f32_16x16x32_bf16 v[248:251], a[108:111], v[104:107], v[248:251]
    v_mfma_f32_16x16x32_bf16 v[252:255], a[108:111], v[108:111], v[252:255]
    s_waitcnt vmcnt(5)
    s_mov_b32 s61, 0
ffn_kernels_fhl8:
    v_cmp_gt_u32 vcc, 7, v244
    s_add_u32 s61, s61, 1
    s_cmp_eq_u64 vcc, 0
    s_cbranch_scc1 ffn_kernels_fhok7
    s_cmp_ge_u32 s61, 4000
    s_cbranch_scc1 ffn_kernels_fhok7
    s_sleep 1
    buffer_load_dword v244, v245, s[8:11], s33 offen sc1
    s_waitcnt vmcnt(0)
    s_branch ffn_kernels_fhl8
ffn_kernels_fhok7:
    v_mfma_f32_16x16x32_bf16 v[200:203], v[24:27], v[112:115], v[200:203]
    v_mfma_f32_16x16x32_bf16 v[204:207], v[24:27], v[116:119], v[204:207]
    s_add_u32 s29, s25, 74752
    buffer_load_dwordx4 v[80:83], v3, s[8:11], s29 offen
    v_mfma_f32_16x16x32_bf16 v[208:211], v[28:31], v[112:115], v[208:211]
    v_mfma_f32_16x16x32_bf16 v[212:215], v[28:31], v[116:119], v[212:215]
    v_mfma_f32_16x16x32_bf16 v[216:219], v[32:35], v[112:115], v[216:219]
    v_mfma_f32_16x16x32_bf16 v[220:223], v[32:35], v[116:119], v[220:223]
    s_add_u32 s29, s25, 75776
    buffer_load_dwordx4 v[84:87], v3, s[8:11], s29 offen
    v_mfma_f32_16x16x32_bf16 v[224:227], v[36:39], v[112:115], v[224:227]
    v_mfma_f32_16x16x32_bf16 v[228:231], v[36:39], v[116:119], v[228:231]
    v_mfma_f32_16x16x32_bf16 v[184:187], v[40:43], v[112:115], v[184:187]
    s_add_u32 s31, s30, 4096
    buffer_load_dwordx4 v[96:99], v12, s[8:11], s31 offen offset:0 sc1
    v_mfma_f32_16x16x32_bf16 v[188:191], v[40:43], v[116:119], v[188:191]
    s_add_u32 s31, s30, 4096
    buffer_load_dwordx4 v[100:103], v12, s[8:11], s31 offen offset:256 sc1
    v_mfma_f32_16x16x32_bf16 v[192:195], v[44:47], v[112:115], v[192:195]
    v_mfma_f32_16x16x32_bf16 v[196:199], v[44:47], v[116:119], v[196:199]
    v_mfma_f32_16x16x32_bf16 v[248:251], v[48:51], v[112:115], v[248:251]
    v_mfma_f32_16x16x32_bf16 v[252:255], v[48:51], v[116:119], v[252:255]
    s_add_u32 s29, s25, 76800
    buffer_load_dwordx4 v[88:91], v3, s[8:11], s29 offen
    v_mfma_f32_16x16x32_bf16 v[200:203], a[112:115], v[120:123], v[200:203]
    v_mfma_f32_16x16x32_bf16 v[204:207], a[112:115], v[124:127], v[204:207]
    v_mfma_f32_16x16x32_bf16 v[208:211], a[116:119], v[120:123], v[208:211]
    v_mfma_f32_16x16x32_bf16 v[212:215], a[116:119], v[124:127], v[212:215]
    s_add_u32 s29, s25, 77824
    buffer_load_dwordx4 v[92:95], v3, s[8:11], s29 offen
    v_mfma_f32_16x16x32_bf16 v[216:219], a[120:123], v[120:123], v[216:219]
    v_mfma_f32_16x16x32_bf16 v[220:223], a[120:123], v[124:127], v[220:223]
    v_mfma_f32_16x16x32_bf16 v[224:227], a[124:127], v[120:123], v[224:227]
    v_mfma_f32_16x16x32_bf16 v[228:231], a[124:127], v[124:127], v[228:231]
    s_add_u32 s31, s30, 18432
    buffer_load_dwordx4 v[104:107], v12, s[8:11], s31 offen offset:0 sc1
    v_mfma_f32_16x16x32_bf16 v[184:187], a[128:131], v[120:123], v[184:187]
    v_mfma_f32_16x16x32_bf16 v[188:191], a[128:131], v[124:127], v[188:191]
    s_add_u32 s31, s30, 18432
    buffer_load_dwordx4 v[108:111], v12, s[8:11], s31 offen offset:256 sc1
    v_mfma_f32_16x16x32_bf16 v[192:195], a[132:135], v[120:123], v[192:195]
    v_mfma_f32_16x16x32_bf16 v[196:199], a[132:135], v[124:127], v[196:199]
    v_mfma_f32_16x16x32_bf16 v[248:251], a[136:139], v[120:123], v[248:251]
    v_mfma_f32_16x16x32_bf16 v[252:255], a[136:139], v[124:127], v[252:255]
    s_add_u32 s31, s30, 5120
    buffer_load_dwordx4 v[24:27], v12, s[8:11], s31 offen offset:0 sc1
    v_mfma_f32_16x16x32_bf16 v[200:203], v[52:55], v[156:159], v[200:203]
    v_mfma_f32_16x16x32_bf16 v[204:207], v[52:55], v[160:163], v[204:207]
    v_mfma_f32_16x16x32_bf16 v[208:211], v[56:59], v[156:159], v[208:211]
    v_mfma_f32_16x16x32_bf16 v[212:215], v[56:59], v[160:163], v[212:215]
    s_add_u32 s31, s30, 5120
    buffer_load_dwordx4 v[28:31], v12, s[8:11], s31 offen offset:256 sc1
    v_mfma_f32_16x16x32_bf16 v[216:219], v[60:63], v[156:159], v[216:219]
    v_mfma_f32_16x16x32_bf16 v[220:223], v[60:63], v[160:163], v[220:223]
    v_mfma_f32_16x16x32_bf16 v[224:227], v[64:67], v[156:159], v[224:227]
    v_mfma_f32_16x16x32_bf16 v[228:231], v[64:67], v[160:163], v[228:231]
    s_add_u32 s29, s25, 93184
    buffer_load_dwordx4 v[32:35], v3, s[8:11], s29 offen
    v_mfma_f32_16x16x32_bf16 v[184:187], v[68:71], v[156:159], v[184:187]
    v_mfma_f32_16x16x32_bf16 v[188:191], v[68:71], v[160:163], v[188:191]
    v_mfma_f32_16x16x32_bf16 v[192:195], v[72:75], v[156:159], v[192:195]
    v_mfma_f32_16x16x32_bf16 v[196:199], v[72:75], v[160:163], v[196:199]
    s_add_u32 s29, s25, 94208
    buffer_load_dwordx4 v[36:39], v3, s[8:11], s29 offen
    v_mfma_f32_16x16x32_bf16 v[248:251], v[76:79], v[156:159], v[248:251]
    v_mfma_f32_16x16x32_bf16 v[252:255], v[76:79], v[160:163], v[252:255]
    s_waitcnt vmcnt(16)
    v_mfma_f32_16x16x32_bf16 v[200:203], a[140:143], v[164:167], v[200:203]
    s_waitcnt vmcnt(15)
    v_mfma_f32_16x16x32_bf16 v[204:207], a[140:143], v[168:171], v[204:207]
    s_add_u32 s29, s25, 95232
    buffer_load_dwordx4 v[40:43], v3, s[8:11], s29 offen
    v_mfma_f32_16x16x32_bf16 v[208:211], a[144:147], v[164:167], v[208:211]
    v_mfma_f32_16x16x32_bf16 v[212:215], a[144:147], v[168:171], v[212:215]
    v_mfma_f32_16x16x32_bf16 v[216:219], a[148:151], v[164:167], v[216:219]
    v_mfma_f32_16x16x32_bf16 v[220:223], a[148:151], v[168:171], v[220:223]
    s_add_u32 s29, s25, 96256
    buffer_load_dwordx4 v[44:47], v3, s[8:11], s29 offen
    v_mfma_f32_16x16x32_bf16 v[224:227], a[152:155], v[164:167], v[224:227]
    v_mfma_f32_16x16x32_bf16 v[228:231], a[152:155], v[168:171], v[228:231]
    v_mfma_f32_16x16x32_bf16 v[184:187], a[156:159], v[164:167], v[184:187]
    s_add_u32 s31, s30, 19456
    buffer_load_dwordx4 v[120:123], v12, s[8:11], s31 offen offset:0 sc1
    v_mfma_f32_16x16x32_bf16 v[188:191], a[156:159], v[168:171], v[188:191]
    s_add_u32 s31, s30, 19456
    buffer_load_dwordx4 v[124:127], v12, s[8:11], s31 offen offset:256 sc1
    v_mfma_f32_16x16x32_bf16 v[192:195], a[160:163], v[164:167], v[192:195]
    s_add_u32 s31, s30, 6144
    buffer_load_dwordx4 v[52:55], v12, s[8:11], s31 offen offset:0 sc1
    v_mfma_f32_16x16x32_bf16 v[196:199], a[160:163], v[168:171], v[196:199]
    s_add_u32 s31, s30, 6144
    buffer_load_dwordx4 v[56:59], v12, s[8:11], s31 offen offset:256 sc1
    v_mfma_f32_16x16x32_bf16 v[248:251], a[164:167], v[164:167], v[248:251]
    s_add_u32 s31, s30, 20480
    buffer_load_dwordx4 v[60:63], v12, s[8:11], s31 offen offset:0 sc1
    v_mfma_f32_16x16x32_bf16 v[252:255], a[164:167], v[168:171], v[252:255]
    s_add_u32 s31, s30, 20480
    buffer_load_dwordx4 v[64:67], v12, s[8:11], s31 offen offset:256 sc1
    s_barrier
    s_waitcnt vmcnt(17)
    v_mfma_f32_16x16x32_bf16 v[200:203], v[128:131], v[96:99], v[200:203]
    s_waitcnt vmcnt(16)
    v_mfma_f32_16x16x32_bf16 v[204:207], v[128:131], v[100:103], v[204:207]
    v_mfma_f32_16x16x32_bf16 v[208:211], v[132:135], v[96:99], v[208:211]
    v_mfma_f32_16x16x32_bf16 v[212:215], v[132:135], v[100:103], v[212:215]
    s_add_u32 s29, s25, 97280
    buffer_load_dwordx4 v[48:51], v3, s[8:11], s29 offen
    v_mfma_f32_16x16x32_bf16 v[216:219], v[136:139], v[96:99], v[216:219]
    v_mfma_f32_16x16x32_bf16 v[220:223], v[136:139], v[100:103], v[220:223]
    v_mfma_f32_16x16x32_bf16 v[224:227], v[140:143], v[96:99], v[224:227]
    v_mfma_f32_16x16x32_bf16 v[228:231], v[140:143], v[100:103], v[228:231]
    s_add_u32 s29, s25, 98304
    buffer_load_dwordx4 v[112:115], v3, s[8:11], s29 offen
    v_mfma_f32_16x16x32_bf16 v[184:187], v[144:147], v[96:99], v[184:187]
    v_mfma_f32_16x16x32_bf16 v[188:191], v[144:147], v[100:103], v[188:191]
    v_mfma_f32_16x16x32_bf16 v[192:195], v[148:151], v[96:99], v[192:195]
    v_mfma_f32_16x16x32_bf16 v[196:199], v[148:151], v[100:103], v[196:199]
    s_add_u32 s29, s25, 99328
    buffer_load_dwordx4 v[116:119], v3, s[8:11], s29 offen
    v_mfma_f32_16x16x32_bf16 v[248:251], v[152:155], v[96:99], v[248:251]
    v_mfma_f32_16x16x32_bf16 v[252:255], v[152:155], v[100:103], v[252:255]
    s_waitcnt vmcnt(16)
    v_mfma_f32_16x16x32_bf16 v[200:203], a[168:171], v[104:107], v[200:203]
    s_waitcnt vmcnt(15)
    v_mfma_f32_16x16x32_bf16 v[204:207], a[168:171], v[108:111], v[204:207]
    s_add_u32 s26, s37, 6291456
    v_lshlrev_b32 v13, 4, v0
    buffer_load_dwordx4 v[68:71], v13, s[8:11], s26 offen sc1
    v_mfma_f32_16x16x32_bf16 v[208:211], a[172:175], v[104:107], v[208:211]
    s_add_u32 s26, s37, 6295552
    v_lshlrev_b32 v13, 4, v0
    v_mov_b32 v14, 2147483648
    v_cmp_gt_u32 vcc, 192, v0
    s_nop 1
    v_cndmask_b32 v13, v14, v13, vcc
    buffer_load_dwordx4 v[72:75], v13, s[8:11], s26 offen sc1
    v_mfma_f32_16x16x32_bf16 v[212:215], a[172:175], v[108:111], v[212:215]
    v_mfma_f32_16x16x32_bf16 v[216:219], a[176:179], v[104:107], v[216:219]
    v_mfma_f32_16x16x32_bf16 v[220:223], a[176:179], v[108:111], v[220:223]
    v_mfma_f32_16x16x32_bf16 v[224:227], a[180:183], v[104:107], v[224:227]
    v_mfma_f32_16x16x32_bf16 v[228:231], a[180:183], v[108:111], v[228:231]
    v_mfma_f32_16x16x32_bf16 v[184:187], a[184:187], v[104:107], v[184:187]
    v_mfma_f32_16x16x32_bf16 v[188:191], a[184:187], v[108:111], v[188:191]
    v_mfma_f32_16x16x32_bf16 v[192:195], a[188:191], v[104:107], v[192:195]
    v_mfma_f32_16x16x32_bf16 v[196:199], a[188:191], v[108:111], v[196:199]
    v_mfma_f32_16x16x32_bf16 v[248:251], a[192:195], v[104:107], v[248:251]
    v_mfma_f32_16x16x32_bf16 v[252:255], a[192:195], v[108:111], v[252:255]
    s_waitcnt vmcnt(16)
    v_mfma_f32_16x16x32_bf16 v[200:203], v[172:175], v[24:27], v[200:203]
    s_waitcnt vmcnt(15)
    v_mfma_f32_16x16x32_bf16 v[204:207], v[172:175], v[28:31], v[204:207]
    v_mfma_f32_16x16x32_bf16 v[208:211], v[176:179], v[24:27], v[208:211]
    v_mfma_f32_16x16x32_bf16 v[212:215], v[176:179], v[28:31], v[212:215]
    v_mfma_f32_16x16x32_bf16 v[216:219], v[180:183], v[24:27], v[216:219]
    v_mfma_f32_16x16x32_bf16 v[220:223], v[180:183], v[28:31], v[220:223]
    v_mfma_f32_16x16x32_bf16 v[224:227], v[80:83], v[24:27], v[224:227]
    v_mfma_f32_16x16x32_bf16 v[228:231], v[80:83], v[28:31], v[228:231]
    v_mfma_f32_16x16x32_bf16 v[184:187], v[84:87], v[24:27], v[184:187]
    v_mfma_f32_16x16x32_bf16 v[188:191], v[84:87], v[28:31], v[188:191]
    v_mfma_f32_16x16x32_bf16 v[192:195], v[88:91], v[24:27], v[192:195]
    v_mfma_f32_16x16x32_bf16 v[196:199], v[88:91], v[28:31], v[196:199]
    v_mfma_f32_16x16x32_bf16 v[248:251], v[92:95], v[24:27], v[248:251]
    v_mfma_f32_16x16x32_bf16 v[252:255], v[92:95], v[28:31], v[252:255]
    s_waitcnt vmcnt(10)
    v_mfma_f32_16x16x32_bf16 v[200:203], a[196:199], v[120:123], v[200:203]
    s_mul_i32 s26, s3, 14336
    v_add_u32 v6, s26, v3
    s_waitcnt vmcnt(9)
    v_mfma_f32_16x16x32_bf16 v[204:207], a[196:199], v[124:127], v[204:207]
    s_waitcnt vmcnt(8)
    v_mfma_f32_16x16x32_bf16 v[200:203], a[224:227], v[52:55], v[200:203]
    s_waitcnt vmcnt(7)
    v_mfma_f32_16x16x32_bf16 v[204:207], a[224:227], v[56:59], v[204:207]
    s_waitcnt vmcnt(6)
    v_mfma_f32_16x16x32_bf16 v[200:203], v[32:35], v[60:63], v[200:203]
    s_waitcnt vmcnt(5)
    v_mfma_f32_16x16x32_bf16 v[204:207], v[32:35], v[64:67], v[204:207]
    v_mfma_f32_16x16x32_bf16 v[208:211], a[200:203], v[120:123], v[208:211]
    v_mfma_f32_16x16x32_bf16 v[212:215], a[200:203], v[124:127], v[212:215]
    v_mfma_f32_16x16x32_bf16 v[208:211], a[228:231], v[52:55], v[208:211]
    s_nop 2
    ds_write_b128 v6, v[200:203] offset:0
    v_mfma_f32_16x16x32_bf16 v[212:215], a[228:231], v[56:59], v[212:215]
    ds_write_b128 v6, v[204:207] offset:1024
    v_mfma_f32_16x16x32_bf16 v[208:211], v[36:39], v[60:63], v[208:211]
    v_mfma_f32_16x16x32_bf16 v[212:215], v[36:39], v[64:67], v[212:215]
    v_mfma_f32_16x16x32_bf16 v[216:219], a[204:207], v[120:123], v[216:219]
    v_mfma_f32_16x16x32_bf16 v[220:223], a[204:207], v[124:127], v[220:223]
    v_mfma_f32_16x16x32_bf16 v[216:219], a[232:235], v[52:55], v[216:219]
    s_nop 3
    ds_write_b128 v6, v[208:211] offset:2048
    v_mfma_f32_16x16x32_bf16 v[220:223], a[232:235], v[56:59], v[220:223]
    ds_write_b128 v6, v[212:215] offset:3072
    v_mfma_f32_16x16x32_bf16 v[216:219], v[40:43], v[60:63], v[216:219]
    v_mfma_f32_16x16x32_bf16 v[220:223], v[40:43], v[64:67], v[220:223]
    v_mfma_f32_16x16x32_bf16 v[224:227], a[208:211], v[120:123], v[224:227]
    v_mfma_f32_16x16x32_bf16 v[228:231], a[208:211], v[124:127], v[228:231]
    v_mfma_f32_16x16x32_bf16 v[224:227], a[236:239], v[52:55], v[224:227]
    s_nop 3
    ds_write_b128 v6, v[216:219] offset:4096
    v_mfma_f32_16x16x32_bf16 v[228:231], a[236:239], v[56:59], v[228:231]
    ds_write_b128 v6, v[220:223] offset:5120
    v_mfma_f32_16x16x32_bf16 v[224:227], v[44:47], v[60:63], v[224:227]
    v_mfma_f32_16x16x32_bf16 v[228:231], v[44:47], v[64:67], v[228:231]
    v_mfma_f32_16x16x32_bf16 v[184:187], a[212:215], v[120:123], v[184:187]
    v_mfma_f32_16x16x32_bf16 v[188:191], a[212:215], v[124:127], v[188:191]
    v_mfma_f32_16x16x32_bf16 v[184:187], a[240:243], v[52:55], v[184:187]
    s_nop 3
    ds_write_b128 v6, v[224:227] offset:6144
    v_mfma_f32_16x16x32_bf16 v[188:191], a[240:243], v[56:59], v[188:191]
    ds_write_b128 v6, v[228:231] offset:7168
    s_waitcnt vmcnt(4)
    v_mfma_f32_16x16x32_bf16 v[184:187], v[48:51], v[60:63], v[184:187]
    v_mfma_f32_16x16x32_bf16 v[188:191], v[48:51], v[64:67], v[188:191]
    v_mfma_f32_16x16x32_bf16 v[192:195], a[216:219], v[120:123], v[192:195]
    v_mfma_f32_16x16x32_bf16 v[196:199], a[216:219], v[124:127], v[196:199]
    v_mfma_f32_16x16x32_bf16 v[192:195], a[244:247], v[52:55], v[192:195]
    s_nop 3
    ds_write_b128 v6, v[184:187] offset:8192
    v_mfma_f32_16x16x32_bf16 v[196:199], a[244:247], v[56:59], v[196:199]
    ds_write_b128 v6, v[188:191] offset:9216
    s_waitcnt vmcnt(3)
    v_mfma_f32_16x16x32_bf16 v[192:195], v[112:115], v[60:63], v[192:195]
    v_mfma_f32_16x16x32_bf16 v[196:199], v[112:115], v[64:67], v[196:199]
    v_mfma_f32_16x16x32_bf16 v[248:251], a[220:223], v[120:123], v[248:251]
    v_mfma_f32_16x16x32_bf16 v[252:255], a[220:223], v[124:127], v[252:255]
    v_mfma_f32_16x16x32_bf16 v[248:251], a[248:251], v[52:55], v[248:251]
    s_nop 3
    ds_write_b128 v6, v[192:195] offset:10240
    v_mfma_f32_16x16x32_bf16 v[252:255], a[248:251], v[56:59], v[252:255]
    ds_write_b128 v6, v[196:199] offset:11264
    s_waitcnt vmcnt(2)
    v_mfma_f32_16x16x32_bf16 v[248:251], v[116:119], v[60:63], v[248:251]
    v_mfma_f32_16x16x32_bf16 v[252:255], v[116:119], v[64:67], v[252:255]
    v_mov_b32 v13, v6
    v_lshlrev_b32 v6, 4, v0
    v_add_u32 v7, 4096, v6
    v_cmp_gt_u32 vcc, 192, v0
    v_mov_b32 v8, 2147483648
    s_nop 0
    v_cndmask_b32 v7, v8, v7, vcc
    v_and_b32 v9, 15, v2
    v_bfe_u32 v14, v2, 4, 1
    v_lshl_add_u32 v14, v1, 1, v14
    v_lshlrev_b32 v14, 10, v14
    v_lshrrev_b32 v15, 5, v2
    v_lshl_add_u32 v14, v15, 9, v14
    v_lshl_add_u32 v14, v9, 4, v14
    ds_write_b128 v13, v[248:251] offset:12288
    ds_write_b128 v13, v[252:255] offset:13312
    s_waitcnt lgkmcnt(0)
    s_barrier
    ds_read_b128 v[76:79], v14 offset:0
    ds_read_b128 v[80:83], v14 offset:256
    ds_read_b128 v[84:87], v14 offset:14336
    ds_read_b128 v[88:91], v14 offset:14592
    ds_read_b128 v[92:95], v14 offset:28672
    ds_read_b128 v[96:99], v14 offset:28928
    ds_read_b128 v[100:103], v14 offset:43008
    ds_read_b128 v[104:107], v14 offset:43264
    ds_read_b128 v[108:111], v14 offset:8192
    ds_read_b128 v[112:115], v14 offset:8448
    ds_read_b128 v[116:119], v14 offset:22528
    ds_read_b128 v[120:123], v14 offset:22784
    ds_read_b128 v[124:127], v14 offset:36864
    ds_read_b128 v[128:131], v14 offset:37120
    ds_read_b128 v[132:135], v14 offset:51200
    ds_read_b128 v[136:139], v14 offset:51456
    s_waitcnt vmcnt(0)
    s_waitcnt lgkmcnt(8)
    v_pk_add_f32 v[76:77], v[76:77], v[84:85]
    v_pk_add_f32 v[92:93], v[92:93], v[100:101]
    v_pk_add_f32 v[78:79], v[78:79], v[86:87]
    v_pk_add_f32 v[94:95], v[94:95], v[102:103]
    v_pk_add_f32 v[80:81], v[80:81], v[88:89]
    v_pk_add_f32 v[96:97], v[96:97], v[104:105]
    v_pk_add_f32 v[82:83], v[82:83], v[90:91]
    v_pk_add_f32 v[98:99], v[98:99], v[106:107]
    v_pk_add_f32 v[76:77], v[76:77], v[92:93]
    v_pk_add_f32 v[78:79], v[78:79], v[94:95]
    v_pk_add_f32 v[80:81], v[80:81], v[96:97]
    v_pk_add_f32 v[82:83], v[82:83], v[98:99]
    v_cvt_pk_bf16_f32 v84, v76, v77
    v_cvt_pk_bf16_f32 v85, v78, v79
    v_cvt_pk_bf16_f32 v86, v80, v81
    v_cvt_pk_bf16_f32 v87, v82, v83
    v_lshlrev_b32 v76, 16, v84
    v_and_b32 v77, 0xffff0000, v84
    v_lshlrev_b32 v92, 16, v16
    v_and_b32 v93, 0xffff0000, v16
    v_lshlrev_b32 v78, 16, v85
    v_and_b32 v79, 0xffff0000, v85
    v_lshlrev_b32 v94, 16, v17
    v_and_b32 v95, 0xffff0000, v17
    v_lshlrev_b32 v80, 16, v86
    v_and_b32 v81, 0xffff0000, v86
    v_lshlrev_b32 v96, 16, v18
    v_and_b32 v97, 0xffff0000, v18
    v_lshlrev_b32 v82, 16, v87
    v_and_b32 v83, 0xffff0000, v87
    v_lshlrev_b32 v98, 16, v19
    v_and_b32 v99, 0xffff0000, v19
    v_pk_add_f32 v[76:77], v[76:77], v[92:93]
    v_pk_add_f32 v[78:79], v[78:79], v[94:95]
    v_pk_add_f32 v[80:81], v[80:81], v[96:97]
    v_pk_add_f32 v[82:83], v[82:83], v[98:99]
    v_cvt_pk_bf16_f32 v16, v76, v77
    v_cvt_pk_bf16_f32 v17, v78, v79
    v_cvt_pk_bf16_f32 v18, v80, v81
    v_cvt_pk_bf16_f32 v19, v82, v83
    s_waitcnt lgkmcnt(0)
    v_pk_add_f32 v[108:109], v[108:109], v[116:117]
    v_pk_add_f32 v[124:125], v[124:125], v[132:133]
    v_pk_add_f32 v[110:111], v[110:111], v[118:119]
    v_pk_add_f32 v[126:127], v[126:127], v[134:135]
    v_pk_add_f32 v[112:113], v[112:113], v[120:121]
    v_pk_add_f32 v[128:129], v[128:129], v[136:137]
    v_pk_add_f32 v[114:115], v[114:115], v[122:123]
    v_pk_add_f32 v[130:131], v[130:131], v[138:139]
    v_pk_add_f32 v[108:109], v[108:109], v[124:125]
    v_pk_add_f32 v[110:111], v[110:111], v[126:127]
    v_pk_add_f32 v[112:113], v[112:113], v[128:129]
    v_pk_add_f32 v[114:115], v[114:115], v[130:131]
    v_cvt_pk_bf16_f32 v116, v108, v109
    v_cvt_pk_bf16_f32 v117, v110, v111
    v_cvt_pk_bf16_f32 v118, v112, v113
    v_cvt_pk_bf16_f32 v119, v114, v115
    v_lshlrev_b32 v108, 16, v116
    v_and_b32 v109, 0xffff0000, v116
    v_lshlrev_b32 v124, 16, v20
    v_and_b32 v125, 0xffff0000, v20
    v_lshlrev_b32 v110, 16, v117
    v_and_b32 v111, 0xffff0000, v117
    v_lshlrev_b32 v126, 16, v21
    v_and_b32 v127, 0xffff0000, v21
    v_lshlrev_b32 v112, 16, v118
    v_and_b32 v113, 0xffff0000, v118
    v_lshlrev_b32 v128, 16, v22
    v_and_b32 v129, 0xffff0000, v22
    v_lshlrev_b32 v114, 16, v119
    v_and_b32 v115, 0xffff0000, v119
    v_lshlrev_b32 v130, 16, v23
    v_and_b32 v131, 0xffff0000, v23
    v_pk_add_f32 v[108:109], v[108:109], v[124:125]
    v_pk_add_f32 v[110:111], v[110:111], v[126:127]
    v_pk_add_f32 v[112:113], v[112:113], v[128:129]
    v_pk_add_f32 v[114:115], v[114:115], v[130:131]
    v_cvt_pk_bf16_f32 v20, v108, v109
    v_cvt_pk_bf16_f32 v21, v110, v111
    v_cvt_pk_bf16_f32 v22, v112, v113
    v_cvt_pk_bf16_f32 v23, v114, v115
    v_and_b32 v11, 31, v2
    v_lshlrev_b32 v11, 3, v11
    v_lshrrev_b32 v15, 5, v2
    v_lshl_add_u32 v10, v15, 11, v11
    v_mov_b32 v8, 0
    v_mov_b32 v9, 0
    s_mov_b32 s27, 0x3f803f80
    v_dot2_f32_bf16 v8, v16, s27, v8
    v_dot2_f32_bf16 v9, v16, v16, v9
    v_dot2_f32_bf16 v8, v17, s27, v8
    v_dot2_f32_bf16 v9, v17, v17, v9
    v_dot2_f32_bf16 v8, v18, s27, v8
    v_dot2_f32_bf16 v9, v18, v18, v9
    v_dot2_f32_bf16 v8, v19, s27, v8
    v_dot2_f32_bf16 v9, v19, v19, v9
    s_cmp_eq_u32 s3, 3
    s_cbranch_scc1 ffn_kernels_sk9
    v_dot2_f32_bf16 v8, v20, s27, v8
    v_dot2_f32_bf16 v9, v20, v20, v9
    v_dot2_f32_bf16 v8, v21, s27, v8
    v_dot2_f32_bf16 v9, v21, v21, v9
    v_dot2_f32_bf16 v8, v22, s27, v8
    v_dot2_f32_bf16 v9, v22, v22, v9
    v_dot2_f32_bf16 v8, v23, s27, v8
    v_dot2_f32_bf16 v9, v23, v23, v9
ffn_kernels_sk9:
    s_nop 2
    v_mov_b32 v15, v8
    s_nop 1
    v_permlane32_swap_b32 v8, v15
    v_add_f32 v8, v8, v15
    v_mov_b32 v15, v9
    s_nop 1
    v_permlane32_swap_b32 v9, v15
    v_add_f32 v9, v9, v15
    v_or_b32 v9, 1, v9
    s_add_u32 s26, s38, 31457280
    s_mov_b32 exec_hi, 0
    buffer_store_dwordx2 v[8:9], v11, s[8:11], s26 offen sc1
    s_mov_b64 exec, -1
    s_lshl_b32 s26, s21, 12
    s_add_u32 s26, s26, 31457280
    v_lshlrev_b32 v76, 16, v16
    v_and_b32 v77, 0xffff0000, v16
    v_lshlrev_b32 v84, 16, v68
    v_and_b32 v85, 0xffff0000, v68
    v_lshlrev_b32 v78, 16, v17
    v_and_b32 v79, 0xffff0000, v17
    v_lshlrev_b32 v86, 16, v69
    v_and_b32 v87, 0xffff0000, v69
    v_lshlrev_b32 v80, 16, v18
    v_and_b32 v81, 0xffff0000, v18
    v_lshlrev_b32 v88, 16, v70
    v_and_b32 v89, 0xffff0000, v70
    v_lshlrev_b32 v82, 16, v19
    v_and_b32 v83, 0xffff0000, v19
    v_lshlrev_b32 v90, 16, v71
    v_and_b32 v91, 0xffff0000, v71
    v_lshlrev_b32 v108, 16, v20
    v_and_b32 v109, 0xffff0000, v20
    v_lshlrev_b32 v116, 16, v72
    v_and_b32 v117, 0xffff0000, v72
    v_lshlrev_b32 v110, 16, v21
    v_and_b32 v111, 0xffff0000, v21
    v_lshlrev_b32 v118, 16, v73
    v_and_b32 v119, 0xffff0000, v73
    v_lshlrev_b32 v112, 16, v22
    v_and_b32 v113, 0xffff0000, v22
    v_lshlrev_b32 v120, 16, v74
    v_and_b32 v121, 0xffff0000, v74
    v_lshlrev_b32 v114, 16, v23
    v_and_b32 v115, 0xffff0000, v23
    v_lshlrev_b32 v122, 16, v75
    v_and_b32 v123, 0xffff0000, v75
    buffer_load_dwordx2 v[140:141], v10, s[8:11], s26 offen offset:0 sc1
    buffer_load_dwordx2 v[142:143], v10, s[8:11], s26 offen offset:256 sc1
    buffer_load_dwordx2 v[144:145], v10, s[8:11], s26 offen offset:512 sc1
    buffer_load_dwordx2 v[146:147], v10, s[8:11], s26 offen offset:768 sc1
    buffer_load_dwordx2 v[148:149], v10, s[8:11], s26 offen offset:1024 sc1
    buffer_load_dwordx2 v[150:151], v10, s[8:11], s26 offen offset:1280 sc1
    buffer_load_dwordx2 v[152:153], v10, s[8:11], s26 offen offset:1536 sc1
    buffer_load_dwordx2 v[154:155], v10, s[8:11], s26 offen offset:1792 sc1
    s_barrier
    s_add_u32 m0, s28, 0
    s_add_u32 s27, s24, 0
    buffer_load_dwordx4 v3, s[8:11], s27 offen lds
    s_add_u32 m0, s28, 4096
    s_add_u32 s27, s24, 4096
    buffer_load_dwordx4 v3, s[8:11], s27 offen lds
    s_add_u32 m0, s28, 8192
    s_add_u32 s27, s24, 8192
    buffer_load_dwordx4 v3, s[8:11], s27 offen lds
    s_waitcnt vmcnt(3)
    s_mov_b32 s61, 0
ffn_kernels_stl11:
    v_and_b32 v15, v141, v143
    v_and_b32 v15, v15, v145
    v_and_b32 v15, v15, v147
    v_and_b32 v15, v15, v149
    v_and_b32 v15, v15, v151
    v_and_b32 v15, v15, v153
    v_and_b32 v15, v15, v155
    v_and_b32 v15, 1, v15
    v_cmp_eq_u32 vcc, 0, v15
    s_add_u32 s61, s61, 1
    s_cmp_eq_u64 vcc, 0
    s_cbranch_scc1 ffn_kernels_stok10
    s_cmp_ge_u32 s61, 4000
    s_cbranch_scc1 ffn_kernels_stok10
    s_sleep 1
    buffer_load_dwordx2 v[140:141], v10, s[8:11], s26 offen offset:0 sc1
    buffer_load_dwordx2 v[142:143], v10, s[8:11], s26 offen offset:256 sc1
    buffer_load_dwordx2 v[144:145], v10, s[8:11], s26 offen offset:512 sc1
    buffer_load_dwordx2 v[146:147], v10, s[8:11], s26 offen offset:768 sc1
    buffer_load_dwordx2 v[148:149], v10, s[8:11], s26 offen offset:1024 sc1
    buffer_load_dwordx2 v[150:151], v10, s[8:11], s26 offen offset:1280 sc1
    buffer_load_dwordx2 v[152:153], v10, s[8:11], s26 offen offset:1536 sc1
    buffer_load_dwordx2 v[154:155], v10, s[8:11], s26 offen offset:1792 sc1
    s_waitcnt vmcnt(0)
    s_branch ffn_kernels_stl11
ffn_kernels_stok10:
    v_pk_add_f32 v[140:141], v[140:141], v[148:149]
    v_pk_add_f32 v[142:143], v[142:143], v[150:151]
    v_pk_add_f32 v[144:145], v[144:145], v[152:153]
    v_pk_add_f32 v[146:147], v[146:147], v[154:155]
    v_pk_add_f32 v[140:141], v[140:141], v[144:145]
    v_pk_add_f32 v[142:143], v[142:143], v[146:147]
    v_pk_add_f32 v[140:141], v[140:141], v[142:143]
    v_mov_b32 v15, v140
    s_nop 1
    v_permlane32_swap_b32 v140, v15
    v_add_f32 v140, v140, v15
    v_mov_b32 v15, v141
    s_nop 1
    v_permlane32_swap_b32 v141, v15
    v_add_f32 v141, v141, v15
    v_mul_f32 v140, 0x3b124925, v140
    v_mul_f32 v141, 0x3b124925, v141
    v_fma_f32 v141, -v140, v140, v141
    v_max_f32 v141, 0, v141
    v_cvt_pk_bf16_f32 v142, v140, v140
    v_lshlrev_b32 v142, 16, v142
    v_cvt_pk_bf16_f32 v141, v141, v141
    v_lshlrev_b32 v141, 16, v141
    v_add_f32 v141, 0x3727c5ac, v141
    v_cvt_pk_bf16_f32 v141, v141, v141
    v_lshlrev_b32 v141, 16, v141
    v_sqrt_f32 v141, v141
    s_nop 0
    v_cvt_pk_bf16_f32 v141, v141, v141
    v_lshlrev_b32 v141, 16, v141
    v_rcp_f32 v144, v141
    s_nop 0
    v_mul_f32 v142, v142, v144
    v_mov_b32 v145, v144
    v_sub_f32 v142, 0, v142
    v_mov_b32 v143, v142
    v_pk_fma_f32 v[92:93], v[76:77], v[144:145], v[142:143]
    v_pk_fma_f32 v[94:95], v[78:79], v[144:145], v[142:143]
    v_pk_fma_f32 v[96:97], v[80:81], v[144:145], v[142:143]
    v_pk_fma_f32 v[98:99], v[82:83], v[144:145], v[142:143]
    v_pk_fma_f32 v[92:93], v[92:93], v[84:85], v[76:77]
    v_pk_fma_f32 v[94:95], v[94:95], v[86:87], v[78:79]
    v_pk_fma_f32 v[96:97], v[96:97], v[88:89], v[80:81]
    v_pk_fma_f32 v[98:99], v[98:99], v[90:91], v[82:83]
    v_cvt_pk_bf16_f32 v16, v92, v93
    v_cvt_pk_bf16_f32 v17, v94, v95
    v_cvt_pk_bf16_f32 v18, v96, v97
    v_cvt_pk_bf16_f32 v19, v98, v99
    s_add_u32 s26, s37, 12582912
    buffer_store_dwordx4 v[16:19], v6, s[8:11], s26 offen sc1
    v_pk_fma_f32 v[124:125], v[108:109], v[144:145], v[142:143]
    v_pk_fma_f32 v[126:127], v[110:111], v[144:145], v[142:143]
    v_pk_fma_f32 v[128:129], v[112:113], v[144:145], v[142:143]
    v_pk_fma_f32 v[130:131], v[114:115], v[144:145], v[142:143]
    v_pk_fma_f32 v[124:125], v[124:125], v[116:117], v[108:109]
    v_pk_fma_f32 v[126:127], v[126:127], v[118:119], v[110:111]
    v_pk_fma_f32 v[128:129], v[128:129], v[120:121], v[112:113]
    v_pk_fma_f32 v[130:131], v[130:131], v[122:123], v[114:115]
    v_cvt_pk_bf16_f32 v20, v124, v125
    v_cvt_pk_bf16_f32 v21, v126, v127
    v_cvt_pk_bf16_f32 v22, v128, v129
    v_cvt_pk_bf16_f32 v23, v130, v131
    buffer_store_dwordx4 v[20:23], v7, s[8:11], s26 offen sc1
    v_mov_b32 v8, 0
    v_mov_b32 v9, 0
    s_mov_b32 s27, 0x3f803f80
    v_dot2_f32_bf16 v8, v16, s27, v8
    v_dot2_f32_bf16 v9, v16, v16, v9
    v_dot2_f32_bf16 v8, v17, s27, v8
    v_dot2_f32_bf16 v9, v17, v17, v9
    v_dot2_f32_bf16 v8, v18, s27, v8
    v_dot2_f32_bf16 v9, v18, v18, v9
    v_dot2_f32_bf16 v8, v19, s27, v8
    v_dot2_f32_bf16 v9, v19, v19, v9
    s_cmp_eq_u32 s3, 3
    s_cbranch_scc1 ffn_kernels_sk12
    v_dot2_f32_bf16 v8, v20, s27, v8
    v_dot2_f32_bf16 v9, v20, v20, v9
    v_dot2_f32_bf16 v8, v21, s27, v8
    v_dot2_f32_bf16 v9, v21, v21, v9
    v_dot2_f32_bf16 v8, v22, s27, v8
    v_dot2_f32_bf16 v9, v22, v22, v9
    v_dot2_f32_bf16 v8, v23, s27, v8
    v_dot2_f32_bf16 v9, v23, v23, v9
ffn_kernels_sk12:
    s_nop 2
    v_mov_b32 v15, v8
    s_nop 1
    v_permlane32_swap_b32 v8, v15
    v_add_f32 v8, v8, v15
    v_mov_b32 v15, v9
    s_nop 1
    v_permlane32_swap_b32 v9, v15
    v_add_f32 v9, v9, v15
    v_or_b32 v9, 1, v9
    s_add_u32 s26, s38, 32768000
    s_waitcnt vmcnt(0)
    s_mov_b32 exec_hi, 0
    buffer_store_dwordx2 v[8:9], v11, s[8:11], s26 offen sc1
    s_mov_b64 exec, -1
    v_mov_b32 v6, v10
    s_lshl_b32 s43, s20, 12
    s_add_u32 s43, s43, 32768000
    buffer_load_dwordx2 v[232:233], v6, s[8:11], s43 offen offset:0 sc1
    buffer_load_dwordx2 v[234:235], v6, s[8:11], s43 offen offset:256 sc1
    buffer_load_dwordx2 v[236:237], v6, s[8:11], s43 offen offset:512 sc1
    buffer_load_dwordx2 v[238:239], v6, s[8:11], s43 offen offset:768 sc1
    buffer_load_dwordx2 v[240:241], v6, s[8:11], s43 offen offset:1024 sc1
    buffer_load_dwordx2 v[242:243], v6, s[8:11], s43 offen offset:1280 sc1
    buffer_load_dwordx2 v[244:245], v6, s[8:11], s43 offen offset:1536 sc1
    buffer_load_dwordx2 v[246:247], v6, s[8:11], s43 offen offset:1792 sc1
    s_add_u32 m0, s28, 12288
    s_add_u32 s27, s24, 12288
    buffer_load_dwordx4 v3, s[8:11], s27 offen lds
    s_add_u32 m0, s28, 16384
    s_add_u32 s27, s24, 16384
    buffer_load_dwordx4 v3, s[8:11], s27 offen lds
    s_add_u32 m0, s28, 20480
    s_add_u32 s27, s24, 20480
    buffer_load_dwordx4 v3, s[8:11], s27 offen lds
    s_waitcnt vmcnt(3)
    s_mov_b32 s61, 0
ffn_kernels_fxl14:
    v_and_b32 v15, v233, v235
    v_and_b32 v15, v15, v237
    v_and_b32 v15, v15, v239
    v_and_b32 v15, v15, v241
    v_and_b32 v15, v15, v243
    v_and_b32 v15, v15, v245
    v_and_b32 v15, v15, v247
    v_and_b32 v15, 1, v15
    v_cmp_eq_u32 vcc, 0, v15
    s_add_u32 s61, s61, 1
    s_cmp_eq_u64 vcc, 0
    s_cbranch_scc1 ffn_kernels_fxok13
    s_cmp_ge_u32 s61, 4000
    s_cbranch_scc1 ffn_kernels_fxok13
    s_sleep 1
    buffer_load_dwordx2 v[232:233], v6, s[8:11], s43 offen offset:0 sc1
    buffer_load_dwordx2 v[234:235], v6, s[8:11], s43 offen offset:256 sc1
    buffer_load_dwordx2 v[236:237], v6, s[8:11], s43 offen offset:512 sc1
    buffer_load_dwordx2 v[238:239], v6, s[8:11], s43 offen offset:768 sc1
    buffer_load_dwordx2 v[240:241], v6, s[8:11], s43 offen offset:1024 sc1
    buffer_load_dwordx2 v[242:243], v6, s[8:11], s43 offen offset:1280 sc1
    buffer_load_dwordx2 v[244:245], v6, s[8:11], s43 offen offset:1536 sc1
    buffer_load_dwordx2 v[246:247], v6, s[8:11], s43 offen offset:1792 sc1
    s_waitcnt vmcnt(0)
    s_branch ffn_kernels_fxl14
ffn_kernels_fxok13:
    s_add_u32 s26, s23, 4194304
    buffer_load_dwordx4 v[24:27], v3, s[8:11], s26 offen sc1
    s_add_u32 s26, s23, 4195328
    buffer_load_dwordx4 v[28:31], v3, s[8:11], s26 offen sc1
    s_add_u32 s26, s23, 4196352
    buffer_load_dwordx4 v[32:35], v3, s[8:11], s26 offen sc1
    s_add_u32 s26, s23, 4197376
    buffer_load_dwordx4 v[36:39], v3, s[8:11], s26 offen sc1
    s_add_u32 s26, s23, 4198400
    buffer_load_dwordx4 v[40:43], v3, s[8:11], s26 offen sc1
    s_add_u32 s26, s23, 4199424
    buffer_load_dwordx4 v[44:47], v3, s[8:11], s26 offen sc1
    s_add_u32 m0, s28, 24576
    s_add_u32 s27, s24, 24576
    buffer_load_dwordx4 v3, s[8:11], s27 offen lds
    s_add_u32 m0, s28, 28672
    s_add_u32 s27, s24, 28672
    buffer_load_dwordx4 v3, s[8:11], s27 offen lds
    s_add_u32 m0, s28, 32768
    s_add_u32 s27, s24, 32768
    buffer_load_dwordx4 v3, s[8:11], s27 offen lds
    s_add_u32 m0, s28, 36864
    s_add_u32 s27, s24, 36864
    buffer_load_dwordx4 v3, s[8:11], s27 offen lds
    s_add_u32 m0, s28, 40960
    s_add_u32 s27, s24, 40960
    buffer_load_dwordx4 v3, s[8:11], s27 offen lds
    s_add_u32 m0, s28, 45056
    s_add_u32 s27, s24, 45056
    buffer_load_dwordx4 v3, s[8:11], s27 offen lds
    s_add_u32 m0, s28, 49152
    s_add_u32 s27, s24, 49152
    buffer_load_dwordx4 v3, s[8:11], s27 offen lds
    s_add_u32 m0, s28, 53248
    s_add_u32 s27, s24, 53248
    buffer_load_dwordx4 v3, s[8:11], s27 offen lds
    s_add_u32 s26, s23, 4200448
    buffer_load_dwordx4 v[48:51], v3, s[8:11], s26 offen sc1
    s_add_u32 s26, s23, 4201472
    buffer_load_dwordx4 v[52:55], v3, s[8:11], s26 offen sc1
    s_add_u32 s26, s23, 4202496
    buffer_load_dwordx4 v[56:59], v3, s[8:11], s26 offen sc1
    s_add_u32 s26, s23, 4203520
    buffer_load_dwordx4 v[60:63], v3, s[8:11], s26 offen sc1
    s_add_u32 s26, s23, 4204544
    buffer_load_dwordx4 v[64:67], v3, s[8:11], s26 offen sc1
    s_waitcnt vmcnt(19)
    s_barrier
    ds_read_b128 v[200:203], v3 offset:0
    ds_read_b128 v[204:207], v3 offset:1024
    ds_read_b128 v[208:211], v3 offset:2048
    ds_read_b128 v[212:215], v3 offset:3072
    ds_read_b128 v[216:219], v3 offset:4096
    ds_read_b128 v[220:223], v3 offset:5120
    ds_read_b128 v[224:227], v3 offset:6144
    s_waitcnt vmcnt(18)
    s_waitcnt lgkmcnt(6)
    v_mfma_f32_32x32x16_bf16 v[136:151], v[200:203], v[24:27], 0
    ds_read_b128 v[228:231], v3 offset:7168
    s_waitcnt lgkmcnt(6)
    v_mfma_f32_32x32x16_bf16 v[152:167], v[204:207], v[24:27], 0
    ds_read_b128 v[200:203], v3 offset:8192
    s_add_u32 s26, s23, 4205568
    buffer_load_dwordx4 v[68:71], v3, s[8:11], s26 offen sc1
    s_waitcnt lgkmcnt(6)
    v_mfma_f32_32x32x16_bf16 v[168:183], v[208:211], v[24:27], 0
    ds_read_b128 v[204:207], v3 offset:9216
    s_waitcnt vmcnt(18)
    s_waitcnt lgkmcnt(6)
    v_mfma_f32_32x32x16_bf16 v[136:151], v[212:215], v[28:31], v[136:151]
    ds_read_b128 v[208:211], v3 offset:10240
    s_add_u32 s26, s23, 4206592
    buffer_load_dwordx4 v[72:75], v3, s[8:11], s26 offen sc1
    s_waitcnt lgkmcnt(6)
    v_mfma_f32_32x32x16_bf16 v[152:167], v[216:219], v[28:31], v[152:167]
    ds_read_b128 v[212:215], v3 offset:11264
    s_waitcnt lgkmcnt(6)
    v_mfma_f32_32x32x16_bf16 v[168:183], v[220:223], v[28:31], v[168:183]
    ds_read_b128 v[216:219], v3 offset:12288
    s_add_u32 s26, s23, 4207616
    buffer_load_dwordx4 v[76:79], v3, s[8:11], s26 offen sc1
    s_waitcnt vmcnt(19)
    s_waitcnt lgkmcnt(6)
    v_mfma_f32_32x32x16_bf16 v[136:151], v[224:227], v[32:35], v[136:151]
    ds_read_b128 v[220:223], v3 offset:13312
    s_waitcnt lgkmcnt(6)
    v_mfma_f32_32x32x16_bf16 v[152:167], v[228:231], v[32:35], v[152:167]
    ds_read_b128 v[224:227], v3 offset:14336
    s_add_u32 s26, s23, 4208640
    buffer_load_dwordx4 v[80:83], v3, s[8:11], s26 offen sc1
    s_waitcnt lgkmcnt(6)
    v_mfma_f32_32x32x16_bf16 v[168:183], v[200:203], v[32:35], v[168:183]
    ds_read_b128 v[228:231], v3 offset:15360
    s_waitcnt vmcnt(19)
    s_waitcnt lgkmcnt(6)
    v_mfma_f32_32x32x16_bf16 v[136:151], v[204:207], v[36:39], v[136:151]
    ds_read_b128 v[200:203], v3 offset:16384
    s_add_u32 s26, s23, 4209664
    buffer_load_dwordx4 v[84:87], v3, s[8:11], s26 offen sc1
    s_waitcnt lgkmcnt(6)
    v_mfma_f32_32x32x16_bf16 v[152:167], v[208:211], v[36:39], v[152:167]
    ds_read_b128 v[204:207], v3 offset:17408
    s_waitcnt lgkmcnt(6)
    v_mfma_f32_32x32x16_bf16 v[168:183], v[212:215], v[36:39], v[168:183]
    ds_read_b128 v[208:211], v3 offset:18432
    s_add_u32 s26, s23, 4210688
    buffer_load_dwordx4 v[88:91], v3, s[8:11], s26 offen sc1
    s_waitcnt vmcnt(20)
    s_waitcnt lgkmcnt(6)
    v_mfma_f32_32x32x16_bf16 v[136:151], v[216:219], v[40:43], v[136:151]
    ds_read_b128 v[212:215], v3 offset:19456
    s_waitcnt lgkmcnt(6)
    v_mfma_f32_32x32x16_bf16 v[152:167], v[220:223], v[40:43], v[152:167]
    ds_read_b128 v[216:219], v3 offset:20480
    s_add_u32 s26, s23, 4211712
    buffer_load_dwordx4 v[92:95], v3, s[8:11], s26 offen sc1
    s_waitcnt lgkmcnt(6)
    v_mfma_f32_32x32x16_bf16 v[168:183], v[224:227], v[40:43], v[168:183]
    ds_read_b128 v[220:223], v3 offset:21504
    s_waitcnt vmcnt(20)
    s_waitcnt lgkmcnt(6)
    v_mfma_f32_32x32x16_bf16 v[136:151], v[228:231], v[44:47], v[136:151]
    ds_read_b128 v[224:227], v3 offset:22528
    s_add_u32 s26, s23, 4212736
    buffer_load_dwordx4 v[96:99], v3, s[8:11], s26 offen sc1
    s_waitcnt lgkmcnt(6)
    v_mfma_f32_32x32x16_bf16 v[152:167], v[200:203], v[44:47], v[152:167]
    ds_read_b128 v[228:231], v3 offset:23552
    s_waitcnt vmcnt(13)
    s_barrier
    s_waitcnt lgkmcnt(6)
    v_mfma_f32_32x32x16_bf16 v[168:183], v[204:207], v[44:47], v[168:183]
    ds_read_b128 v[200:203], v3 offset:24576
    s_add_u32 s26, s23, 4213760
    buffer_load_dwordx4 v[100:103], v3, s[8:11], s26 offen sc1
    s_waitcnt vmcnt(13)
    s_waitcnt lgkmcnt(6)
    v_mfma_f32_32x32x16_bf16 v[136:151], v[208:211], v[48:51], v[136:151]
    ds_read_b128 v[204:207], v3 offset:25600
    s_waitcnt lgkmcnt(6)
    v_mfma_f32_32x32x16_bf16 v[152:167], v[212:215], v[48:51], v[152:167]
    ds_read_b128 v[208:211], v3 offset:26624
    s_add_u32 s26, s23, 4214784
    buffer_load_dwordx4 v[104:107], v3, s[8:11], s26 offen sc1
    s_waitcnt lgkmcnt(6)
    v_mfma_f32_32x32x16_bf16 v[168:183], v[216:219], v[48:51], v[168:183]
    ds_read_b128 v[212:215], v3 offset:27648
    s_waitcnt vmcnt(13)
    s_waitcnt lgkmcnt(6)
    v_mfma_f32_32x32x16_bf16 v[136:151], v[220:223], v[52:55], v[136:151]
    ds_read_b128 v[216:219], v3 offset:28672
    s_add_u32 s26, s23, 4215808
    buffer_load_dwordx4 v[108:111], v3, s[8:11], s26 offen sc1
    s_waitcnt lgkmcnt(6)
    v_mfma_f32_32x32x16_bf16 v[152:167], v[224:227], v[52:55], v[152:167]
    ds_read_b128 v[220:223], v3 offset:29696
    s_waitcnt lgkmcnt(6)
    v_mfma_f32_32x32x16_bf16 v[168:183], v[228:231], v[52:55], v[168:183]
    ds_read_b128 v[224:227], v3 offset:30720
    s_add_u32 s26, s23, 4216832
    buffer_load_dwordx4 v[112:115], v3, s[8:11], s26 offen sc1
    s_waitcnt vmcnt(14)
    s_waitcnt lgkmcnt(6)
    v_mfma_f32_32x32x16_bf16 v[136:151], v[200:203], v[56:59], v[136:151]
    ds_read_b128 v[228:231], v3 offset:31744
    s_waitcnt lgkmcnt(6)
    v_mfma_f32_32x32x16_bf16 v[152:167], v[204:207], v[56:59], v[152:167]
    ds_read_b128 v[200:203], v3 offset:32768
    s_add_u32 s26, s23, 4217856
    buffer_load_dwordx4 v[116:119], v3, s[8:11], s26 offen sc1
    s_waitcnt lgkmcnt(6)
    v_mfma_f32_32x32x16_bf16 v[168:183], v[208:211], v[56:59], v[168:183]
    ds_read_b128 v[204:207], v3 offset:33792
    s_waitcnt vmcnt(14)
    s_waitcnt lgkmcnt(6)
    v_mfma_f32_32x32x16_bf16 v[136:151], v[212:215], v[60:63], v[136:151]
    ds_read_b128 v[208:211], v3 offset:34816
    s_add_u32 s26, s23, 4218880
    buffer_load_dwordx4 v[120:123], v3, s[8:11], s26 offen sc1
    s_waitcnt lgkmcnt(6)
    v_mfma_f32_32x32x16_bf16 v[152:167], v[216:219], v[60:63], v[152:167]
    ds_read_b128 v[212:215], v3 offset:35840
    s_waitcnt lgkmcnt(6)
    v_mfma_f32_32x32x16_bf16 v[168:183], v[220:223], v[60:63], v[168:183]
    ds_read_b128 v[216:219], v3 offset:36864
    s_add_u32 s26, s23, 4219904
    buffer_load_dwordx4 v[124:127], v3, s[8:11], s26 offen sc1
    s_waitcnt vmcnt(15)
    s_waitcnt lgkmcnt(6)
    v_mfma_f32_32x32x16_bf16 v[136:151], v[224:227], v[64:67], v[136:151]
    ds_read_b128 v[220:223], v3 offset:37888
    s_waitcnt lgkmcnt(6)
    v_mfma_f32_32x32x16_bf16 v[152:167], v[228:231], v[64:67], v[152:167]
    ds_read_b128 v[224:227], v3 offset:38912
    s_add_u32 s26, s23, 4220928
    buffer_load_dwordx4 v[128:131], v3, s[8:11], s26 offen sc1
    s_waitcnt lgkmcnt(6)
    v_mfma_f32_32x32x16_bf16 v[168:183], v[200:203], v[64:67], v[168:183]
    ds_read_b128 v[228:231], v3 offset:39936
    s_waitcnt vmcnt(15)
    s_waitcnt lgkmcnt(6)
    v_mfma_f32_32x32x16_bf16 v[136:151], v[204:207], v[68:71], v[136:151]
    ds_read_b128 v[200:203], v3 offset:40960
    s_add_u32 s26, s23, 4221952
    buffer_load_dwordx4 v[132:135], v3, s[8:11], s26 offen sc1
    s_waitcnt lgkmcnt(6)
    v_mfma_f32_32x32x16_bf16 v[152:167], v[208:211], v[68:71], v[152:167]
    ds_read_b128 v[204:207], v3 offset:41984
    s_waitcnt lgkmcnt(6)
    v_mfma_f32_32x32x16_bf16 v[168:183], v[212:215], v[68:71], v[168:183]
    ds_read_b128 v[208:211], v3 offset:43008
    s_waitcnt vmcnt(15)
    s_waitcnt lgkmcnt(6)
    v_mfma_f32_32x32x16_bf16 v[136:151], v[216:219], v[72:75], v[136:151]
    ds_read_b128 v[212:215], v3 offset:44032
    s_waitcnt lgkmcnt(6)
    v_mfma_f32_32x32x16_bf16 v[152:167], v[220:223], v[72:75], v[152:167]
    ds_read_b128 v[216:219], v3 offset:45056
    s_waitcnt lgkmcnt(6)
    v_mfma_f32_32x32x16_bf16 v[168:183], v[224:227], v[72:75], v[168:183]
    ds_read_b128 v[220:223], v3 offset:46080
    s_waitcnt vmcnt(14)
    s_waitcnt lgkmcnt(6)
    v_mfma_f32_32x32x16_bf16 v[136:151], v[228:231], v[76:79], v[136:151]
    ds_read_b128 v[224:227], v3 offset:47104
    s_waitcnt lgkmcnt(6)
    v_mfma_f32_32x32x16_bf16 v[152:167], v[200:203], v[76:79], v[152:167]
    ds_read_b128 v[228:231], v3 offset:48128
    v_add_f32 v6, v232, v234
    v_add_f32 v7, v233, v235
    v_add_f32 v6, v6, v236
    v_add_f32 v7, v7, v237
    s_waitcnt lgkmcnt(6)
    v_mfma_f32_32x32x16_bf16 v[168:183], v[204:207], v[76:79], v[168:183]
    ds_read_b128 v[200:203], v3 offset:49152
    v_add_f32 v6, v6, v238
    v_add_f32 v7, v7, v239
    v_add_f32 v6, v6, v240
    v_add_f32 v7, v7, v241
    s_waitcnt vmcnt(13)
    s_waitcnt lgkmcnt(6)
    v_mfma_f32_32x32x16_bf16 v[136:151], v[208:211], v[80:83], v[136:151]
    ds_read_b128 v[204:207], v3 offset:50176
    v_add_f32 v6, v6, v242
    v_add_f32 v7, v7, v243
    v_add_f32 v6, v6, v244
    v_add_f32 v7, v7, v245
    s_waitcnt lgkmcnt(6)
    v_mfma_f32_32x32x16_bf16 v[152:167], v[212:215], v[80:83], v[152:167]
    ds_read_b128 v[208:211], v3 offset:51200
    v_add_f32 v6, v6, v246
    v_add_f32 v7, v7, v247
    v_mov_b32 v8, v6
    s_nop 1
    v_permlane32_swap_b32 v6, v8
    s_waitcnt lgkmcnt(6)
    v_mfma_f32_32x32x16_bf16 v[168:183], v[216:219], v[80:83], v[168:183]
    ds_read_b128 v[212:215], v3 offset:52224
    v_add_f32 v6, v6, v8
    v_mov_b32 v9, v7
    s_nop 1
    v_permlane32_swap_b32 v7, v9
    v_add_f32 v7, v7, v9
    s_waitcnt vmcnt(12)
    s_waitcnt lgkmcnt(6)
    v_mfma_f32_32x32x16_bf16 v[136:151], v[220:223], v[84:87], v[136:151]
    ds_read_b128 v[216:219], v3 offset:53248
    v_mul_f32 v6, 0x3b124925, v6
    v_mul_f32 v7, 0x3b124925, v7
    v_fma_f32 v7, -v6, v6, v7
    v_max_f32 v7, 0, v7
    s_waitcnt lgkmcnt(6)
    v_mfma_f32_32x32x16_bf16 v[152:167], v[224:227], v[84:87], v[152:167]
    ds_read_b128 v[220:223], v3 offset:54272
    v_cvt_pk_bf16_f32 v11, v6, v6
    v_lshlrev_b32 v11, 16, v11
    v_cvt_pk_bf16_f32 v7, v7, v7
    v_lshlrev_b32 v7, 16, v7
    s_waitcnt lgkmcnt(6)
    v_mfma_f32_32x32x16_bf16 v[168:183], v[228:231], v[84:87], v[168:183]
    ds_read_b128 v[224:227], v3 offset:55296
    v_add_f32 v7, 0x3727c5ac, v7
    v_cvt_pk_bf16_f32 v7, v7, v7
    v_lshlrev_b32 v7, 16, v7
    v_sqrt_f32 v7, v7
    s_waitcnt vmcnt(11)
    s_waitcnt lgkmcnt(6)
    v_mfma_f32_32x32x16_bf16 v[136:151], v[200:203], v[88:91], v[136:151]
    ds_read_b128 v[228:231], v3 offset:56320
    v_cvt_pk_bf16_f32 v7, v7, v7
    v_lshlrev_b32 v7, 16, v7
    v_rcp_f32 v10, v7
    v_cvt_pk_bf16_f32 v248, -v11, -v11
    s_waitcnt lgkmcnt(6)
    v_mfma_f32_32x32x16_bf16 v[152:167], v[204:207], v[88:91], v[152:167]
    ds_read_b128 v[200:203], v3 offset:57344
    v_mov_b32 v249, v248
    v_mov_b32 v250, v248
    v_mov_b32 v251, v248
    v_mul_f32 v10, v10, v10
    s_waitcnt lgkmcnt(6)
    v_mfma_f32_32x32x16_bf16 v[168:183], v[208:211], v[88:91], v[168:183]
    ds_read_b128 v[204:207], v3 offset:58368
    s_waitcnt vmcnt(10)
    s_waitcnt lgkmcnt(6)
    v_mfma_f32_32x32x16_bf16 v[136:151], v[212:215], v[92:95], v[136:151]
    ds_read_b128 v[208:211], v3 offset:59392
    s_waitcnt lgkmcnt(6)
    v_mfma_f32_32x32x16_bf16 v[152:167], v[216:219], v[92:95], v[152:167]
    ds_read_b128 v[212:215], v3 offset:60416
    s_waitcnt lgkmcnt(6)
    v_mfma_f32_32x32x16_bf16 v[168:183], v[220:223], v[92:95], v[168:183]
    ds_read_b128 v[216:219], v3 offset:61440
    s_waitcnt vmcnt(9)
    s_waitcnt lgkmcnt(6)
    v_mfma_f32_32x32x16_bf16 v[136:151], v[224:227], v[96:99], v[136:151]
    ds_read_b128 v[220:223], v3 offset:62464
    s_waitcnt lgkmcnt(6)
    v_mfma_f32_32x32x16_bf16 v[152:167], v[228:231], v[96:99], v[152:167]
    ds_read_b128 v[224:227], v3 offset:63488
    s_waitcnt lgkmcnt(6)
    v_mfma_f32_32x32x16_bf16 v[168:183], v[200:203], v[96:99], v[168:183]
    ds_read_b128 v[228:231], v3 offset:64512
    s_waitcnt vmcnt(8)
    s_waitcnt lgkmcnt(6)
    v_mfma_f32_32x32x16_bf16 v[136:151], v[204:207], v[100:103], v[136:151]
    ds_read_b128 v[200:203], v4 offset:0
    s_waitcnt lgkmcnt(6)
    v_mfma_f32_32x32x16_bf16 v[152:167], v[208:211], v[100:103], v[152:167]
    ds_read_b128 v[204:207], v4 offset:1024
    s_waitcnt lgkmcnt(6)
    v_mfma_f32_32x32x16_bf16 v[168:183], v[212:215], v[100:103], v[168:183]
    ds_read_b128 v[208:211], v4 offset:2048
    s_waitcnt vmcnt(7)
    s_waitcnt lgkmcnt(6)
    v_mfma_f32_32x32x16_bf16 v[136:151], v[216:219], v[104:107], v[136:151]
    ds_read_b128 v[212:215], v4 offset:3072
    s_waitcnt lgkmcnt(6)
    v_mfma_f32_32x32x16_bf16 v[152:167], v[220:223], v[104:107], v[152:167]
    ds_read_b128 v[216:219], v4 offset:4096
    s_barrier
    s_waitcnt lgkmcnt(6)
    v_mfma_f32_32x32x16_bf16 v[168:183], v[224:227], v[104:107], v[168:183]
    ds_read_b128 v[220:223], v4 offset:5120
    s_waitcnt vmcnt(6)
    s_waitcnt lgkmcnt(6)
    v_mfma_f32_32x32x16_bf16 v[136:151], v[228:231], v[108:111], v[136:151]
    ds_read_b128 v[224:227], v4 offset:6144
    s_add_u32 m0, s28, 0
    s_add_u32 s27, s24, 159744
    buffer_load_dwordx4 v3, s[8:11], s27 offen lds
    s_waitcnt lgkmcnt(6)
    v_mfma_f32_32x32x16_bf16 v[152:167], v[200:203], v[108:111], v[152:167]
    ds_read_b128 v[228:231], v4 offset:7168
    s_add_u32 m0, s28, 4096
    s_add_u32 s27, s24, 163840
    buffer_load_dwordx4 v3, s[8:11], s27 offen lds
    s_waitcnt lgkmcnt(6)
    v_mfma_f32_32x32x16_bf16 v[168:183], v[204:207], v[108:111], v[168:183]
    ds_read_b128 v[200:203], v4 offset:8192
    s_add_u32 m0, s28, 8192
    s_add_u32 s27, s24, 167936
    buffer_load_dwordx4 v3, s[8:11], s27 offen lds
    s_waitcnt vmcnt(8)
    s_waitcnt lgkmcnt(6)
    v_mfma_f32_32x32x16_bf16 v[136:151], v[208:211], v[112:115], v[136:151]
    ds_read_b128 v[204:207], v4 offset:9216
    s_add_u32 m0, s28, 12288
    s_add_u32 s27, s24, 172032
    buffer_load_dwordx4 v3, s[8:11], s27 offen lds
    s_waitcnt lgkmcnt(6)
    v_mfma_f32_32x32x16_bf16 v[152:167], v[212:215], v[112:115], v[152:167]
    ds_read_b128 v[208:211], v4 offset:10240
    s_add_u32 m0, s28, 16384
    s_add_u32 s27, s24, 176128
    buffer_load_dwordx4 v3, s[8:11], s27 offen lds
    s_waitcnt lgkmcnt(6)
    v_mfma_f32_32x32x16_bf16 v[168:183], v[216:219], v[112:115], v[168:183]
    ds_read_b128 v[212:215], v4 offset:11264
    s_waitcnt vmcnt(9)
    s_waitcnt lgkmcnt(6)
    v_mfma_f32_32x32x16_bf16 v[136:151], v[220:223], v[116:119], v[136:151]
    ds_read_b128 v[216:219], v4 offset:12288
    s_add_u32 m0, s28, 20480
    s_add_u32 s27, s24, 180224
    buffer_load_dwordx4 v3, s[8:11], s27 offen lds
    s_waitcnt lgkmcnt(6)
    v_mfma_f32_32x32x16_bf16 v[152:167], v[224:227], v[116:119], v[152:167]
    ds_read_b128 v[220:223], v4 offset:13312
    s_waitcnt lgkmcnt(6)
    v_mfma_f32_32x32x16_bf16 v[168:183], v[228:231], v[116:119], v[168:183]
    ds_read_b128 v[224:227], v4 offset:14336
    s_add_u32 m0, s28, 24576
    s_add_u32 s27, s24, 184320
    buffer_load_dwordx4 v3, s[8:11], s27 offen lds
    s_waitcnt vmcnt(10)
    s_waitcnt lgkmcnt(6)
    v_mfma_f32_32x32x16_bf16 v[136:151], v[200:203], v[120:123], v[136:151]
    ds_read_b128 v[228:231], v4 offset:15360
    s_waitcnt lgkmcnt(6)
    v_mfma_f32_32x32x16_bf16 v[152:167], v[204:207], v[120:123], v[152:167]
    ds_read_b128 v[200:203], v4 offset:16384
    s_add_u32 m0, s28, 28672
    s_add_u32 s27, s24, 188416
    buffer_load_dwordx4 v3, s[8:11], s27 offen lds
    s_waitcnt lgkmcnt(6)
    v_mfma_f32_32x32x16_bf16 v[168:183], v[208:211], v[120:123], v[168:183]
    ds_read_b128 v[204:207], v4 offset:17408
    s_waitcnt vmcnt(10)
    s_waitcnt lgkmcnt(6)
    v_mfma_f32_32x32x16_bf16 v[136:151], v[212:215], v[124:127], v[136:151]
    ds_read_b128 v[208:211], v4 offset:18432
    s_add_u32 m0, s28, 32768
    s_add_u32 s27, s24, 192512
    buffer_load_dwordx4 v3, s[8:11], s27 offen lds
    s_waitcnt lgkmcnt(6)
    v_mfma_f32_32x32x16_bf16 v[152:167], v[216:219], v[124:127], v[152:167]
    ds_read_b128 v[212:215], v4 offset:19456
    s_waitcnt lgkmcnt(6)
    v_mfma_f32_32x32x16_bf16 v[168:183], v[220:223], v[124:127], v[168:183]
    ds_read_b128 v[216:219], v4 offset:20480
    s_add_u32 m0, s28, 36864
    s_add_u32 s27, s24, 196608
    buffer_load_dwordx4 v3, s[8:11], s27 offen lds
    s_waitcnt vmcnt(11)
    s_waitcnt lgkmcnt(6)
    v_mfma_f32_32x32x16_bf16 v[136:151], v[224:227], v[128:131], v[136:151]
    ds_read_b128 v[220:223], v4 offset:21504
    s_waitcnt lgkmcnt(6)
    v_mfma_f32_32x32x16_bf16 v[152:167], v[228:231], v[128:131], v[152:167]
    ds_read_b128 v[224:227], v4 offset:22528
    s_add_u32 m0, s28, 40960
    s_add_u32 s27, s24, 200704
    buffer_load_dwordx4 v3, s[8:11], s27 offen lds
    s_waitcnt lgkmcnt(6)
    v_mfma_f32_32x32x16_bf16 v[168:183], v[200:203], v[128:131], v[168:183]
    ds_read_b128 v[228:231], v4 offset:23552
    s_waitcnt vmcnt(11)
    s_waitcnt lgkmcnt(6)
    v_mfma_f32_32x32x16_bf16 v[136:151], v[204:207], v[132:135], v[136:151]
    ds_read_b128 v[200:203], v4 offset:24576
    s_add_u32 m0, s28, 45056
    s_add_u32 s27, s24, 204800
    buffer_load_dwordx4 v3, s[8:11], s27 offen lds
    s_waitcnt lgkmcnt(6)
    v_mfma_f32_32x32x16_bf16 v[152:167], v[208:211], v[132:135], v[152:167]
    ds_read_b128 v[204:207], v4 offset:25600
    s_waitcnt lgkmcnt(6)
    v_mfma_f32_32x32x16_bf16 v[168:183], v[212:215], v[132:135], v[168:183]
    ds_read_b128 v[208:211], v4 offset:26624
    s_waitcnt lgkmcnt(6)
    v_mfma_f32_32x32x16_bf16 v[184:199], v[216:219], v[24:27], 0
    ds_read_b128 v[212:215], v4 offset:27648
    s_waitcnt lgkmcnt(6)
    v_mfma_f32_32x32x16_bf16 v[184:199], v[220:223], v[28:31], v[184:199]
    ds_read_b128 v[216:219], v4 offset:28672
    s_waitcnt lgkmcnt(6)
    v_mfma_f32_32x32x16_bf16 v[184:199], v[224:227], v[32:35], v[184:199]
    ds_read_b128 v[220:223], v4 offset:29696
    s_waitcnt lgkmcnt(6)
    v_mfma_f32_32x32x16_bf16 v[184:199], v[228:231], v[36:39], v[184:199]
    ds_read_b128 v[224:227], v4 offset:30720
    s_waitcnt lgkmcnt(6)
    v_mfma_f32_32x32x16_bf16 v[184:199], v[200:203], v[40:43], v[184:199]
    ds_read_b128 v[228:231], v4 offset:31744
    s_waitcnt lgkmcnt(6)
    v_mfma_f32_32x32x16_bf16 v[184:199], v[204:207], v[44:47], v[184:199]
    ds_read_b128 v[200:203], v4 offset:32768
    s_waitcnt lgkmcnt(6)
    v_mfma_f32_32x32x16_bf16 v[184:199], v[208:211], v[48:51], v[184:199]
    ds_read_b128 v[204:207], v4 offset:33792
    s_waitcnt lgkmcnt(6)
    v_mfma_f32_32x32x16_bf16 v[136:151], v[212:215], v[248:251], v[136:151]
    ds_read_b128 v[208:211], v4 offset:34816
    s_waitcnt lgkmcnt(6)
    v_mfma_f32_32x32x16_bf16 v[152:167], v[216:219], v[248:251], v[152:167]
    ds_read_b128 v[212:215], v4 offset:35840
    s_waitcnt lgkmcnt(6)
    v_mfma_f32_32x32x16_bf16 v[168:183], v[220:223], v[248:251], v[168:183]
    ds_read_b128 v[216:219], v4 offset:36864
    s_waitcnt lgkmcnt(6)
    v_mfma_f32_32x32x16_bf16 v[184:199], v[224:227], v[52:55], v[184:199]
    ds_read_b128 v[220:223], v4 offset:37888
    s_nop 1
    v_max_f32 v136, 0, v136
    v_max_f32 v137, 0, v137
    v_max_f32 v138, 0, v138
    v_max_f32 v139, 0, v139
    s_waitcnt lgkmcnt(6)
    v_mfma_f32_32x32x16_bf16 v[184:199], v[228:231], v[56:59], v[184:199]
    ds_read_b128 v[224:227], v4 offset:38912
    v_mul_f32 v140, v10, v140
    v_mul_f32 v141, v10, v141
    v_mul_f32 v142, v10, v142
    v_mul_f32 v143, v10, v143
    s_waitcnt lgkmcnt(6)
    v_mfma_f32_32x32x16_bf16 v[184:199], v[200:203], v[60:63], v[184:199]
    ds_read_b128 v[228:231], v4 offset:39936
    v_mul_f32 v136, v136, v140
    v_mul_f32 v137, v137, v141
    v_mul_f32 v138, v138, v142
    v_mul_f32 v139, v139, v143
    s_waitcnt lgkmcnt(6)
    v_mfma_f32_32x32x16_bf16 v[184:199], v[204:207], v[64:67], v[184:199]
    ds_read_b128 v[200:203], v4 offset:40960
    v_cvt_pk_bf16_f32 v232, v136, v137
    v_cvt_pk_bf16_f32 v233, v138, v139
    v_max_f32 v144, 0, v144
    v_max_f32 v145, 0, v145
    s_waitcnt lgkmcnt(6)
    v_mfma_f32_32x32x16_bf16 v[184:199], v[208:211], v[68:71], v[184:199]
    ds_read_b128 v[204:207], v4 offset:41984
    v_max_f32 v146, 0, v146
    v_max_f32 v147, 0, v147
    v_mul_f32 v148, v10, v148
    v_mul_f32 v149, v10, v149
    s_waitcnt lgkmcnt(6)
    v_mfma_f32_32x32x16_bf16 v[184:199], v[212:215], v[72:75], v[184:199]
    ds_read_b128 v[208:211], v4 offset:43008
    v_mul_f32 v150, v10, v150
    v_mul_f32 v151, v10, v151
    v_mul_f32 v144, v144, v148
    v_mul_f32 v145, v145, v149
    s_waitcnt lgkmcnt(6)
    v_mfma_f32_32x32x16_bf16 v[184:199], v[216:219], v[76:79], v[184:199]
    ds_read_b128 v[212:215], v4 offset:44032
    v_mul_f32 v146, v146, v150
    v_mul_f32 v147, v147, v151
    v_cvt_pk_bf16_f32 v234, v144, v145
    v_cvt_pk_bf16_f32 v235, v146, v147
    s_waitcnt lgkmcnt(6)
    v_mfma_f32_32x32x16_bf16 v[184:199], v[220:223], v[80:83], v[184:199]
    ds_read_b128 v[216:219], v4 offset:45056
    s_add_u32 s26, s36, 16777216
    buffer_store_dwordx4 v[232:235], v3, s[8:11], s26 offen sc1
    v_max_f32 v152, 0, v152
    v_max_f32 v153, 0, v153
    v_max_f32 v154, 0, v154
    s_waitcnt lgkmcnt(6)
    v_mfma_f32_32x32x16_bf16 v[184:199], v[224:227], v[84:87], v[184:199]
    ds_read_b128 v[220:223], v4 offset:46080
    v_max_f32 v155, 0, v155
    v_mul_f32 v156, v10, v156
    v_mul_f32 v157, v10, v157
    v_mul_f32 v158, v10, v158
    s_waitcnt lgkmcnt(6)
    v_mfma_f32_32x32x16_bf16 v[184:199], v[228:231], v[88:91], v[184:199]
    ds_read_b128 v[224:227], v4 offset:47104
    v_mul_f32 v159, v10, v159
    v_mul_f32 v152, v152, v156
    v_mul_f32 v153, v153, v157
    v_mul_f32 v154, v154, v158
    s_waitcnt lgkmcnt(6)
    v_mfma_f32_32x32x16_bf16 v[184:199], v[200:203], v[92:95], v[184:199]
    ds_read_b128 v[228:231], v4 offset:48128
    v_mul_f32 v155, v155, v159
    v_cvt_pk_bf16_f32 v236, v152, v153
    v_cvt_pk_bf16_f32 v237, v154, v155
    v_max_f32 v160, 0, v160
    s_waitcnt lgkmcnt(6)
    v_mfma_f32_32x32x16_bf16 v[184:199], v[204:207], v[96:99], v[184:199]
    ds_read_b128 v[200:203], v4 offset:49152
    v_max_f32 v161, 0, v161
    v_max_f32 v162, 0, v162
    v_max_f32 v163, 0, v163
    v_mul_f32 v164, v10, v164
    s_waitcnt lgkmcnt(6)
    v_mfma_f32_32x32x16_bf16 v[184:199], v[208:211], v[100:103], v[184:199]
    ds_read_b128 v[204:207], v4 offset:50176
    v_mul_f32 v165, v10, v165
    v_mul_f32 v166, v10, v166
    v_mul_f32 v167, v10, v167
    v_mul_f32 v160, v160, v164
    s_waitcnt lgkmcnt(6)
    v_mfma_f32_32x32x16_bf16 v[184:199], v[212:215], v[104:107], v[184:199]
    ds_read_b128 v[208:211], v4 offset:51200
    v_mul_f32 v161, v161, v165
    v_mul_f32 v162, v162, v166
    v_mul_f32 v163, v163, v167
    v_cvt_pk_bf16_f32 v238, v160, v161
    s_waitcnt lgkmcnt(6)
    v_mfma_f32_32x32x16_bf16 v[184:199], v[216:219], v[108:111], v[184:199]
    ds_read_b128 v[212:215], v4 offset:52224
    v_cvt_pk_bf16_f32 v239, v162, v163
    s_add_u32 s26, s36, 16778240
    buffer_store_dwordx4 v[236:239], v3, s[8:11], s26 offen sc1
    v_max_f32 v168, 0, v168
    v_max_f32 v169, 0, v169
    s_waitcnt lgkmcnt(6)
    v_mfma_f32_32x32x16_bf16 v[184:199], v[220:223], v[112:115], v[184:199]
    ds_read_b128 v[216:219], v4 offset:53248
    v_max_f32 v170, 0, v170
    v_max_f32 v171, 0, v171
    v_mul_f32 v172, v10, v172
    v_mul_f32 v173, v10, v173
    s_waitcnt lgkmcnt(6)
    v_mfma_f32_32x32x16_bf16 v[184:199], v[224:227], v[116:119], v[184:199]
    ds_read_b128 v[220:223], v4 offset:54272
    v_mul_f32 v174, v10, v174
    v_mul_f32 v175, v10, v175
    v_mul_f32 v168, v168, v172
    v_mul_f32 v169, v169, v173
    s_waitcnt lgkmcnt(6)
    v_mfma_f32_32x32x16_bf16 v[184:199], v[228:231], v[120:123], v[184:199]
    ds_read_b128 v[224:227], v4 offset:55296
    v_mul_f32 v170, v170, v174
    v_mul_f32 v171, v171, v175
    v_cvt_pk_bf16_f32 v232, v168, v169
    v_cvt_pk_bf16_f32 v233, v170, v171
    s_waitcnt lgkmcnt(6)
    v_mfma_f32_32x32x16_bf16 v[184:199], v[200:203], v[124:127], v[184:199]
    ds_read_b128 v[228:231], v4 offset:56320
    v_max_f32 v176, 0, v176
    v_max_f32 v177, 0, v177
    v_max_f32 v178, 0, v178
    v_max_f32 v179, 0, v179
    s_waitcnt lgkmcnt(6)
    v_mfma_f32_32x32x16_bf16 v[184:199], v[204:207], v[128:131], v[184:199]
    ds_read_b128 v[200:203], v4 offset:57344
    v_mul_f32 v180, v10, v180
    v_mul_f32 v181, v10, v181
    v_mul_f32 v182, v10, v182
    v_mul_f32 v183, v10, v183
    s_waitcnt lgkmcnt(6)
    v_mfma_f32_32x32x16_bf16 v[184:199], v[208:211], v[132:135], v[184:199]
    ds_read_b128 v[204:207], v4 offset:58368
    v_mul_f32 v176, v176, v180
    v_mul_f32 v177, v177, v181
    v_mul_f32 v178, v178, v182
    v_mul_f32 v179, v179, v183
    s_waitcnt lgkmcnt(6)
    v_mfma_f32_32x32x16_bf16 v[184:199], v[212:215], v[248:251], v[184:199]
    ds_read_b128 v[208:211], v4 offset:59392
    v_cvt_pk_bf16_f32 v234, v176, v177
    v_cvt_pk_bf16_f32 v235, v178, v179
    s_add_u32 s26, s36, 16779264
    buffer_store_dwordx4 v[232:235], v3, s[8:11], s26 offen sc1
    s_waitcnt lgkmcnt(6)
    v_mfma_f32_32x32x16_bf16 v[136:151], v[216:219], v[24:27], 0
    ds_read_b128 v[212:215], v4 offset:60416
    s_waitcnt lgkmcnt(6)
    v_mfma_f32_32x32x16_bf16 v[152:167], v[220:223], v[24:27], 0
    ds_read_b128 v[216:219], v4 offset:61440
    s_waitcnt lgkmcnt(6)
    v_mfma_f32_32x32x16_bf16 v[168:183], v[224:227], v[24:27], 0
    ds_read_b128 v[220:223], v4 offset:62464
    v_max_f32 v184, 0, v184
    v_max_f32 v185, 0, v185
    v_max_f32 v186, 0, v186
    v_max_f32 v187, 0, v187
    s_waitcnt lgkmcnt(6)
    v_mfma_f32_32x32x16_bf16 v[136:151], v[228:231], v[28:31], v[136:151]
    ds_read_b128 v[224:227], v4 offset:63488
    v_mul_f32 v188, v10, v188
    v_mul_f32 v189, v10, v189
    v_mul_f32 v190, v10, v190
    v_mul_f32 v191, v10, v191
    s_waitcnt lgkmcnt(6)
    v_mfma_f32_32x32x16_bf16 v[152:167], v[200:203], v[28:31], v[152:167]
    ds_read_b128 v[228:231], v4 offset:64512
    v_mul_f32 v184, v184, v188
    v_mul_f32 v185, v185, v189
    v_mul_f32 v186, v186, v190
    v_mul_f32 v187, v187, v191
    s_add_u32 s29, s25, 28672
    buffer_load_dwordx4 v[24:27], v3, s[8:11], s29 offen
    s_waitcnt lgkmcnt(6)
    v_mfma_f32_32x32x16_bf16 v[168:183], v[204:207], v[28:31], v[168:183]
    ds_read_b128 v[200:203], v5 offset:0
    v_cvt_pk_bf16_f32 v236, v184, v185
    v_cvt_pk_bf16_f32 v237, v186, v187
    v_max_f32 v192, 0, v192
    v_max_f32 v193, 0, v193
    s_waitcnt lgkmcnt(6)
    v_mfma_f32_32x32x16_bf16 v[136:151], v[208:211], v[32:35], v[136:151]
    ds_read_b128 v[204:207], v5 offset:1024
    v_max_f32 v194, 0, v194
    v_max_f32 v195, 0, v195
    v_mul_f32 v196, v10, v196
    v_mul_f32 v197, v10, v197
    s_waitcnt lgkmcnt(6)
    v_mfma_f32_32x32x16_bf16 v[152:167], v[212:215], v[32:35], v[152:167]
    ds_read_b128 v[208:211], v5 offset:2048
    v_mul_f32 v198, v10, v198
    v_mul_f32 v199, v10, v199
    v_mul_f32 v192, v192, v196
    v_mul_f32 v193, v193, v197
    s_add_u32 s29, s25, 29696
    buffer_load_dwordx4 v[28:31], v3, s[8:11], s29 offen
    s_waitcnt lgkmcnt(6)
    v_mfma_f32_32x32x16_bf16 v[168:183], v[216:219], v[32:35], v[168:183]
    ds_read_b128 v[212:215], v5 offset:3072
    v_mul_f32 v194, v194, v198
    v_mul_f32 v195, v195, v199
    v_cvt_pk_bf16_f32 v238, v192, v193
    v_cvt_pk_bf16_f32 v239, v194, v195
    s_waitcnt lgkmcnt(6)
    v_mfma_f32_32x32x16_bf16 v[136:151], v[220:223], v[36:39], v[136:151]
    ds_read_b128 v[216:219], v5 offset:4096
    s_add_u32 s26, s36, 16780288
    buffer_store_dwordx4 v[236:239], v3, s[8:11], s26 offen sc1
    s_waitcnt lgkmcnt(6)
    v_mfma_f32_32x32x16_bf16 v[152:167], v[224:227], v[36:39], v[152:167]
    ds_read_b128 v[220:223], v5 offset:5120
    s_add_u32 s29, s25, 30720
    buffer_load_dwordx4 v[32:35], v3, s[8:11], s29 offen
    s_waitcnt lgkmcnt(6)
    v_mfma_f32_32x32x16_bf16 v[168:183], v[228:231], v[36:39], v[168:183]
    ds_read_b128 v[224:227], v5 offset:6144
    s_waitcnt lgkmcnt(6)
    v_mfma_f32_32x32x16_bf16 v[136:151], v[200:203], v[40:43], v[136:151]
    ds_read_b128 v[228:231], v5 offset:7168
    s_waitcnt lgkmcnt(6)
    v_mfma_f32_32x32x16_bf16 v[152:167], v[204:207], v[40:43], v[152:167]
    ds_read_b128 v[200:203], v5 offset:8192
    s_add_u32 s29, s25, 31744
    buffer_load_dwordx4 v[36:39], v3, s[8:11], s29 offen
    s_waitcnt lgkmcnt(6)
    v_mfma_f32_32x32x16_bf16 v[168:183], v[208:211], v[40:43], v[168:183]
    ds_read_b128 v[204:207], v5 offset:9216
    s_waitcnt lgkmcnt(6)
    v_mfma_f32_32x32x16_bf16 v[136:151], v[212:215], v[44:47], v[136:151]
    ds_read_b128 v[208:211], v5 offset:10240
    s_waitcnt lgkmcnt(6)
    v_mfma_f32_32x32x16_bf16 v[152:167], v[216:219], v[44:47], v[152:167]
    ds_read_b128 v[212:215], v5 offset:11264
    s_add_u32 s29, s25, 32768
    buffer_load_dwordx4 v[40:43], v3, s[8:11], s29 offen
    s_waitcnt lgkmcnt(6)
    v_mfma_f32_32x32x16_bf16 v[168:183], v[220:223], v[44:47], v[168:183]
    ds_read_b128 v[216:219], v5 offset:12288
    s_waitcnt lgkmcnt(6)
    v_mfma_f32_32x32x16_bf16 v[136:151], v[224:227], v[48:51], v[136:151]
    ds_read_b128 v[220:223], v5 offset:13312
    s_waitcnt lgkmcnt(6)
    v_mfma_f32_32x32x16_bf16 v[152:167], v[228:231], v[48:51], v[152:167]
    ds_read_b128 v[224:227], v5 offset:14336
    s_add_u32 s29, s25, 33792
    buffer_load_dwordx4 v[44:47], v3, s[8:11], s29 offen
    s_waitcnt lgkmcnt(6)
    v_mfma_f32_32x32x16_bf16 v[168:183], v[200:203], v[48:51], v[168:183]
    ds_read_b128 v[228:231], v5 offset:15360
    s_waitcnt lgkmcnt(6)
    v_mfma_f32_32x32x16_bf16 v[136:151], v[204:207], v[52:55], v[136:151]
    ds_read_b128 v[200:203], v5 offset:16384
    s_waitcnt lgkmcnt(6)
    v_mfma_f32_32x32x16_bf16 v[152:167], v[208:211], v[52:55], v[152:167]
    ds_read_b128 v[204:207], v5 offset:17408
    s_add_u32 s29, s25, 34816
    buffer_load_dwordx4 v[48:51], v3, s[8:11], s29 offen
    s_waitcnt lgkmcnt(6)
    v_mfma_f32_32x32x16_bf16 v[168:183], v[212:215], v[52:55], v[168:183]
    ds_read_b128 v[208:211], v5 offset:18432
    s_waitcnt lgkmcnt(6)
    v_mfma_f32_32x32x16_bf16 v[136:151], v[216:219], v[56:59], v[136:151]
    ds_read_b128 v[212:215], v5 offset:19456
    s_waitcnt lgkmcnt(6)
    v_mfma_f32_32x32x16_bf16 v[152:167], v[220:223], v[56:59], v[152:167]
    ds_read_b128 v[216:219], v5 offset:20480
    s_add_u32 s29, s25, 43008
    buffer_load_dwordx4 v[52:55], v3, s[8:11], s29 offen
    s_waitcnt lgkmcnt(6)
    v_mfma_f32_32x32x16_bf16 v[168:183], v[224:227], v[56:59], v[168:183]
    ds_read_b128 v[220:223], v5 offset:21504
    s_waitcnt lgkmcnt(6)
    v_mfma_f32_32x32x16_bf16 v[136:151], v[228:231], v[60:63], v[136:151]
    ds_read_b128 v[224:227], v5 offset:22528
    s_waitcnt lgkmcnt(6)
    v_mfma_f32_32x32x16_bf16 v[152:167], v[200:203], v[60:63], v[152:167]
    ds_read_b128 v[228:231], v5 offset:23552
    s_add_u32 s29, s25, 44032
    buffer_load_dwordx4 v[56:59], v3, s[8:11], s29 offen
    s_waitcnt lgkmcnt(6)
    v_mfma_f32_32x32x16_bf16 v[168:183], v[204:207], v[60:63], v[168:183]
    ds_read_b128 v[200:203], v5 offset:24576
    s_waitcnt lgkmcnt(6)
    v_mfma_f32_32x32x16_bf16 v[136:151], v[208:211], v[64:67], v[136:151]
    ds_read_b128 v[204:207], v5 offset:25600
    s_waitcnt lgkmcnt(6)
    v_mfma_f32_32x32x16_bf16 v[152:167], v[212:215], v[64:67], v[152:167]
    ds_read_b128 v[208:211], v5 offset:26624
    s_add_u32 s29, s25, 45056
    buffer_load_dwordx4 v[60:63], v3, s[8:11], s29 offen
    s_waitcnt lgkmcnt(6)
    v_mfma_f32_32x32x16_bf16 v[168:183], v[216:219], v[64:67], v[168:183]
    ds_read_b128 v[212:215], v5 offset:27648
    s_waitcnt vmcnt(14)
    s_barrier
    s_waitcnt lgkmcnt(6)
    v_mfma_f32_32x32x16_bf16 v[136:151], v[220:223], v[68:71], v[136:151]
    ds_read_b128 v[216:219], v3 offset:0
    s_waitcnt vmcnt(8)
    v_mov_b32 v14, 4
    v_mov_b32 v13, 0
    s_add_u32 s35, s34, 262144
    s_mov_b64 exec, 1
    buffer_store_dword v14, v13, s[8:11], s35 offen sc1
    s_mov_b64 exec, -1
    s_waitcnt lgkmcnt(6)
    v_mfma_f32_32x32x16_bf16 v[152:167], v[224:227], v[68:71], v[152:167]
    ds_read_b128 v[220:223], v3 offset:1024
    s_add_u32 s29, s25, 46080
    buffer_load_dwordx4 v[64:67], v3, s[8:11], s29 offen
    s_waitcnt lgkmcnt(6)
    v_mfma_f32_32x32x16_bf16 v[168:183], v[228:231], v[68:71], v[168:183]
    ds_read_b128 v[224:227], v3 offset:2048
    s_waitcnt lgkmcnt(6)
    v_mfma_f32_32x32x16_bf16 v[136:151], v[200:203], v[72:75], v[136:151]
    ds_read_b128 v[228:231], v3 offset:3072
    s_waitcnt lgkmcnt(6)
    v_mfma_f32_32x32x16_bf16 v[152:167], v[204:207], v[72:75], v[152:167]
    ds_read_b128 v[200:203], v3 offset:4096
    s_add_u32 s29, s25, 47104
    buffer_load_dwordx4 v[68:71], v3, s[8:11], s29 offen
    s_waitcnt lgkmcnt(6)
    v_mfma_f32_32x32x16_bf16 v[168:183], v[208:211], v[72:75], v[168:183]
    ds_read_b128 v[204:207], v3 offset:5120
    s_waitcnt lgkmcnt(6)
    v_mfma_f32_32x32x16_bf16 v[136:151], v[212:215], v[76:79], v[136:151]
    ds_read_b128 v[208:211], v3 offset:6144
    s_waitcnt lgkmcnt(6)
    v_mfma_f32_32x32x16_bf16 v[152:167], v[216:219], v[76:79], v[152:167]
    ds_read_b128 v[212:215], v3 offset:7168
    s_add_u32 s29, s25, 48128
    buffer_load_dwordx4 v[72:75], v3, s[8:11], s29 offen
    s_waitcnt lgkmcnt(6)
    v_mfma_f32_32x32x16_bf16 v[168:183], v[220:223], v[76:79], v[168:183]
    ds_read_b128 v[216:219], v3 offset:8192
    s_waitcnt lgkmcnt(6)
    v_mfma_f32_32x32x16_bf16 v[136:151], v[224:227], v[80:83], v[136:151]
    ds_read_b128 v[220:223], v3 offset:9216
    s_waitcnt lgkmcnt(6)
    v_mfma_f32_32x32x16_bf16 v[152:167], v[228:231], v[80:83], v[152:167]
    ds_read_b128 v[224:227], v3 offset:10240
    s_add_u32 s29, s25, 49152
    buffer_load_dwordx4 v[76:79], v3, s[8:11], s29 offen
    s_add_u32 s33, s32, 262144
    v_and_b32 v245, 3, v2
    v_lshlrev_b32 v245, 8, v245
    buffer_load_dword v244, v245, s[8:11], s33 offen sc1
    s_waitcnt lgkmcnt(6)
    v_mfma_f32_32x32x16_bf16 v[168:183], v[200:203], v[80:83], v[168:183]
    ds_read_b128 v[228:231], v3 offset:11264
    s_waitcnt lgkmcnt(6)
    v_mfma_f32_32x32x16_bf16 v[136:151], v[204:207], v[84:87], v[136:151]
    ds_read_b128 v[200:203], v3 offset:12288
    s_waitcnt lgkmcnt(6)
    v_mfma_f32_32x32x16_bf16 v[152:167], v[208:211], v[84:87], v[152:167]
    ds_read_b128 v[204:207], v3 offset:13312
    s_waitcnt lgkmcnt(6)
    v_mfma_f32_32x32x16_bf16 v[168:183], v[212:215], v[84:87], v[168:183]
    ds_read_b128 v[208:211], v3 offset:14336
    s_waitcnt lgkmcnt(6)
    v_mfma_f32_32x32x16_bf16 v[136:151], v[216:219], v[88:91], v[136:151]
    ds_read_b128 v[212:215], v3 offset:15360
    s_waitcnt lgkmcnt(6)
    v_mfma_f32_32x32x16_bf16 v[152:167], v[220:223], v[88:91], v[152:167]
    ds_read_b128 v[216:219], v3 offset:16384
    s_waitcnt lgkmcnt(6)
    v_mfma_f32_32x32x16_bf16 v[168:183], v[224:227], v[88:91], v[168:183]
    ds_read_b128 v[220:223], v3 offset:17408
    s_waitcnt lgkmcnt(6)
    v_mfma_f32_32x32x16_bf16 v[136:151], v[228:231], v[92:95], v[136:151]
    ds_read_b128 v[224:227], v3 offset:18432
    s_waitcnt lgkmcnt(6)
    v_mfma_f32_32x32x16_bf16 v[152:167], v[200:203], v[92:95], v[152:167]
    ds_read_b128 v[228:231], v3 offset:19456
    s_waitcnt lgkmcnt(6)
    v_mfma_f32_32x32x16_bf16 v[168:183], v[204:207], v[92:95], v[168:183]
    ds_read_b128 v[200:203], v3 offset:20480
    s_waitcnt lgkmcnt(6)
    v_mfma_f32_32x32x16_bf16 v[136:151], v[208:211], v[96:99], v[136:151]
    ds_read_b128 v[204:207], v3 offset:21504
    s_waitcnt lgkmcnt(6)
    v_mfma_f32_32x32x16_bf16 v[152:167], v[212:215], v[96:99], v[152:167]
    ds_read_b128 v[208:211], v3 offset:22528
    s_waitcnt lgkmcnt(6)
    v_mfma_f32_32x32x16_bf16 v[168:183], v[216:219], v[96:99], v[168:183]
    ds_read_b128 v[212:215], v3 offset:23552
    s_waitcnt lgkmcnt(6)
    v_mfma_f32_32x32x16_bf16 v[136:151], v[220:223], v[100:103], v[136:151]
    ds_read_b128 v[216:219], v3 offset:24576
    s_waitcnt lgkmcnt(6)
    v_mfma_f32_32x32x16_bf16 v[152:167], v[224:227], v[100:103], v[152:167]
    ds_read_b128 v[220:223], v3 offset:25600
    s_waitcnt lgkmcnt(6)
    v_mfma_f32_32x32x16_bf16 v[168:183], v[228:231], v[100:103], v[168:183]
    ds_read_b128 v[224:227], v3 offset:26624
    s_waitcnt vmcnt(0)
    s_mov_b32 s61, 0
ffn_kernels_fhl16:
    v_cmp_gt_u32 vcc, 4, v244
    s_add_u32 s61, s61, 1
    s_cmp_eq_u64 vcc, 0
    s_cbranch_scc1 ffn_kernels_fhok15
    s_cmp_ge_u32 s61, 4000
    s_cbranch_scc1 ffn_kernels_fhok15
    s_sleep 1
    buffer_load_dword v244, v245, s[8:11], s33 offen sc1
    s_waitcnt vmcnt(0)
    s_branch ffn_kernels_fhl16
ffn_kernels_fhok15:
    s_waitcnt lgkmcnt(6)
    v_mfma_f32_32x32x16_bf16 v[136:151], v[200:203], v[104:107], v[136:151]
    ds_read_b128 v[228:231], v3 offset:27648
    s_add_u32 s31, s30, 16777216
    buffer_load_dwordx4 v[80:83], v12, s[8:11], s31 offen offset:0 sc1
    s_add_u32 s31, s30, 16777216
    buffer_load_dwordx4 v[84:87], v12, s[8:11], s31 offen offset:256 sc1
    s_waitcnt lgkmcnt(6)
    v_mfma_f32_32x32x16_bf16 v[152:167], v[204:207], v[104:107], v[152:167]
    ds_read_b128 v[200:203], v3 offset:28672
    s_add_u32 s31, s30, 16791552
    buffer_load_dwordx4 v[88:91], v12, s[8:11], s31 offen offset:0 sc1
    s_waitcnt lgkmcnt(6)
    v_mfma_f32_32x32x16_bf16 v[168:183], v[208:211], v[104:107], v[168:183]
    ds_read_b128 v[204:207], v3 offset:29696
    s_add_u32 s31, s30, 16791552
    buffer_load_dwordx4 v[92:95], v12, s[8:11], s31 offen offset:256 sc1
    s_waitcnt lgkmcnt(6)
    v_mfma_f32_32x32x16_bf16 v[136:151], v[212:215], v[108:111], v[136:151]
    ds_read_b128 v[208:211], v3 offset:30720
    s_waitcnt lgkmcnt(6)
    v_mfma_f32_32x32x16_bf16 v[136:151], v[216:219], v[112:115], v[136:151]
    ds_read_b128 v[212:215], v3 offset:31744
    s_add_u32 s31, s30, 16778240
    buffer_load_dwordx4 v[96:99], v12, s[8:11], s31 offen offset:0 sc1
    s_waitcnt lgkmcnt(6)
    v_mfma_f32_32x32x16_bf16 v[136:151], v[220:223], v[116:119], v[136:151]
    ds_read_b128 v[216:219], v3 offset:32768
    s_waitcnt lgkmcnt(6)
    v_mfma_f32_32x32x16_bf16 v[136:151], v[224:227], v[120:123], v[136:151]
    ds_read_b128 v[220:223], v3 offset:33792
    s_add_u32 s31, s30, 16778240
    buffer_load_dwordx4 v[100:103], v12, s[8:11], s31 offen offset:256 sc1
    s_waitcnt lgkmcnt(6)
    v_mfma_f32_32x32x16_bf16 v[136:151], v[228:231], v[124:127], v[136:151]
    ds_read_b128 v[224:227], v3 offset:34816
    s_waitcnt lgkmcnt(6)
    v_mfma_f32_32x32x16_bf16 v[136:151], v[200:203], v[128:131], v[136:151]
    ds_read_b128 v[228:231], v3 offset:35840
    s_add_u32 s31, s30, 16792576
    buffer_load_dwordx4 v[104:107], v12, s[8:11], s31 offen offset:0 sc1
    s_waitcnt lgkmcnt(6)
    v_mfma_f32_32x32x16_bf16 v[136:151], v[204:207], v[132:135], v[136:151]
    ds_read_b128 v[200:203], v3 offset:36864
    s_waitcnt lgkmcnt(6)
    v_mfma_f32_32x32x16_bf16 v[136:151], v[208:211], v[248:251], v[136:151]
    ds_read_b128 v[204:207], v3 offset:37888
    s_waitcnt lgkmcnt(6)
    v_mfma_f32_32x32x16_bf16 v[152:167], v[212:215], v[108:111], v[152:167]
    ds_read_b128 v[208:211], v3 offset:38912
    s_waitcnt lgkmcnt(6)
    v_mfma_f32_32x32x16_bf16 v[152:167], v[216:219], v[112:115], v[152:167]
    ds_read_b128 v[212:215], v3 offset:39936
    s_nop 4
    v_max_f32 v136, 0, v136
    v_max_f32 v137, 0, v137
    v_max_f32 v138, 0, v138
    v_max_f32 v139, 0, v139
    s_waitcnt lgkmcnt(6)
    v_mfma_f32_32x32x16_bf16 v[152:167], v[220:223], v[116:119], v[152:167]
    ds_read_b128 v[216:219], v3 offset:40960
    v_mul_f32 v140, v10, v140
    v_mul_f32 v141, v10, v141
    v_mul_f32 v142, v10, v142
    v_mul_f32 v143, v10, v143
    s_waitcnt lgkmcnt(6)
    v_mfma_f32_32x32x16_bf16 v[152:167], v[224:227], v[120:123], v[152:167]
    ds_read_b128 v[220:223], v3 offset:41984
    v_mul_f32 v136, v136, v140
    v_mul_f32 v137, v137, v141
    v_mul_f32 v138, v138, v142
    v_mul_f32 v139, v139, v143
    s_waitcnt lgkmcnt(6)
    v_mfma_f32_32x32x16_bf16 v[152:167], v[228:231], v[124:127], v[152:167]
    ds_read_b128 v[224:227], v3 offset:43008
    v_cvt_pk_bf16_f32 v232, v136, v137
    v_cvt_pk_bf16_f32 v233, v138, v139
    v_max_f32 v144, 0, v144
    v_max_f32 v145, 0, v145
    s_waitcnt lgkmcnt(6)
    v_mfma_f32_32x32x16_bf16 v[152:167], v[200:203], v[128:131], v[152:167]
    ds_read_b128 v[228:231], v3 offset:44032
    v_max_f32 v146, 0, v146
    v_max_f32 v147, 0, v147
    v_mul_f32 v148, v10, v148
    v_mul_f32 v149, v10, v149
    s_waitcnt lgkmcnt(6)
    v_mfma_f32_32x32x16_bf16 v[152:167], v[204:207], v[132:135], v[152:167]
    ds_read_b128 v[200:203], v3 offset:45056
    v_mul_f32 v150, v10, v150
    v_mul_f32 v151, v10, v151
    v_mul_f32 v144, v144, v148
    v_mul_f32 v145, v145, v149
    s_waitcnt lgkmcnt(6)
    v_mfma_f32_32x32x16_bf16 v[152:167], v[208:211], v[248:251], v[152:167]
    ds_read_b128 v[204:207], v3 offset:46080
    v_mul_f32 v146, v146, v150
    v_mul_f32 v147, v147, v151
    v_cvt_pk_bf16_f32 v234, v144, v145
    v_cvt_pk_bf16_f32 v235, v146, v147
    s_waitcnt lgkmcnt(6)
    v_mfma_f32_32x32x16_bf16 v[168:183], v[212:215], v[108:111], v[168:183]
    ds_read_b128 v[208:211], v3 offset:47104
    s_add_u32 s26, s36, 16781312
    buffer_store_dwordx4 v[232:235], v3, s[8:11], s26 offen sc1
    s_waitcnt lgkmcnt(6)
    v_mfma_f32_32x32x16_bf16 v[168:183], v[216:219], v[112:115], v[168:183]
    v_max_f32 v152, 0, v152
    v_max_f32 v153, 0, v153
    v_max_f32 v154, 0, v154
    v_max_f32 v155, 0, v155
    s_add_u32 s31, s30, 16792576
    buffer_load_dwordx4 v[108:111], v12, s[8:11], s31 offen offset:256 sc1
    s_waitcnt lgkmcnt(5)
    v_mfma_f32_32x32x16_bf16 v[168:183], v[220:223], v[116:119], v[168:183]
    v_mul_f32 v156, v10, v156
    v_mul_f32 v157, v10, v157
    v_mul_f32 v158, v10, v158
    v_mul_f32 v159, v10, v159
    s_waitcnt lgkmcnt(4)
    v_mfma_f32_32x32x16_bf16 v[168:183], v[224:227], v[120:123], v[168:183]
    v_mul_f32 v152, v152, v156
    v_mul_f32 v153, v153, v157
    v_mul_f32 v154, v154, v158
    v_mul_f32 v155, v155, v159
    s_add_u32 s31, s30, 16779264
    buffer_load_dwordx4 v[112:115], v12, s[8:11], s31 offen offset:0 sc1
    s_waitcnt lgkmcnt(3)
    v_mfma_f32_32x32x16_bf16 v[168:183], v[228:231], v[124:127], v[168:183]
    v_cvt_pk_bf16_f32 v236, v152, v153
    v_cvt_pk_bf16_f32 v237, v154, v155
    v_max_f32 v160, 0, v160
    v_max_f32 v161, 0, v161
    s_add_u32 s31, s30, 16779264
    buffer_load_dwordx4 v[116:119], v12, s[8:11], s31 offen offset:256 sc1
    s_waitcnt lgkmcnt(2)
    v_mfma_f32_32x32x16_bf16 v[168:183], v[200:203], v[128:131], v[168:183]
    v_max_f32 v162, 0, v162
    v_max_f32 v163, 0, v163
    v_mul_f32 v164, v10, v164
    v_mul_f32 v165, v10, v165
    s_add_u32 s31, s30, 16793600
    buffer_load_dwordx4 v[120:123], v12, s[8:11], s31 offen offset:0 sc1
    s_waitcnt lgkmcnt(1)
    v_mfma_f32_32x32x16_bf16 v[168:183], v[204:207], v[132:135], v[168:183]
    v_mul_f32 v166, v10, v166
    v_mul_f32 v167, v10, v167
    v_mul_f32 v160, v160, v164
    v_mul_f32 v161, v161, v165
    s_add_u32 s31, s30, 16793600
    buffer_load_dwordx4 v[124:127], v12, s[8:11], s31 offen offset:256 sc1
    s_waitcnt lgkmcnt(0)
    v_mfma_f32_32x32x16_bf16 v[168:183], v[208:211], v[248:251], v[168:183]
    v_mul_f32 v162, v162, v166
    v_mul_f32 v163, v163, v167
    v_cvt_pk_bf16_f32 v238, v160, v161
    v_cvt_pk_bf16_f32 v239, v162, v163
    s_add_u32 s29, s25, 57344
    buffer_load_dwordx4 v[128:131], v3, s[8:11], s29 offen
    s_add_u32 s26, s36, 16782336
    buffer_store_dwordx4 v[236:239], v3, s[8:11], s26 offen sc1
    s_nop 3
    v_max_f32 v168, 0, v168
    v_max_f32 v169, 0, v169
    v_max_f32 v170, 0, v170
    v_max_f32 v171, 0, v171
    v_mul_f32 v172, v10, v172
    v_mul_f32 v173, v10, v173
    v_mul_f32 v174, v10, v174
    v_mul_f32 v175, v10, v175
    v_mul_f32 v168, v168, v172
    v_mul_f32 v169, v169, v173
    v_mul_f32 v170, v170, v174
    v_mul_f32 v171, v171, v175
    v_cvt_pk_bf16_f32 v232, v168, v169
    v_cvt_pk_bf16_f32 v233, v170, v171
    v_max_f32 v176, 0, v176
    v_max_f32 v177, 0, v177
    v_max_f32 v178, 0, v178
    v_max_f32 v179, 0, v179
    v_mul_f32 v180, v10, v180
    v_mul_f32 v181, v10, v181
    v_mul_f32 v182, v10, v182
    v_mul_f32 v183, v10, v183
    v_mul_f32 v176, v176, v180
    v_mul_f32 v177, v177, v181
    v_mul_f32 v178, v178, v182
    v_mul_f32 v179, v179, v183
    v_cvt_pk_bf16_f32 v234, v176, v177
    v_cvt_pk_bf16_f32 v235, v178, v179
    s_add_u32 s26, s36, 16783360
    buffer_store_dwordx4 v[232:235], v3, s[8:11], s26 offen sc1
    s_waitcnt vmcnt(15)
    v_mfma_f32_16x16x32_bf16 v[200:203], a[0:3], v[80:83], 0
    s_waitcnt vmcnt(14)
    v_mfma_f32_16x16x32_bf16 v[204:207], a[0:3], v[84:87], 0
    v_mfma_f32_16x16x32_bf16 v[208:211], a[4:7], v[80:83], 0
    v_mfma_f32_16x16x32_bf16 v[212:215], a[4:7], v[84:87], 0
    s_add_u32 s29, s25, 58368
    buffer_load_dwordx4 v[132:135], v3, s[8:11], s29 offen
    v_mfma_f32_16x16x32_bf16 v[216:219], a[8:11], v[80:83], 0
    v_mfma_f32_16x16x32_bf16 v[220:223], a[8:11], v[84:87], 0
    v_mfma_f32_16x16x32_bf16 v[224:227], a[12:15], v[80:83], 0
    v_mfma_f32_16x16x32_bf16 v[228:231], a[12:15], v[84:87], 0
    s_add_u32 s29, s25, 59392
    buffer_load_dwordx4 v[136:139], v3, s[8:11], s29 offen
    v_mfma_f32_16x16x32_bf16 v[184:187], a[16:19], v[80:83], 0
    v_mfma_f32_16x16x32_bf16 v[188:191], a[16:19], v[84:87], 0
    v_mfma_f32_16x16x32_bf16 v[192:195], a[20:23], v[80:83], 0
    v_mfma_f32_16x16x32_bf16 v[196:199], a[20:23], v[84:87], 0
    s_add_u32 s29, s25, 60416
    buffer_load_dwordx4 v[140:143], v3, s[8:11], s29 offen
    v_mfma_f32_16x16x32_bf16 v[248:251], a[24:27], v[80:83], 0
    v_mfma_f32_16x16x32_bf16 v[252:255], a[24:27], v[84:87], 0
    s_waitcnt vmcnt(16)
    v_mfma_f32_16x16x32_bf16 v[200:203], a[28:31], v[88:91], v[200:203]
    s_waitcnt vmcnt(15)
    v_mfma_f32_16x16x32_bf16 v[204:207], a[28:31], v[92:95], v[204:207]
    s_add_u32 s29, s25, 61440
    buffer_load_dwordx4 v[144:147], v3, s[8:11], s29 offen
    v_mfma_f32_16x16x32_bf16 v[208:211], a[32:35], v[88:91], v[208:211]
    v_mfma_f32_16x16x32_bf16 v[212:215], a[32:35], v[92:95], v[212:215]
    v_mfma_f32_16x16x32_bf16 v[216:219], a[36:39], v[88:91], v[216:219]
    v_mfma_f32_16x16x32_bf16 v[220:223], a[36:39], v[92:95], v[220:223]
    s_add_u32 s29, s25, 62464
    buffer_load_dwordx4 v[148:151], v3, s[8:11], s29 offen
    v_mfma_f32_16x16x32_bf16 v[224:227], a[40:43], v[88:91], v[224:227]
    v_mfma_f32_16x16x32_bf16 v[228:231], a[40:43], v[92:95], v[228:231]
    v_mfma_f32_16x16x32_bf16 v[184:187], a[44:47], v[88:91], v[184:187]
    v_mfma_f32_16x16x32_bf16 v[188:191], a[44:47], v[92:95], v[188:191]
    s_add_u32 s29, s25, 63488
    buffer_load_dwordx4 v[152:155], v3, s[8:11], s29 offen
    v_mfma_f32_16x16x32_bf16 v[192:195], a[48:51], v[88:91], v[192:195]
    v_mfma_f32_16x16x32_bf16 v[196:199], a[48:51], v[92:95], v[196:199]
    s_add_u32 s31, s30, 16780288
    buffer_load_dwordx4 v[156:159], v12, s[8:11], s31 offen offset:0 sc1
    v_mfma_f32_16x16x32_bf16 v[248:251], a[52:55], v[88:91], v[248:251]
    s_add_u32 s31, s30, 16780288
    buffer_load_dwordx4 v[160:163], v12, s[8:11], s31 offen offset:256 sc1
    v_mfma_f32_16x16x32_bf16 v[252:255], a[52:55], v[92:95], v[252:255]
    s_waitcnt vmcnt(8)
    v_mov_b32 v14, 7
    v_mov_b32 v13, 0
    s_add_u32 s35, s34, 262144
    s_mov_b64 exec, 1
    buffer_store_dword v14, v13, s[8:11], s35 offen sc1
    s_mov_b64 exec, -1
    v_mfma_f32_16x16x32_bf16 v[200:203], a[56:59], v[96:99], v[200:203]
    v_mfma_f32_16x16x32_bf16 v[204:207], a[56:59], v[100:103], v[204:207]
    v_mfma_f32_16x16x32_bf16 v[208:211], a[60:63], v[96:99], v[208:211]
    s_add_u32 s31, s30, 16794624
    buffer_load_dwordx4 v[164:167], v12, s[8:11], s31 offen offset:0 sc1
    v_mfma_f32_16x16x32_bf16 v[212:215], a[60:63], v[100:103], v[212:215]
    v_mfma_f32_16x16x32_bf16 v[216:219], a[64:67], v[96:99], v[216:219]
    v_mfma_f32_16x16x32_bf16 v[220:223], a[64:67], v[100:103], v[220:223]
    v_mfma_f32_16x16x32_bf16 v[224:227], a[68:71], v[96:99], v[224:227]
    s_add_u32 s31, s30, 16794624
    buffer_load_dwordx4 v[168:171], v12, s[8:11], s31 offen offset:256 sc1
    v_mfma_f32_16x16x32_bf16 v[228:231], a[68:71], v[100:103], v[228:231]
    s_add_u32 s33, s32, 262144
    v_and_b32 v245, 3, v2
    v_lshlrev_b32 v245, 8, v245
    buffer_load_dword v244, v245, s[8:11], s33 offen sc1
    v_mfma_f32_16x16x32_bf16 v[184:187], a[72:75], v[96:99], v[184:187]
    v_mfma_f32_16x16x32_bf16 v[188:191], a[72:75], v[100:103], v[188:191]
    v_mfma_f32_16x16x32_bf16 v[192:195], a[76:79], v[96:99], v[192:195]
    s_add_u32 s29, s25, 71680
    buffer_load_dwordx4 v[172:175], v3, s[8:11], s29 offen
    v_mfma_f32_16x16x32_bf16 v[196:199], a[76:79], v[100:103], v[196:199]
    v_mfma_f32_16x16x32_bf16 v[248:251], a[80:83], v[96:99], v[248:251]
    v_mfma_f32_16x16x32_bf16 v[252:255], a[80:83], v[100:103], v[252:255]
    v_mfma_f32_16x16x32_bf16 v[200:203], a[84:87], v[104:107], v[200:203]
    s_add_u32 s29, s25, 72704
    buffer_load_dwordx4 v[176:179], v3, s[8:11], s29 offen
    v_mfma_f32_16x16x32_bf16 v[204:207], a[84:87], v[108:111], v[204:207]
    v_mfma_f32_16x16x32_bf16 v[208:211], a[88:91], v[104:107], v[208:211]
    v_mfma_f32_16x16x32_bf16 v[212:215], a[88:91], v[108:111], v[212:215]
    v_mfma_f32_16x16x32_bf16 v[216:219], a[92:95], v[104:107], v[216:219]
    s_add_u32 s29, s25, 73728
    buffer_load_dwordx4 v[180:183], v3, s[8:11], s29 offen
    v_mfma_f32_16x16x32_bf16 v[220:223], a[92:95], v[108:111], v[220:223]
    v_mfma_f32_16x16x32_bf16 v[224:227], a[96:99], v[104:107], v[224:227]
    v_mfma_f32_16x16x32_bf16 v[228:231], a[96:99], v[108:111], v[228:231]
    v_mfma_f32_16x16x32_bf16 v[184:187], a[100:103], v[104:107], v[184:187]
    s_add_u32 s29, s25, 74752
    buffer_load_dwordx4 v[80:83], v3, s[8:11], s29 offen
    v_mfma_f32_16x16x32_bf16 v[188:191], a[100:103], v[108:111], v[188:191]
    v_mfma_f32_16x16x32_bf16 v[192:195], a[104:107], v[104:107], v[192:195]
    v_mfma_f32_16x16x32_bf16 v[196:199], a[104:107], v[108:111], v[196:199]
    v_mfma_f32_16x16x32_bf16 v[248:251], a[108:111], v[104:107], v[248:251]
    s_add_u32 s29, s25, 75776
    buffer_load_dwordx4 v[84:87], v3, s[8:11], s29 offen
    v_mfma_f32_16x16x32_bf16 v[252:255], a[108:111], v[108:111], v[252:255]
    s_waitcnt vmcnt(5)
    s_mov_b32 s61, 0
ffn_kernels_fhl18:
    v_cmp_gt_u32 vcc, 7, v244
    s_add_u32 s61, s61, 1
    s_cmp_eq_u64 vcc, 0
    s_cbranch_scc1 ffn_kernels_fhok17
    s_cmp_ge_u32 s61, 4000
    s_cbranch_scc1 ffn_kernels_fhok17
    s_sleep 1
    buffer_load_dword v244, v245, s[8:11], s33 offen sc1
    s_waitcnt vmcnt(0)
    s_branch ffn_kernels_fhl18
ffn_kernels_fhok17:
    v_mfma_f32_16x16x32_bf16 v[200:203], v[24:27], v[112:115], v[200:203]
    s_add_u32 s31, s30, 16781312
    buffer_load_dwordx4 v[96:99], v12, s[8:11], s31 offen offset:0 sc1
    s_add_u32 s31, s30, 16781312
    buffer_load_dwordx4 v[100:103], v12, s[8:11], s31 offen offset:256 sc1
    v_mfma_f32_16x16x32_bf16 v[204:207], v[24:27], v[116:119], v[204:207]
    v_mfma_f32_16x16x32_bf16 v[208:211], v[28:31], v[112:115], v[208:211]
    v_mfma_f32_16x16x32_bf16 v[212:215], v[28:31], v[116:119], v[212:215]
    v_mfma_f32_16x16x32_bf16 v[216:219], v[32:35], v[112:115], v[216:219]
    s_add_u32 s29, s25, 76800
    buffer_load_dwordx4 v[88:91], v3, s[8:11], s29 offen
    v_mfma_f32_16x16x32_bf16 v[220:223], v[32:35], v[116:119], v[220:223]
    v_mfma_f32_16x16x32_bf16 v[224:227], v[36:39], v[112:115], v[224:227]
    v_mfma_f32_16x16x32_bf16 v[228:231], v[36:39], v[116:119], v[228:231]
    v_mfma_f32_16x16x32_bf16 v[184:187], v[40:43], v[112:115], v[184:187]
    s_add_u32 s29, s25, 77824
    buffer_load_dwordx4 v[92:95], v3, s[8:11], s29 offen
    v_mfma_f32_16x16x32_bf16 v[188:191], v[40:43], v[116:119], v[188:191]
    v_mfma_f32_16x16x32_bf16 v[192:195], v[44:47], v[112:115], v[192:195]
    v_mfma_f32_16x16x32_bf16 v[196:199], v[44:47], v[116:119], v[196:199]
    s_add_u32 s31, s30, 16795648
    buffer_load_dwordx4 v[104:107], v12, s[8:11], s31 offen offset:0 sc1
    v_mfma_f32_16x16x32_bf16 v[248:251], v[48:51], v[112:115], v[248:251]
    s_add_u32 s31, s30, 16795648
    buffer_load_dwordx4 v[108:111], v12, s[8:11], s31 offen offset:256 sc1
    v_mfma_f32_16x16x32_bf16 v[252:255], v[48:51], v[116:119], v[252:255]
    v_mfma_f32_16x16x32_bf16 v[200:203], a[112:115], v[120:123], v[200:203]
    v_mfma_f32_16x16x32_bf16 v[204:207], a[112:115], v[124:127], v[204:207]
    v_mfma_f32_16x16x32_bf16 v[208:211], a[116:119], v[120:123], v[208:211]
    s_add_u32 s31, s30, 16782336
    buffer_load_dwordx4 v[24:27], v12, s[8:11], s31 offen offset:0 sc1
    v_mfma_f32_16x16x32_bf16 v[212:215], a[116:119], v[124:127], v[212:215]
    v_mfma_f32_16x16x32_bf16 v[216:219], a[120:123], v[120:123], v[216:219]
    v_mfma_f32_16x16x32_bf16 v[220:223], a[120:123], v[124:127], v[220:223]
    v_mfma_f32_16x16x32_bf16 v[224:227], a[124:127], v[120:123], v[224:227]
    s_add_u32 s31, s30, 16782336
    buffer_load_dwordx4 v[28:31], v12, s[8:11], s31 offen offset:256 sc1
    v_mfma_f32_16x16x32_bf16 v[228:231], a[124:127], v[124:127], v[228:231]
    v_mfma_f32_16x16x32_bf16 v[184:187], a[128:131], v[120:123], v[184:187]
    v_mfma_f32_16x16x32_bf16 v[188:191], a[128:131], v[124:127], v[188:191]
    v_mfma_f32_16x16x32_bf16 v[192:195], a[132:135], v[120:123], v[192:195]
    s_add_u32 s29, s25, 93184
    buffer_load_dwordx4 v[32:35], v3, s[8:11], s29 offen
    v_mfma_f32_16x16x32_bf16 v[196:199], a[132:135], v[124:127], v[196:199]
    v_mfma_f32_16x16x32_bf16 v[248:251], a[136:139], v[120:123], v[248:251]
    v_mfma_f32_16x16x32_bf16 v[252:255], a[136:139], v[124:127], v[252:255]
    v_mfma_f32_16x16x32_bf16 v[200:203], v[52:55], v[156:159], v[200:203]
    s_add_u32 s29, s25, 94208
    buffer_load_dwordx4 v[36:39], v3, s[8:11], s29 offen
    v_mfma_f32_16x16x32_bf16 v[204:207], v[52:55], v[160:163], v[204:207]
    v_mfma_f32_16x16x32_bf16 v[208:211], v[56:59], v[156:159], v[208:211]
    v_mfma_f32_16x16x32_bf16 v[212:215], v[56:59], v[160:163], v[212:215]
    v_mfma_f32_16x16x32_bf16 v[216:219], v[60:63], v[156:159], v[216:219]
    s_add_u32 s29, s25, 95232
    buffer_load_dwordx4 v[40:43], v3, s[8:11], s29 offen
    v_mfma_f32_16x16x32_bf16 v[220:223], v[60:63], v[160:163], v[220:223]
    v_mfma_f32_16x16x32_bf16 v[224:227], v[64:67], v[156:159], v[224:227]
    v_mfma_f32_16x16x32_bf16 v[228:231], v[64:67], v[160:163], v[228:231]
    v_mfma_f32_16x16x32_bf16 v[184:187], v[68:71], v[156:159], v[184:187]
    s_add_u32 s29, s25, 96256
    buffer_load_dwordx4 v[44:47], v3, s[8:11], s29 offen
    v_mfma_f32_16x16x32_bf16 v[188:191], v[68:71], v[160:163], v[188:191]
    v_mfma_f32_16x16x32_bf16 v[192:195], v[72:75], v[156:159], v[192:195]
    v_mfma_f32_16x16x32_bf16 v[196:199], v[72:75], v[160:163], v[196:199]
    s_add_u32 s31, s30, 16796672
    buffer_load_dwordx4 v[120:123], v12, s[8:11], s31 offen offset:0 sc1
    v_mfma_f32_16x16x32_bf16 v[248:251], v[76:79], v[156:159], v[248:251]
    s_add_u32 s31, s30, 16796672
    buffer_load_dwordx4 v[124:127], v12, s[8:11], s31 offen offset:256 sc1
    v_mfma_f32_16x16x32_bf16 v[252:255], v[76:79], v[160:163], v[252:255]
    s_add_u32 s31, s30, 16783360
    buffer_load_dwordx4 v[52:55], v12, s[8:11], s31 offen offset:0 sc1
    v_mfma_f32_16x16x32_bf16 v[200:203], a[140:143], v[164:167], v[200:203]
    s_add_u32 s31, s30, 16783360
    buffer_load_dwordx4 v[56:59], v12, s[8:11], s31 offen offset:256 sc1
    v_mfma_f32_16x16x32_bf16 v[204:207], a[140:143], v[168:171], v[204:207]
    s_add_u32 s31, s30, 16797696
    buffer_load_dwordx4 v[60:63], v12, s[8:11], s31 offen offset:0 sc1
    v_mfma_f32_16x16x32_bf16 v[208:211], a[144:147], v[164:167], v[208:211]
    s_add_u32 s31, s30, 16797696
    buffer_load_dwordx4 v[64:67], v12, s[8:11], s31 offen offset:256 sc1
    v_mfma_f32_16x16x32_bf16 v[212:215], a[144:147], v[168:171], v[212:215]
    v_mfma_f32_16x16x32_bf16 v[216:219], a[148:151], v[164:167], v[216:219]
    v_mfma_f32_16x16x32_bf16 v[220:223], a[148:151], v[168:171], v[220:223]
    v_mfma_f32_16x16x32_bf16 v[224:227], a[152:155], v[164:167], v[224:227]
    s_add_u32 s29, s25, 97280
    buffer_load_dwordx4 v[48:51], v3, s[8:11], s29 offen
    v_mfma_f32_16x16x32_bf16 v[228:231], a[152:155], v[168:171], v[228:231]
    v_mfma_f32_16x16x32_bf16 v[184:187], a[156:159], v[164:167], v[184:187]
    v_mfma_f32_16x16x32_bf16 v[188:191], a[156:159], v[168:171], v[188:191]
    v_mfma_f32_16x16x32_bf16 v[192:195], a[160:163], v[164:167], v[192:195]
    s_add_u32 s29, s25, 98304
    buffer_load_dwordx4 v[112:115], v3, s[8:11], s29 offen
    v_mfma_f32_16x16x32_bf16 v[196:199], a[160:163], v[168:171], v[196:199]
    v_mfma_f32_16x16x32_bf16 v[248:251], a[164:167], v[164:167], v[248:251]
    v_mfma_f32_16x16x32_bf16 v[252:255], a[164:167], v[168:171], v[252:255]
    s_barrier
    s_waitcnt vmcnt(19)
    v_mfma_f32_16x16x32_bf16 v[200:203], v[128:131], v[96:99], v[200:203]
    s_add_u32 s29, s25, 99328
    buffer_load_dwordx4 v[116:119], v3, s[8:11], s29 offen
    s_waitcnt vmcnt(19)
    v_mfma_f32_16x16x32_bf16 v[204:207], v[128:131], v[100:103], v[204:207]
    v_mfma_f32_16x16x32_bf16 v[208:211], v[132:135], v[96:99], v[208:211]
    v_mfma_f32_16x16x32_bf16 v[212:215], v[132:135], v[100:103], v[212:215]
    v_mfma_f32_16x16x32_bf16 v[216:219], v[136:139], v[96:99], v[216:219]
    v_mfma_f32_16x16x32_bf16 v[220:223], v[136:139], v[100:103], v[220:223]
    v_mfma_f32_16x16x32_bf16 v[224:227], v[140:143], v[96:99], v[224:227]
    v_mfma_f32_16x16x32_bf16 v[228:231], v[140:143], v[100:103], v[228:231]
    v_mfma_f32_16x16x32_bf16 v[184:187], v[144:147], v[96:99], v[184:187]
    v_mfma_f32_16x16x32_bf16 v[188:191], v[144:147], v[100:103], v[188:191]
    v_mfma_f32_16x16x32_bf16 v[192:195], v[148:151], v[96:99], v[192:195]
    v_mfma_f32_16x16x32_bf16 v[196:199], v[148:151], v[100:103], v[196:199]
    v_mfma_f32_16x16x32_bf16 v[248:251], v[152:155], v[96:99], v[248:251]
    v_mfma_f32_16x16x32_bf16 v[252:255], v[152:155], v[100:103], v[252:255]
    s_waitcnt vmcnt(16)
    v_mfma_f32_16x16x32_bf16 v[200:203], a[168:171], v[104:107], v[200:203]
    s_waitcnt vmcnt(15)
    v_mfma_f32_16x16x32_bf16 v[204:207], a[168:171], v[108:111], v[204:207]
    v_mfma_f32_16x16x32_bf16 v[208:211], a[172:175], v[104:107], v[208:211]
    v_mfma_f32_16x16x32_bf16 v[212:215], a[172:175], v[108:111], v[212:215]
    v_mfma_f32_16x16x32_bf16 v[216:219], a[176:179], v[104:107], v[216:219]
    v_mfma_f32_16x16x32_bf16 v[220:223], a[176:179], v[108:111], v[220:223]
    v_mfma_f32_16x16x32_bf16 v[224:227], a[180:183], v[104:107], v[224:227]
    v_mfma_f32_16x16x32_bf16 v[228:231], a[180:183], v[108:111], v[228:231]
    v_mfma_f32_16x16x32_bf16 v[184:187], a[184:187], v[104:107], v[184:187]
    v_mfma_f32_16x16x32_bf16 v[188:191], a[184:187], v[108:111], v[188:191]
    v_mfma_f32_16x16x32_bf16 v[192:195], a[188:191], v[104:107], v[192:195]
    v_mfma_f32_16x16x32_bf16 v[196:199], a[188:191], v[108:111], v[196:199]
    v_mfma_f32_16x16x32_bf16 v[248:251], a[192:195], v[104:107], v[248:251]
    v_mfma_f32_16x16x32_bf16 v[252:255], a[192:195], v[108:111], v[252:255]
    s_waitcnt vmcnt(14)
    v_mfma_f32_16x16x32_bf16 v[200:203], v[172:175], v[24:27], v[200:203]
    s_waitcnt vmcnt(13)
    v_mfma_f32_16x16x32_bf16 v[204:207], v[172:175], v[28:31], v[204:207]
    v_mfma_f32_16x16x32_bf16 v[208:211], v[176:179], v[24:27], v[208:211]
    v_mfma_f32_16x16x32_bf16 v[212:215], v[176:179], v[28:31], v[212:215]
    v_mfma_f32_16x16x32_bf16 v[216:219], v[180:183], v[24:27], v[216:219]
    v_mfma_f32_16x16x32_bf16 v[220:223], v[180:183], v[28:31], v[220:223]
    v_mfma_f32_16x16x32_bf16 v[224:227], v[80:83], v[24:27], v[224:227]
    v_mfma_f32_16x16x32_bf16 v[228:231], v[80:83], v[28:31], v[228:231]
    v_mfma_f32_16x16x32_bf16 v[184:187], v[84:87], v[24:27], v[184:187]
    v_mfma_f32_16x16x32_bf16 v[188:191], v[84:87], v[28:31], v[188:191]
    v_mfma_f32_16x16x32_bf16 v[192:195], v[88:91], v[24:27], v[192:195]
    v_mfma_f32_16x16x32_bf16 v[196:199], v[88:91], v[28:31], v[196:199]
    v_mfma_f32_16x16x32_bf16 v[248:251], v[92:95], v[24:27], v[248:251]
    v_mfma_f32_16x16x32_bf16 v[252:255], v[92:95], v[28:31], v[252:255]
    s_waitcnt vmcnt(8)
    v_mfma_f32_16x16x32_bf16 v[200:203], a[196:199], v[120:123], v[200:203]
    s_mul_i32 s26, s3, 14336
    v_add_u32 v6, s26, v3
    s_waitcnt vmcnt(7)
    v_mfma_f32_16x16x32_bf16 v[204:207], a[196:199], v[124:127], v[204:207]
    s_waitcnt vmcnt(6)
    v_mfma_f32_16x16x32_bf16 v[200:203], a[224:227], v[52:55], v[200:203]
    s_waitcnt vmcnt(5)
    v_mfma_f32_16x16x32_bf16 v[204:207], a[224:227], v[56:59], v[204:207]
    s_waitcnt vmcnt(4)
    v_mfma_f32_16x16x32_bf16 v[200:203], v[32:35], v[60:63], v[200:203]
    s_waitcnt vmcnt(3)
    v_mfma_f32_16x16x32_bf16 v[204:207], v[32:35], v[64:67], v[204:207]
    v_mfma_f32_16x16x32_bf16 v[208:211], a[200:203], v[120:123], v[208:211]
    v_mfma_f32_16x16x32_bf16 v[212:215], a[200:203], v[124:127], v[212:215]
    v_mfma_f32_16x16x32_bf16 v[208:211], a[228:231], v[52:55], v[208:211]
    s_nop 2
    ds_write_b128 v6, v[200:203] offset:0
    v_mfma_f32_16x16x32_bf16 v[212:215], a[228:231], v[56:59], v[212:215]
    ds_write_b128 v6, v[204:207] offset:1024
    v_mfma_f32_16x16x32_bf16 v[208:211], v[36:39], v[60:63], v[208:211]
    v_mfma_f32_16x16x32_bf16 v[212:215], v[36:39], v[64:67], v[212:215]
    v_mfma_f32_16x16x32_bf16 v[216:219], a[204:207], v[120:123], v[216:219]
    v_mfma_f32_16x16x32_bf16 v[220:223], a[204:207], v[124:127], v[220:223]
    v_mfma_f32_16x16x32_bf16 v[216:219], a[232:235], v[52:55], v[216:219]
    s_nop 3
    ds_write_b128 v6, v[208:211] offset:2048
    v_mfma_f32_16x16x32_bf16 v[220:223], a[232:235], v[56:59], v[220:223]
    ds_write_b128 v6, v[212:215] offset:3072
    v_mfma_f32_16x16x32_bf16 v[216:219], v[40:43], v[60:63], v[216:219]
    v_mfma_f32_16x16x32_bf16 v[220:223], v[40:43], v[64:67], v[220:223]
    v_mfma_f32_16x16x32_bf16 v[224:227], a[208:211], v[120:123], v[224:227]
    v_mfma_f32_16x16x32_bf16 v[228:231], a[208:211], v[124:127], v[228:231]
    v_mfma_f32_16x16x32_bf16 v[224:227], a[236:239], v[52:55], v[224:227]
    s_nop 3
    ds_write_b128 v6, v[216:219] offset:4096
    v_mfma_f32_16x16x32_bf16 v[228:231], a[236:239], v[56:59], v[228:231]
    ds_write_b128 v6, v[220:223] offset:5120
    v_mfma_f32_16x16x32_bf16 v[224:227], v[44:47], v[60:63], v[224:227]
    v_mfma_f32_16x16x32_bf16 v[228:231], v[44:47], v[64:67], v[228:231]
    v_mfma_f32_16x16x32_bf16 v[184:187], a[212:215], v[120:123], v[184:187]
    v_mfma_f32_16x16x32_bf16 v[188:191], a[212:215], v[124:127], v[188:191]
    v_mfma_f32_16x16x32_bf16 v[184:187], a[240:243], v[52:55], v[184:187]
    s_nop 3
    ds_write_b128 v6, v[224:227] offset:6144
    v_mfma_f32_16x16x32_bf16 v[188:191], a[240:243], v[56:59], v[188:191]
    ds_write_b128 v6, v[228:231] offset:7168
    s_waitcnt vmcnt(2)
    v_mfma_f32_16x16x32_bf16 v[184:187], v[48:51], v[60:63], v[184:187]
    v_mfma_f32_16x16x32_bf16 v[188:191], v[48:51], v[64:67], v[188:191]
    v_mfma_f32_16x16x32_bf16 v[192:195], a[216:219], v[120:123], v[192:195]
    v_mfma_f32_16x16x32_bf16 v[196:199], a[216:219], v[124:127], v[196:199]
    v_mfma_f32_16x16x32_bf16 v[192:195], a[244:247], v[52:55], v[192:195]
    s_nop 3
    ds_write_b128 v6, v[184:187] offset:8192
    v_mfma_f32_16x16x32_bf16 v[196:199], a[244:247], v[56:59], v[196:199]
    ds_write_b128 v6, v[188:191] offset:9216
    s_waitcnt vmcnt(1)
    v_mfma_f32_16x16x32_bf16 v[192:195], v[112:115], v[60:63], v[192:195]
    v_mfma_f32_16x16x32_bf16 v[196:199], v[112:115], v[64:67], v[196:199]
    v_mfma_f32_16x16x32_bf16 v[248:251], a[220:223], v[120:123], v[248:251]
    v_mfma_f32_16x16x32_bf16 v[252:255], a[220:223], v[124:127], v[252:255]
    v_mfma_f32_16x16x32_bf16 v[248:251], a[248:251], v[52:55], v[248:251]
    s_nop 3
    ds_write_b128 v6, v[192:195] offset:10240
    v_mfma_f32_16x16x32_bf16 v[252:255], a[248:251], v[56:59], v[252:255]
    ds_write_b128 v6, v[196:199] offset:11264
    s_waitcnt vmcnt(0)
    v_mfma_f32_16x16x32_bf16 v[248:251], v[116:119], v[60:63], v[248:251]
    v_mfma_f32_16x16x32_bf16 v[252:255], v[116:119], v[64:67], v[252:255]
    v_mov_b32 v13, v6
    v_lshlrev_b32 v6, 4, v0
    v_add_u32 v7, 4096, v6
    v_cmp_gt_u32 vcc, 192, v0
    v_mov_b32 v8, 2147483648
    s_nop 0
    v_cndmask_b32 v7, v8, v7, vcc
    v_and_b32 v9, 15, v2
    v_bfe_u32 v14, v2, 4, 1
    v_lshl_add_u32 v14, v1, 1, v14
    v_lshlrev_b32 v14, 10, v14
    v_lshrrev_b32 v15, 5, v2
    v_lshl_add_u32 v14, v15, 9, v14
    v_lshl_add_u32 v14, v9, 4, v14
    ds_write_b128 v13, v[248:251] offset:12288
    ds_write_b128 v13, v[252:255] offset:13312
    s_waitcnt lgkmcnt(0)
    s_barrier
    ds_read_b128 v[24:27], v14 offset:0
    ds_read_b128 v[28:31], v14 offset:256
    ds_read_b128 v[32:35], v14 offset:14336
    ds_read_b128 v[36:39], v14 offset:14592
    ds_read_b128 v[40:43], v14 offset:28672
    ds_read_b128 v[44:47], v14 offset:28928
    ds_read_b128 v[48:51], v14 offset:43008
    ds_read_b128 v[52:55], v14 offset:43264
    ds_read_b128 v[56:59], v14 offset:8192
    ds_read_b128 v[60:63], v14 offset:8448
    ds_read_b128 v[64:67], v14 offset:22528
    ds_read_b128 v[68:71], v14 offset:22784
    ds_read_b128 v[72:75], v14 offset:36864
    ds_read_b128 v[76:79], v14 offset:37120
    ds_read_b128 v[80:83], v14 offset:51200
    ds_read_b128 v[84:87], v14 offset:51456
    s_waitcnt lgkmcnt(8)
    v_pk_add_f32 v[24:25], v[24:25], v[32:33]
    v_pk_add_f32 v[40:41], v[40:41], v[48:49]
    v_pk_add_f32 v[26:27], v[26:27], v[34:35]
    v_pk_add_f32 v[42:43], v[42:43], v[50:51]
    v_pk_add_f32 v[28:29], v[28:29], v[36:37]
    v_pk_add_f32 v[44:45], v[44:45], v[52:53]
    v_pk_add_f32 v[30:31], v[30:31], v[38:39]
    v_pk_add_f32 v[46:47], v[46:47], v[54:55]
    v_pk_add_f32 v[24:25], v[24:25], v[40:41]
    v_pk_add_f32 v[26:27], v[26:27], v[42:43]
    v_pk_add_f32 v[28:29], v[28:29], v[44:45]
    v_pk_add_f32 v[30:31], v[30:31], v[46:47]
    v_cvt_pk_bf16_f32 v32, v24, v25
    v_cvt_pk_bf16_f32 v33, v26, v27
    v_cvt_pk_bf16_f32 v34, v28, v29
    v_cvt_pk_bf16_f32 v35, v30, v31
    v_lshlrev_b32 v24, 16, v32
    v_and_b32 v25, 0xffff0000, v32
    v_lshlrev_b32 v40, 16, v16
    v_and_b32 v41, 0xffff0000, v16
    v_lshlrev_b32 v26, 16, v33
    v_and_b32 v27, 0xffff0000, v33
    v_lshlrev_b32 v42, 16, v17
    v_and_b32 v43, 0xffff0000, v17
    v_lshlrev_b32 v28, 16, v34
    v_and_b32 v29, 0xffff0000, v34
    v_lshlrev_b32 v44, 16, v18
    v_and_b32 v45, 0xffff0000, v18
    v_lshlrev_b32 v30, 16, v35
    v_and_b32 v31, 0xffff0000, v35
    v_lshlrev_b32 v46, 16, v19
    v_and_b32 v47, 0xffff0000, v19
    v_pk_add_f32 v[24:25], v[24:25], v[40:41]
    v_pk_add_f32 v[26:27], v[26:27], v[42:43]
    v_pk_add_f32 v[28:29], v[28:29], v[44:45]
    v_pk_add_f32 v[30:31], v[30:31], v[46:47]
    v_cvt_pk_bf16_f32 v16, v24, v25
    v_cvt_pk_bf16_f32 v17, v26, v27
    v_cvt_pk_bf16_f32 v18, v28, v29
    v_cvt_pk_bf16_f32 v19, v30, v31
    s_waitcnt lgkmcnt(0)
    v_pk_add_f32 v[56:57], v[56:57], v[64:65]
    v_pk_add_f32 v[72:73], v[72:73], v[80:81]
    v_pk_add_f32 v[58:59], v[58:59], v[66:67]
    v_pk_add_f32 v[74:75], v[74:75], v[82:83]
    v_pk_add_f32 v[60:61], v[60:61], v[68:69]
    v_pk_add_f32 v[76:77], v[76:77], v[84:85]
    v_pk_add_f32 v[62:63], v[62:63], v[70:71]
    v_pk_add_f32 v[78:79], v[78:79], v[86:87]
    v_pk_add_f32 v[56:57], v[56:57], v[72:73]
    v_pk_add_f32 v[58:59], v[58:59], v[74:75]
    v_pk_add_f32 v[60:61], v[60:61], v[76:77]
    v_pk_add_f32 v[62:63], v[62:63], v[78:79]
    v_cvt_pk_bf16_f32 v64, v56, v57
    v_cvt_pk_bf16_f32 v65, v58, v59
    v_cvt_pk_bf16_f32 v66, v60, v61
    v_cvt_pk_bf16_f32 v67, v62, v63
    v_lshlrev_b32 v56, 16, v64
    v_and_b32 v57, 0xffff0000, v64
    v_lshlrev_b32 v72, 16, v20
    v_and_b32 v73, 0xffff0000, v20
    v_lshlrev_b32 v58, 16, v65
    v_and_b32 v59, 0xffff0000, v65
    v_lshlrev_b32 v74, 16, v21
    v_and_b32 v75, 0xffff0000, v21
    v_lshlrev_b32 v60, 16, v66
    v_and_b32 v61, 0xffff0000, v66
    v_lshlrev_b32 v76, 16, v22
    v_and_b32 v77, 0xffff0000, v22
    v_lshlrev_b32 v62, 16, v67
    v_and_b32 v63, 0xffff0000, v67
    v_lshlrev_b32 v78, 16, v23
    v_and_b32 v79, 0xffff0000, v23
    v_pk_add_f32 v[56:57], v[56:57], v[72:73]
    v_pk_add_f32 v[58:59], v[58:59], v[74:75]
    v_pk_add_f32 v[60:61], v[60:61], v[76:77]
    v_pk_add_f32 v[62:63], v[62:63], v[78:79]
    v_cvt_pk_bf16_f32 v20, v56, v57
    v_cvt_pk_bf16_f32 v21, v58, v59
    v_cvt_pk_bf16_f32 v22, v60, v61
    v_cvt_pk_bf16_f32 v23, v62, v63
    v_and_b32 v9, 31, v2
    v_mul_u32_u24 v9, 896, v9
    v_lshrrev_b32 v10, 5, v2
    v_lshl_add_u32 v9, v10, 4, v9
    v_lshl_add_u32 v9, v1, 5, v9
    v_add_u32 v10, 128, v9
    v_cmp_gt_u32 vcc, 192, v0
    s_nop 1
    v_cndmask_b32 v10, v8, v10, vcc
    s_mul_i32 s26, s21, 28672
    s_mul_i32 s27, s22, 224
    s_add_u32 s26, s26, s27
    buffer_store_dwordx4 v[16:19], v9, s[12:15], s26 offen
    buffer_store_dwordx4 v[20:23], v10, s[12:15], s26 offen
    s_endpgm
.section .rodata,"a"
.p2align 6
.amdhsa_kernel pre_kernel
  .amdhsa_next_free_vgpr 88
  .amdhsa_next_free_sgpr 80
  .amdhsa_accum_offset 88
  .amdhsa_group_segment_fixed_size 0
  .amdhsa_kernarg_size 104
  .amdhsa_user_sgpr_count 2
  .amdhsa_user_sgpr_kernarg_segment_ptr 1
  .amdhsa_system_sgpr_workgroup_id_x 1
.end_amdhsa_kernel
.p2align 6
.amdhsa_kernel ffn_kernel
  .amdhsa_next_free_vgpr 512
  .amdhsa_next_free_sgpr 100
  .amdhsa_accum_offset 256
  .amdhsa_group_segment_fixed_size 0
  .amdhsa_kernarg_size 104
  .amdhsa_user_sgpr_count 2
  .amdhsa_user_sgpr_kernarg_segment_ptr 1
  .amdhsa_system_sgpr_workgroup_id_x 1
.end_amdhsa_kernel
```
